```python
import torch

def _softmax(x, axis=-1):
    return torch.softmax(x, dim=axis)
def _gelu(x):
    return torch.nn.functional.gelu(x, approximate="tanh")
def _silu(x):
    return torch.nn.functional.silu(x)
def _sigmoid(x):
    return torch.sigmoid(x)
def _layernorm(x, axis=-1, eps=1e-5):
    m = x.mean(dim=axis, keepdim=True)
    v = x.var(dim=axis, keepdim=True, unbiased=False)
    return (x - m) / torch.sqrt(v + eps)
def _scatter_add(tgt, idx, src, axis=0):
    return tgt.clone().index_add_(axis, idx, src)
def _segment_sum(src, seg, n):
    out = torch.zeros((n,) + src.shape[1:], dtype=src.dtype)
    return out.index_add_(0, seg, src)
def _pad(x, pw):
    flat = tuple(v for pair in reversed(pw) for v in pair)
    return torch.nn.functional.pad(x, flat)

kernel_name = 'sequential_preLN__linear_kernel_hedgehog__swiglu_ffn__prompt'

def setup_inputs():

    _w = (lambda a: (lambda t: t.to(torch.bfloat16) if t.is_floating_point() else t)(torch.as_tensor(a)))
    def _A_setup():
        B, S, D, H = 1, 2048, 576, 32
        Dh = D // H
        return {
            "x": _w((lambda *s: torch.randn(*s, dtype=torch.bfloat16) * 0.05)(B, S, D)),
            "wqkv": _w((lambda *s: torch.randn(*s, dtype=torch.bfloat16) * 0.2)(D, 3 * D)),
            "w_phi": _w((lambda *s: torch.randn(*s, dtype=torch.bfloat16) * 0.2)(H, Dh, Dh) * (Dh ** -0.5)),
            "wo": _w((lambda *s: torch.randn(*s, dtype=torch.bfloat16) * 0.05)(D, D)),
        }
    _A_in = _A_setup()

    def _B_setup():
        B, S, D, F = 1, 2048, 576, 4608
        return {
            "x": _w((lambda *s: torch.randn(*s, dtype=torch.bfloat16) * 0.05)(B, S, D)),
            "w_gate": _w((lambda *s: torch.randn(*s, dtype=torch.bfloat16) * 0.05)(D, F)),
            "w_up": _w((lambda *s: torch.randn(*s, dtype=torch.bfloat16) * 0.05)(D, F)),
            "w_down": _w((lambda *s: torch.randn(*s, dtype=torch.bfloat16) * 0.05)(F, D)),
        }
    _B_in = _B_setup()

    return {
        "A_x": _A_in["x"],
        "A_wqkv": _A_in["wqkv"],
        "A_w_phi": _A_in["w_phi"],
        "A_wo": _A_in["wo"],
        "B_x": _B_in["x"],
        "B_w_gate": _B_in["w_gate"],
        "B_w_up": _B_in["w_up"],
        "B_w_down": _B_in["w_down"],
    }

def reference(A_x, A_wqkv, A_w_phi, A_wo, B_x, B_w_gate, B_w_up, B_w_down):
    def _A_ref(x, wqkv, w_phi, wo):
        B, S, D = x.shape
        H = 32; Dh = D // H
        qkv = (lambda x, *d: x.permute(*d))((x @ wqkv).reshape(B, S, 3, H, Dh), 2, 0, 3, 1, 4)
        q, k, v = qkv[0], qkv[1], qkv[2]
        pq = torch.einsum("bhsd,hdf->bhsf", q, w_phi)
        pk = torch.einsum("bhsd,hdf->bhsf", k, w_phi)
        phi_q = torch.concatenate([_softmax(pq, axis=-1), _softmax(-pq, axis=-1)], axis=-1)
        phi_k = torch.concatenate([_softmax(pk, axis=-1), _softmax(-pk, axis=-1)], axis=-1)
        kv = torch.einsum("bhsf,bhsd->bhfd", phi_k, v)
        z  = torch.einsum("bhsf->bhf", phi_k)
        num = torch.einsum("bhqf,bhfd->bhqd", phi_q, kv)
        den = torch.einsum("bhqf,bhf->bhq", phi_q, z)[..., None] + 1e-6
        o = num / den
        return (lambda x, *d: x.permute(*d))(o, 0, 2, 1, 3).reshape(B, S, D) @ wo

    def _B_ref(x, w_gate, w_up, w_down):
        g = _silu(x @ w_gate)
        u = x @ w_up
        return (g * u) @ w_down

    x = A_x
    h = x + _A_ref(_layernorm(x, axis=-1), A_wqkv, A_w_phi, A_wo)
    h2 = h + _B_ref(_layernorm(h, axis=-1), B_w_gate, B_w_up, B_w_down)
    return h2
```

```asm
; @launch grid=(256,1,1) block=(256,1,1) lds=156224
.amdgcn_target "amdgcn-amd-amdhsa--gfx950"
.text
.globl sequential_preLN__linear_kernel_hedgehog__swiglu_ffn__prompt_kernel
.p2align 8
.type sequential_preLN__linear_kernel_hedgehog__swiglu_ffn__prompt_kernel,@function
sequential_preLN__linear_kernel_hedgehog__swiglu_ffn__prompt_kernel:
    s_cmp_ge_u32 s2, 256
    s_cbranch_scc1 L_ffn_kernel_end
    s_load_dwordx8 s[4:11], s[0:1], 0
    s_load_dwordx4 s[44:47], s[0:1], 40
    s_load_dwordx2 s[50:51], s[0:1], 72
    s_load_dwordx2 s[52:53], s[0:1], 80
    v_lshrrev_b32 v1, 6, v0
    v_and_b32 v0, 63, v0
    v_readfirstlane_b32 s28, v1
    s_getpc_b64 s[56:57]
L_p1_pc:
    s_sub_u32 s56, s56, L_p1_pc-sequential_preLN__linear_kernel_hedgehog__swiglu_ffn__prompt_kernel
    s_subb_u32 s57, s57, 0
    s_bfe_u32 s58, s2, 0x20003
    s_lshl_b32 s58, s58, 2
    s_add_u32 s58, s58, s28
    s_lshl_b32 s58, s58, 13
    v_lshlrev_b32 v10, 7, v0
    v_add_u32 v10, s58, v10
    v_min_u32 v10, L_code_end-sequential_preLN__linear_kernel_hedgehog__swiglu_ffn__prompt_kernel-4, v10
    global_load_dword v234, v10, s[56:57]
    s_and_b32 s32, s2, 3
    s_lshl_b32 s32, s32, 2
    s_bfe_u32 s33, s2, 0x20003
    s_add_u32 s29, s32, s33
    s_and_b32 s32, s2, 4
    s_lshl_b32 s32, s32, 1
    s_lshr_b32 s33, s2, 5
    s_add_u32 s30, s32, s33
    s_and_b32 s31, s30, 1
    v_lshrrev_b32 v1, 4, v0
    v_lshlrev_b32 v2, 2, v1
    v_sub_u32 v2, v0, v2
    v_and_b32 v2, 15, v2
    v_cmp_ne_u32 s[42:43], 15, v2
    v_mul_u32_u24 v3, 13, v2
    v_lshrrev_b32 v3, 6, v3
    v_mul_u32_u24 v4, 1072, v3
    v_lshl_add_u32 v4, v2, 4, v4
    s_lshl_b32 s32, s28, 4
    v_add_u32 v1, s32, v1
    v_mul_u32_u24 v1, 3456, v1
    v_add_u32 v220, v1, v4
    v_add_u32 v221, 12800, v220
    v_add_u32 v222, 12800, v221
    v_add_u32 v223, 12800, v222
    s_mul_i32 s3, s30, 72
    s_andn2_b32 s3, s3, 15
    s_lshl_b32 s38, s28, 12
    v_lshrrev_b32 v1, 3, v0
    v_and_b32 v2, 7, v0
    v_lshrrev_b32 v3, 1, v1
    v_xor_b32 v2, v2, v3
    v_mul_u32_u24 v1, 1152, v1
    v_lshl_add_u32 v216, v2, 4, v1
    v_xor_b32 v2, 4, v2
    v_lshl_add_u32 v217, v2, 4, v1
    v_add_u32 v217, 8192, v217
    v_add_u32 v218, 16384, v216
    v_add_u32 v219, 16384, v217
    s_mul_i32 s37, s28, 12288
    s_add_u32 s37, s37, 98304
    s_lshl_b32 s32, s29, 2
    s_add_u32 s34, s32, s28
    s_mul_i32 s36, s34, 36864
    s_waitcnt lgkmcnt(0)
    s_mov_b32 s16, s6
    s_mov_b32 s17, s7
    s_mov_b32 s18, 1990656
    s_mov_b32 s19, 0x00020000
    s_mov_b32 s12, s4
    s_mov_b32 s13, s5
    s_mov_b32 s14, 2359296
    s_mov_b32 s15, 0x00020000
    s_mov_b32 s20, s52
    s_mov_b32 s21, s53
    s_mov_b32 s22, 46137344
    s_mov_b32 s23, 0x00020000
    v_lshlrev_b32 v232, 4, v0
    v_mov_b32 v144, 0
    v_mov_b32 v145, 0
    v_mov_b32 v146, 0
    v_mov_b32 v147, 0
    s_cmp_eq_u32 s29, 0
    s_cbranch_scc0 L_p1_nozero
    s_mul_i32 s32, s30, 7680
    s_mul_i32 s33, s28, 1888
    s_add_u32 s32, s32, s33
    s_add_u32 s32, s32, 4718592
    buffer_store_dwordx4 v[144:147], v232, s[20:23], s32 offen sc1
    buffer_store_dwordx4 v[144:147], v232, s[20:23], s32 offen offset:992 sc1
    s_lshl_b32 s32, s30, 2
    s_add_u32 s32, s32, s28
    s_lshl_b32 s32, s32, 10
    s_add_u32 s32, s32, 4997120
    buffer_store_dwordx4 v[144:147], v232, s[20:23], s32 offen sc1
L_p1_nozero:
    s_add_u32 m0, s38, 0
    s_add_u32 s35, s3, 0
    s_mov_b64 exec, s[42:43]
    buffer_load_dwordx4 v220, s[16:19], s35 offen lds
    buffer_load_dwordx4 v221, s[16:19], s35 offen offset:1024 lds
    buffer_load_dwordx4 v222, s[16:19], s35 offen offset:2048 lds
    buffer_load_dwordx4 v223, s[16:19], s35 offen offset:3072 lds
    s_mov_b64 exec, -1
    s_add_u32 m0, s37, 0
    s_add_u32 s35, s36, 0
    buffer_load_dwordx4 v216, s[12:15], s35 offen lds
    buffer_load_dwordx4 v217, s[12:15], s35 offen offset:1024 lds
    buffer_load_dwordx4 v218, s[12:15], s35 offen offset:2048 lds
    buffer_load_dwordx4 v219, s[12:15], s35 offen offset:3072 lds
    s_add_u32 m0, s38, 16384
    s_add_u32 s35, s3, 221184
    s_mov_b64 exec, s[42:43]
    buffer_load_dwordx4 v220, s[16:19], s35 offen lds
    buffer_load_dwordx4 v221, s[16:19], s35 offen offset:1024 lds
    buffer_load_dwordx4 v222, s[16:19], s35 offen offset:2048 lds
    buffer_load_dwordx4 v223, s[16:19], s35 offen offset:3072 lds
    s_mov_b64 exec, -1
    s_add_u32 m0, s37, 4096
    s_add_u32 s35, s36, 128
    buffer_load_dwordx4 v216, s[12:15], s35 offen lds
    buffer_load_dwordx4 v217, s[12:15], s35 offen offset:1024 lds
    buffer_load_dwordx4 v218, s[12:15], s35 offen offset:2048 lds
    buffer_load_dwordx4 v219, s[12:15], s35 offen offset:3072 lds
    s_mov_b32 s40, 0
    s_mov_b32 s41, -1
    s_lshl_b32 s39, s2, 2
    s_add_u32 s39, s39, s28
    v_lshrrev_b32 v230, 5, v0
    v_and_b32 v231, 31, v0
    v_lshlrev_b32 v232, 4, v0
    v_bfe_u32 v1, v0, 2, 2
    v_bfe_u32 v2, v0, 4, 1
    v_bfe_u32 v3, v0, 1, 1
    v_lshl_add_u32 v2, v2, 1, v3
    v_and_b32 v3, 1, v0
    v_lshl_add_u32 v4, v230, 3, v1
    v_lshlrev_b32 v4, 8, v4
    v_lshlrev_b32 v5, 3, v1
    v_lshl_add_u32 v6, v3, 2, v5
    v_add_u32 v6, s31, v6
    v_add3_u32 v7, v6, v2, 0
    v_and_b32 v7, 31, v7
    v_lshl_add_u32 v206, v7, 3, v4
    v_add3_u32 v7, v6, v2, 10
    v_and_b32 v7, 31, v7
    v_lshl_add_u32 v208, v7, 3, v4
    v_add3_u32 v7, v6, v2, 20
    v_and_b32 v7, 31, v7
    v_lshl_add_u32 v210, v7, 3, v4
    v_mad_u32_u24 v7, v2, 10, v6
    v_add_u32 v7, 4, v7
    v_add_u32 v8, 30, v5
    v_cmp_eq_u32 vcc, 3, v2
    s_nop 1
    v_cndmask_b32 v7, v7, v8, vcc
    v_and_b32 v7, 31, v7
    v_lshl_add_u32 v212, v7, 3, v4
    v_add_u32 v207, 49152, v206
    v_add_u32 v209, 49152, v208
    v_add_u32 v211, 49152, v210
    v_add_u32 v213, 49152, v212
    v_mov_b32 v214, v206
    s_cmp_eq_u32 s28, 1
    s_cselect_b64 vcc, -1, 0
    v_cndmask_b32 v214, v214, v208, vcc
    s_cmp_eq_u32 s28, 2
    s_cselect_b64 vcc, -1, 0
    v_cndmask_b32 v214, v214, v210, vcc
    s_cmp_eq_u32 s28, 3
    s_cselect_b64 vcc, -1, 0
    v_cndmask_b32 v214, v214, v212, vcc
    v_add_u32 v215, 49152, v214
    v_bfe_u32 v1, v231, 1, 3
    v_xor_b32 v1, v1, v230
    v_lshlrev_b32 v1, 4, v1
    v_lshl_add_u32 v1, v231, 7, v1
    v_xor_b32 v2, 0, v1
    v_add_u32 v224, s37, v2
    v_xor_b32 v2, 32, v1
    v_add_u32 v225, s37, v2
    v_xor_b32 v2, 64, v1
    v_add_u32 v226, s37, v2
    v_xor_b32 v2, 96, v1
    v_add_u32 v227, s37, v2
    v_mov_b32 v228, 0
    v_mov_b32 v229, 0
    v_mov_b32 v140, 0x3f803f80
    v_accvgpr_write_b32 a32, v140
    v_mov_b32 v141, 0x3f803f80
    v_accvgpr_write_b32 a33, v141
    v_mov_b32 v142, 0x3f803f80
    v_accvgpr_write_b32 a34, v142
    v_mov_b32 v143, 0x3f803f80
    v_accvgpr_write_b32 a35, v143
    v_and_b32 v1, 3, v0
    v_lshlrev_b32 v1, 2, v1
    v_add_u32 v1, 15, v1
    v_and_b32 v1, 15, v1
    v_lshlrev_b32 v1, 4, v1
    v_lshl_add_u32 v1, v0, 8, v1
    s_lshl_b32 s32, s28, 14
    v_add_u32 v2, s32, v1
    ds_write_b128 v2, v[140:143]
    s_and_b32 s32, s28, 1
    s_lshl_b32 s32, s32, 14
    s_add_u32 s32, s32, 65536
    v_add_u32 v2, s32, v1
    ds_write_b128 v2, v[140:143]
    s_mov_b32 s24, s8
    s_mov_b32 s25, s9
    s_mov_b32 s26, 20736
    s_mov_b32 s27, 0x00020000
    s_and_b32 s32, s28, 1
    s_lshl_b32 s32, s32, 10
    s_add_u32 m0, s32, 154112
    s_mul_i32 s33, s30, 1296
    s_add_u32 s33, s33, s32
    buffer_load_dwordx4 v232, s[24:27], s33 offen lds
    s_add_u32 m0, s38, 32768
    s_add_u32 s35, s3, 442368
    s_mov_b64 exec, s[42:43]
    buffer_load_dwordx4 v220, s[16:19], s35 offen lds
    buffer_load_dwordx4 v221, s[16:19], s35 offen offset:1024 lds
    buffer_load_dwordx4 v222, s[16:19], s35 offen offset:2048 lds
    buffer_load_dwordx4 v223, s[16:19], s35 offen offset:3072 lds
    s_mov_b64 exec, -1
    s_add_u32 m0, s37, 8192
    s_add_u32 s35, s36, 256
    buffer_load_dwordx4 v216, s[12:15], s35 offen lds
    buffer_load_dwordx4 v217, s[12:15], s35 offen offset:1024 lds
    buffer_load_dwordx4 v218, s[12:15], s35 offen offset:2048 lds
    buffer_load_dwordx4 v219, s[12:15], s35 offen offset:3072 lds
    s_waitcnt vmcnt(17)
    ds_read_b128 v[76:79], v224 offset:0
    ds_read_b128 v[80:83], v225 offset:0
    ds_read_b128 v[84:87], v226 offset:0
    ds_read_b128 v[88:91], v227 offset:0
    s_waitcnt vmcnt(13)
    s_waitcnt lgkmcnt(0)
    s_barrier
    ds_read_b64_tr_b16 v[108:109], v206 offset:0
    ds_read_b64_tr_b16 v[110:111], v206 offset:1024
    ds_read_b64_tr_b16 v[112:113], v208 offset:0
    ds_read_b64_tr_b16 v[114:115], v208 offset:1024
    ds_read_b64_tr_b16 v[116:117], v210 offset:0
    ds_read_b64_tr_b16 v[118:119], v210 offset:1024
    ds_read_b64_tr_b16 v[120:121], v212 offset:0
    ds_read_b64_tr_b16 v[122:123], v212 offset:1024
    ds_read_b64_tr_b16 v[124:125], v206 offset:4096
    ds_read_b64_tr_b16 v[126:127], v206 offset:5120
    ds_read_b64_tr_b16 v[128:129], v208 offset:4096
    ds_read_b64_tr_b16 v[130:131], v208 offset:5120
    s_add_u32 s32, s29, s28
    s_cmp_eq_u32 s32, 0
    s_cbranch_scc0 L_p1_noflag
    s_lshl_b32 s32, s30, 2
    v_mov_b32 v5, s32
    v_mov_b32 v6, 1
    global_store_dword v5, v6, s[50:51] sc0 sc1
L_p1_noflag:
    s_waitcnt lgkmcnt(8)
    v_mfma_f32_32x32x16_bf16 v[12:27], v[108:111], v[76:79], 0
    ds_read_b64_tr_b16 v[132:133], v210 offset:4096
    ds_read_b64_tr_b16 v[134:135], v210 offset:5120
    ds_read_b64_tr_b16 a[16:17], v214 offset:0
    ds_read_b64_tr_b16 a[18:19], v214 offset:1024
    v_lshlrev_b32 v1, 16, v76
    v_and_b32 v2, 0xffff0000, v76
    v_fmac_f32 v228, v1, v1
    v_fmac_f32 v229, v2, v2
    s_add_u32 m0, s37, 0
    s_add_u32 s35, s36, 384
    buffer_load_dwordx4 v216, s[12:15], s35 offen lds
    buffer_load_dwordx4 v217, s[12:15], s35 offen offset:1024 lds
    buffer_load_dwordx4 v218, s[12:15], s35 offen offset:2048 lds
    buffer_load_dwordx4 v219, s[12:15], s35 offen offset:3072 lds
    v_mfma_f32_32x32x16_bf16 v[28:43], v[112:115], v[76:79], 0
    ds_read_b64_tr_b16 v[136:137], v212 offset:4096
    ds_read_b64_tr_b16 v[138:139], v212 offset:5120
    v_lshlrev_b32 v3, 16, v77
    v_and_b32 v4, 0xffff0000, v77
    v_fmac_f32 v228, v3, v3
    v_fmac_f32 v229, v4, v4
    s_waitcnt vmcnt(13)
    ds_read_b128 v[92:95], v224 offset:4096
    ds_read_b128 v[96:99], v225 offset:4096
    ds_read_b128 v[100:103], v226 offset:4096
    ds_read_b128 v[104:107], v227 offset:4096
    s_waitcnt lgkmcnt(14)
    v_mfma_f32_32x32x16_bf16 v[44:59], v[116:119], v[76:79], 0
    ds_read_b64_tr_b16 v[108:109], v206 offset:8192
    ds_read_b64_tr_b16 v[110:111], v206 offset:9216
    v_lshlrev_b32 v1, 16, v78
    v_and_b32 v2, 0xffff0000, v78
    v_fmac_f32 v228, v1, v1
    v_fmac_f32 v229, v2, v2
    s_add_u32 m0, s38, 49152
    s_add_u32 s35, s3, 663552
    s_mov_b64 exec, s[42:43]
    buffer_load_dwordx4 v220, s[16:19], s35 offen lds
    buffer_load_dwordx4 v221, s[16:19], s35 offen offset:1024 lds
    buffer_load_dwordx4 v222, s[16:19], s35 offen offset:2048 lds
    buffer_load_dwordx4 v223, s[16:19], s35 offen offset:3072 lds
    s_mov_b64 exec, -1
    v_mfma_f32_32x32x16_bf16 v[60:75], v[120:123], v[76:79], 0
    ds_read_b64_tr_b16 v[112:113], v208 offset:8192
    ds_read_b64_tr_b16 v[114:115], v208 offset:9216
    v_lshlrev_b32 v3, 16, v79
    v_and_b32 v4, 0xffff0000, v79
    v_fmac_f32 v228, v3, v3
    v_fmac_f32 v229, v4, v4
    s_waitcnt lgkmcnt(10)
    v_mfma_f32_32x32x16_bf16 a[0:15], a[16:19], a[32:35], 0
    s_waitcnt lgkmcnt(14)
    v_mfma_f32_32x32x16_bf16 v[12:27], v[124:127], v[80:83], v[12:27]
    ds_read_b64_tr_b16 v[116:117], v210 offset:8192
    ds_read_b64_tr_b16 v[118:119], v210 offset:9216
    ds_read_b64_tr_b16 a[20:21], v214 offset:4096
    ds_read_b64_tr_b16 a[22:23], v214 offset:5120
    v_lshlrev_b32 v1, 16, v80
    v_and_b32 v2, 0xffff0000, v80
    v_fmac_f32 v228, v1, v1
    v_fmac_f32 v229, v2, v2
    s_mov_b32 s24, s10
    s_mov_b32 s25, s11
    s_mov_b32 s26, 663552
    s_mul_hi_u32 s32, s39, 119304648
    s_mul_i32 s33, s32, 36
    s_sub_u32 s33, s39, s33
    s_mul_i32 s56, s33, 57
    s_lshr_b32 s56, s56, 9
    s_mul_i32 s57, s56, 9
    s_sub_u32 s57, s33, s57
    s_lshl_b32 s57, s57, 3
    s_mul_i32 s56, s56, 144
    s_lshl_b32 s58, s32, 6
    s_cmp_lt_u32 s39, 648
    s_cselect_b32 s58, s58, 1073741824
    v_mul_u32_u24 v5, 10368, v230
    v_lshl_add_u32 v5, v231, 1, v5
    s_add_u32 s59, s57, 0
    s_mul_i32 s60, s59, 57
    s_lshr_b32 s60, s60, 9
    s_mul_i32 s60, s60, 9
    s_add_u32 s59, s59, s60
    s_add_u32 s59, s59, s56
    s_mul_i32 s59, s59, 1152
    s_add_u32 s59, s59, s58
    buffer_load_ushort v140, v5, s[24:27], s59 offen
    s_add_u32 s59, s57, 1
    s_mul_i32 s60, s59, 57
    s_lshr_b32 s60, s60, 9
    s_mul_i32 s60, s60, 9
    s_add_u32 s59, s59, s60
    s_add_u32 s59, s59, s56
    s_mul_i32 s59, s59, 1152
    s_add_u32 s59, s59, s58
    buffer_load_ushort v141, v5, s[24:27], s59 offen
    s_add_u32 s59, s57, 2
    s_mul_i32 s60, s59, 57
    s_lshr_b32 s60, s60, 9
    s_mul_i32 s60, s60, 9
    s_add_u32 s59, s59, s60
    s_add_u32 s59, s59, s56
    s_mul_i32 s59, s59, 1152
    s_add_u32 s59, s59, s58
    buffer_load_ushort v142, v5, s[24:27], s59 offen
    s_add_u32 s59, s57, 3
    s_mul_i32 s60, s59, 57
    s_lshr_b32 s60, s60, 9
    s_mul_i32 s60, s60, 9
    s_add_u32 s59, s59, s60
    s_add_u32 s59, s59, s56
    s_mul_i32 s59, s59, 1152
    s_add_u32 s59, s59, s58
    buffer_load_ushort v143, v5, s[24:27], s59 offen
    s_add_u32 s59, s57, 4
    s_mul_i32 s60, s59, 57
    s_lshr_b32 s60, s60, 9
    s_mul_i32 s60, s60, 9
    s_add_u32 s59, s59, s60
    s_add_u32 s59, s59, s56
    s_mul_i32 s59, s59, 1152
    s_add_u32 s59, s59, s58
    buffer_load_ushort v144, v5, s[24:27], s59 offen
    s_add_u32 s59, s57, 5
    s_mul_i32 s60, s59, 57
    s_lshr_b32 s60, s60, 9
    s_mul_i32 s60, s60, 9
    s_add_u32 s59, s59, s60
    s_add_u32 s59, s59, s56
    s_mul_i32 s59, s59, 1152
    s_add_u32 s59, s59, s58
    buffer_load_ushort v145, v5, s[24:27], s59 offen
    s_add_u32 s59, s57, 6
    s_mul_i32 s60, s59, 57
    s_lshr_b32 s60, s60, 9
    s_mul_i32 s60, s60, 9
    s_add_u32 s59, s59, s60
    s_add_u32 s59, s59, s56
    s_mul_i32 s59, s59, 1152
    s_add_u32 s59, s59, s58
    buffer_load_ushort v146, v5, s[24:27], s59 offen
    s_add_u32 s59, s57, 7
    s_mul_i32 s60, s59, 57
    s_lshr_b32 s60, s60, 9
    s_mul_i32 s60, s60, 9
    s_add_u32 s59, s59, s60
    s_add_u32 s59, s59, s56
    s_mul_i32 s59, s59, 1152
    s_add_u32 s59, s59, s58
    buffer_load_ushort v147, v5, s[24:27], s59 offen
    s_mul_i32 s59, s39, 1152
    buffer_load_dwordx4 v[148:151], v232, s[24:27], s59 offen
    v_lshlrev_b32 v5, 2, v231
    v_lshl_add_u32 v5, v230, 30, v5
    buffer_load_dword v152, v5, s[24:27], s59 offen offset:1024
    v_mfma_f32_32x32x16_bf16 v[28:43], v[128:131], v[80:83], v[28:43]
    ds_read_b64_tr_b16 v[120:121], v212 offset:8192
    ds_read_b64_tr_b16 v[122:123], v212 offset:9216
    v_lshlrev_b32 v3, 16, v81
    v_and_b32 v4, 0xffff0000, v81
    v_fmac_f32 v228, v3, v3
    v_fmac_f32 v229, v4, v4
    s_waitcnt lgkmcnt(14)
    v_mfma_f32_32x32x16_bf16 v[44:59], v[132:135], v[80:83], v[44:59]
    ds_read_b64_tr_b16 v[124:125], v206 offset:12288
    ds_read_b64_tr_b16 v[126:127], v206 offset:13312
    v_lshlrev_b32 v1, 16, v82
    v_and_b32 v2, 0xffff0000, v82
    v_fmac_f32 v228, v1, v1
    v_fmac_f32 v229, v2, v2
    s_waitcnt lgkmcnt(12)
    s_add_u32 m0, s37, 4096
    s_add_u32 s35, s36, 512
    buffer_load_dwordx4 v216, s[12:15], s35 offen lds
    buffer_load_dwordx4 v217, s[12:15], s35 offen offset:1024 lds
    buffer_load_dwordx4 v218, s[12:15], s35 offen offset:2048 lds
    buffer_load_dwordx4 v219, s[12:15], s35 offen offset:3072 lds
    v_mfma_f32_32x32x16_bf16 v[60:75], v[136:139], v[80:83], v[60:75]
    ds_read_b64_tr_b16 v[128:129], v208 offset:12288
    ds_read_b64_tr_b16 v[130:131], v208 offset:13312
    v_lshlrev_b32 v3, 16, v83
    v_and_b32 v4, 0xffff0000, v83
    v_fmac_f32 v228, v3, v3
    v_fmac_f32 v229, v4, v4
    s_waitcnt lgkmcnt(6)
    v_mfma_f32_32x32x16_bf16 a[0:15], a[20:23], a[32:35], a[0:15]
    s_waitcnt lgkmcnt(10)
    v_mfma_f32_32x32x16_bf16 v[12:27], v[108:111], v[84:87], v[12:27]
    ds_read_b64_tr_b16 v[132:133], v210 offset:12288
    ds_read_b64_tr_b16 v[134:135], v210 offset:13312
    ds_read_b64_tr_b16 a[24:25], v214 offset:8192
    ds_read_b64_tr_b16 a[26:27], v214 offset:9216
    v_lshlrev_b32 v1, 16, v84
    v_and_b32 v2, 0xffff0000, v84
    v_fmac_f32 v228, v1, v1
    v_fmac_f32 v229, v2, v2
    v_mfma_f32_32x32x16_bf16 v[28:43], v[112:115], v[84:87], v[28:43]
    ds_read_b64_tr_b16 v[136:137], v212 offset:12288
    ds_read_b64_tr_b16 v[138:139], v212 offset:13312
    v_lshlrev_b32 v3, 16, v85
    v_and_b32 v4, 0xffff0000, v85
    v_fmac_f32 v228, v3, v3
    v_fmac_f32 v229, v4, v4
    s_waitcnt lgkmcnt(10)
    v_mfma_f32_32x32x16_bf16 v[44:59], v[116:119], v[84:87], v[44:59]
    ds_read_b64_tr_b16 v[108:109], v206 offset:16384
    ds_read_b64_tr_b16 v[110:111], v206 offset:17408
    v_lshlrev_b32 v1, 16, v86
    v_and_b32 v2, 0xffff0000, v86
    v_fmac_f32 v228, v1, v1
    v_fmac_f32 v229, v2, v2
    v_mfma_f32_32x32x16_bf16 v[60:75], v[120:123], v[84:87], v[60:75]
    ds_read_b64_tr_b16 v[112:113], v208 offset:16384
    ds_read_b64_tr_b16 v[114:115], v208 offset:17408
    v_lshlrev_b32 v3, 16, v87
    v_and_b32 v4, 0xffff0000, v87
    v_fmac_f32 v228, v3, v3
    v_fmac_f32 v229, v4, v4
    s_waitcnt lgkmcnt(6)
    v_mfma_f32_32x32x16_bf16 a[0:15], a[24:27], a[32:35], a[0:15]
    s_waitcnt lgkmcnt(10)
    v_mfma_f32_32x32x16_bf16 v[12:27], v[124:127], v[88:91], v[12:27]
    ds_read_b64_tr_b16 v[116:117], v210 offset:16384
    ds_read_b64_tr_b16 v[118:119], v210 offset:17408
    ds_read_b64_tr_b16 a[28:29], v214 offset:12288
    ds_read_b64_tr_b16 a[30:31], v214 offset:13312
    v_lshlrev_b32 v1, 16, v88
    v_and_b32 v2, 0xffff0000, v88
    v_fmac_f32 v228, v1, v1
    v_fmac_f32 v229, v2, v2
    v_mfma_f32_32x32x16_bf16 v[28:43], v[128:131], v[88:91], v[28:43]
    ds_read_b64_tr_b16 v[120:121], v212 offset:16384
    ds_read_b64_tr_b16 v[122:123], v212 offset:17408
    v_lshlrev_b32 v3, 16, v89
    v_and_b32 v4, 0xffff0000, v89
    v_fmac_f32 v228, v3, v3
    v_fmac_f32 v229, v4, v4
    s_waitcnt lgkmcnt(10)
    v_mfma_f32_32x32x16_bf16 v[44:59], v[132:135], v[88:91], v[44:59]
    ds_read_b64_tr_b16 v[124:125], v206 offset:20480
    ds_read_b64_tr_b16 v[126:127], v206 offset:21504
    v_lshlrev_b32 v1, 16, v90
    v_and_b32 v2, 0xffff0000, v90
    v_fmac_f32 v228, v1, v1
    v_fmac_f32 v229, v2, v2
    v_mfma_f32_32x32x16_bf16 v[60:75], v[136:139], v[88:91], v[60:75]
    ds_read_b64_tr_b16 v[128:129], v208 offset:20480
    ds_read_b64_tr_b16 v[130:131], v208 offset:21504
    v_lshlrev_b32 v3, 16, v91
    v_and_b32 v4, 0xffff0000, v91
    v_fmac_f32 v228, v3, v3
    v_fmac_f32 v229, v4, v4
    s_waitcnt lgkmcnt(6)
    v_mfma_f32_32x32x16_bf16 a[0:15], a[28:31], a[32:35], a[0:15]
    s_waitcnt vmcnt(26)
    s_barrier
    s_waitcnt lgkmcnt(10)
    v_mfma_f32_32x32x16_bf16 v[12:27], v[108:111], v[92:95], v[12:27]
    ds_read_b64_tr_b16 v[132:133], v210 offset:20480
    ds_read_b64_tr_b16 v[134:135], v210 offset:21504
    ds_read_b64_tr_b16 a[16:17], v214 offset:16384
    ds_read_b64_tr_b16 a[18:19], v214 offset:17408
    v_lshlrev_b32 v1, 16, v92
    v_and_b32 v2, 0xffff0000, v92
    v_fmac_f32 v228, v1, v1
    v_fmac_f32 v229, v2, v2
    v_mfma_f32_32x32x16_bf16 v[28:43], v[112:115], v[92:95], v[28:43]
    ds_read_b64_tr_b16 v[136:137], v212 offset:20480
    ds_read_b64_tr_b16 v[138:139], v212 offset:21504
    v_lshlrev_b32 v3, 16, v93
    v_and_b32 v4, 0xffff0000, v93
    v_fmac_f32 v228, v3, v3
    v_fmac_f32 v229, v4, v4
    s_waitcnt vmcnt(22)
    ds_read_b128 v[76:79], v224 offset:8192
    ds_read_b128 v[80:83], v225 offset:8192
    ds_read_b128 v[84:87], v226 offset:8192
    ds_read_b128 v[88:91], v227 offset:8192
    s_waitcnt lgkmcnt(14)
    v_mfma_f32_32x32x16_bf16 v[44:59], v[116:119], v[92:95], v[44:59]
    ds_read_b64_tr_b16 v[108:109], v206 offset:24576
    ds_read_b64_tr_b16 v[110:111], v206 offset:25600
    v_lshlrev_b32 v1, 16, v94
    v_and_b32 v2, 0xffff0000, v94
    v_fmac_f32 v228, v1, v1
    v_fmac_f32 v229, v2, v2
    s_add_u32 m0, s38, 65536
    s_add_u32 s35, s3, 884736
    s_mov_b64 exec, s[42:43]
    buffer_load_dwordx4 v220, s[16:19], s35 offen lds
    buffer_load_dwordx4 v221, s[16:19], s35 offen offset:1024 lds
    buffer_load_dwordx4 v222, s[16:19], s35 offen offset:2048 lds
    buffer_load_dwordx4 v223, s[16:19], s35 offen offset:3072 lds
    s_mov_b64 exec, -1
    v_mfma_f32_32x32x16_bf16 v[60:75], v[120:123], v[92:95], v[60:75]
    ds_read_b64_tr_b16 v[112:113], v208 offset:24576
    ds_read_b64_tr_b16 v[114:115], v208 offset:25600
    v_lshlrev_b32 v3, 16, v95
    v_and_b32 v4, 0xffff0000, v95
    v_fmac_f32 v228, v3, v3
    v_fmac_f32 v229, v4, v4
    s_waitcnt lgkmcnt(10)
    v_mfma_f32_32x32x16_bf16 a[0:15], a[16:19], a[32:35], a[0:15]
    s_waitcnt lgkmcnt(14)
    v_mfma_f32_32x32x16_bf16 v[12:27], v[124:127], v[96:99], v[12:27]
    ds_read_b64_tr_b16 v[116:117], v210 offset:24576
    ds_read_b64_tr_b16 v[118:119], v210 offset:25600
    ds_read_b64_tr_b16 a[20:21], v214 offset:20480
    ds_read_b64_tr_b16 a[22:23], v214 offset:21504
    v_lshlrev_b32 v1, 16, v96
    v_and_b32 v2, 0xffff0000, v96
    v_fmac_f32 v228, v1, v1
    v_fmac_f32 v229, v2, v2
    v_mfma_f32_32x32x16_bf16 v[28:43], v[128:131], v[96:99], v[28:43]
    ds_read_b64_tr_b16 v[120:121], v212 offset:24576
    ds_read_b64_tr_b16 v[122:123], v212 offset:25600
    v_lshlrev_b32 v3, 16, v97
    v_and_b32 v4, 0xffff0000, v97
    v_fmac_f32 v228, v3, v3
    v_fmac_f32 v229, v4, v4
    s_waitcnt lgkmcnt(14)
    v_mfma_f32_32x32x16_bf16 v[44:59], v[132:135], v[96:99], v[44:59]
    ds_read_b64_tr_b16 v[124:125], v206 offset:28672
    ds_read_b64_tr_b16 v[126:127], v206 offset:29696
    v_lshlrev_b32 v1, 16, v98
    v_and_b32 v2, 0xffff0000, v98
    v_fmac_f32 v228, v1, v1
    v_fmac_f32 v229, v2, v2
    s_waitcnt lgkmcnt(12)
    s_add_u32 m0, s37, 8192
    s_add_u32 s35, s36, 640
    buffer_load_dwordx4 v216, s[12:15], s35 offen lds
    buffer_load_dwordx4 v217, s[12:15], s35 offen offset:1024 lds
    buffer_load_dwordx4 v218, s[12:15], s35 offen offset:2048 lds
    buffer_load_dwordx4 v219, s[12:15], s35 offen offset:3072 lds
    v_mfma_f32_32x32x16_bf16 v[60:75], v[136:139], v[96:99], v[60:75]
    ds_read_b64_tr_b16 v[128:129], v208 offset:28672
    ds_read_b64_tr_b16 v[130:131], v208 offset:29696
    v_lshlrev_b32 v3, 16, v99
    v_and_b32 v4, 0xffff0000, v99
    v_fmac_f32 v228, v3, v3
    v_fmac_f32 v229, v4, v4
    s_waitcnt lgkmcnt(6)
    v_mfma_f32_32x32x16_bf16 a[0:15], a[20:23], a[32:35], a[0:15]
    s_waitcnt lgkmcnt(10)
    v_mfma_f32_32x32x16_bf16 v[12:27], v[108:111], v[100:103], v[12:27]
    ds_read_b64_tr_b16 v[132:133], v210 offset:28672
    ds_read_b64_tr_b16 v[134:135], v210 offset:29696
    ds_read_b64_tr_b16 a[24:25], v214 offset:24576
    ds_read_b64_tr_b16 a[26:27], v214 offset:25600
    v_lshlrev_b32 v1, 16, v100
    v_and_b32 v2, 0xffff0000, v100
    v_fmac_f32 v228, v1, v1
    v_fmac_f32 v229, v2, v2
    v_mfma_f32_32x32x16_bf16 v[28:43], v[112:115], v[100:103], v[28:43]
    ds_read_b64_tr_b16 v[136:137], v212 offset:28672
    ds_read_b64_tr_b16 v[138:139], v212 offset:29696
    v_lshlrev_b32 v3, 16, v101
    v_and_b32 v4, 0xffff0000, v101
    v_fmac_f32 v228, v3, v3
    v_fmac_f32 v229, v4, v4
    s_waitcnt lgkmcnt(10)
    v_mfma_f32_32x32x16_bf16 v[44:59], v[116:119], v[100:103], v[44:59]
    ds_read_b64_tr_b16 v[108:109], v206 offset:32768
    ds_read_b64_tr_b16 v[110:111], v206 offset:33792
    v_lshlrev_b32 v1, 16, v102
    v_and_b32 v2, 0xffff0000, v102
    v_fmac_f32 v228, v1, v1
    v_fmac_f32 v229, v2, v2
    v_mfma_f32_32x32x16_bf16 v[60:75], v[120:123], v[100:103], v[60:75]
    ds_read_b64_tr_b16 v[112:113], v208 offset:32768
    ds_read_b64_tr_b16 v[114:115], v208 offset:33792
    v_lshlrev_b32 v3, 16, v103
    v_and_b32 v4, 0xffff0000, v103
    v_fmac_f32 v228, v3, v3
    v_fmac_f32 v229, v4, v4
    s_waitcnt lgkmcnt(6)
    v_mfma_f32_32x32x16_bf16 a[0:15], a[24:27], a[32:35], a[0:15]
    s_waitcnt lgkmcnt(10)
    v_mfma_f32_32x32x16_bf16 v[12:27], v[124:127], v[104:107], v[12:27]
    ds_read_b64_tr_b16 v[116:117], v210 offset:32768
    ds_read_b64_tr_b16 v[118:119], v210 offset:33792
    ds_read_b64_tr_b16 a[28:29], v214 offset:28672
    ds_read_b64_tr_b16 a[30:31], v214 offset:29696
    v_lshlrev_b32 v1, 16, v104
    v_and_b32 v2, 0xffff0000, v104
    v_fmac_f32 v228, v1, v1
    v_fmac_f32 v229, v2, v2
    v_mfma_f32_32x32x16_bf16 v[28:43], v[128:131], v[104:107], v[28:43]
    ds_read_b64_tr_b16 v[120:121], v212 offset:32768
    ds_read_b64_tr_b16 v[122:123], v212 offset:33792
    v_lshlrev_b32 v3, 16, v105
    v_and_b32 v4, 0xffff0000, v105
    v_fmac_f32 v228, v3, v3
    v_fmac_f32 v229, v4, v4
    s_waitcnt lgkmcnt(10)
    v_mfma_f32_32x32x16_bf16 v[44:59], v[132:135], v[104:107], v[44:59]
    ds_read_b64_tr_b16 v[124:125], v206 offset:36864
    ds_read_b64_tr_b16 v[126:127], v206 offset:37888
    v_lshlrev_b32 v1, 16, v106
    v_and_b32 v2, 0xffff0000, v106
    v_fmac_f32 v228, v1, v1
    v_fmac_f32 v229, v2, v2
    v_mfma_f32_32x32x16_bf16 v[60:75], v[136:139], v[104:107], v[60:75]
    ds_read_b64_tr_b16 v[128:129], v208 offset:36864
    ds_read_b64_tr_b16 v[130:131], v208 offset:37888
    v_lshlrev_b32 v3, 16, v107
    v_and_b32 v4, 0xffff0000, v107
    v_fmac_f32 v228, v3, v3
    v_fmac_f32 v229, v4, v4
    s_waitcnt lgkmcnt(6)
    v_mfma_f32_32x32x16_bf16 a[0:15], a[28:31], a[32:35], a[0:15]
    s_waitcnt vmcnt(22)
    s_barrier
    s_waitcnt lgkmcnt(10)
    v_mfma_f32_32x32x16_bf16 v[12:27], v[108:111], v[76:79], v[12:27]
    ds_read_b64_tr_b16 v[132:133], v210 offset:36864
    ds_read_b64_tr_b16 v[134:135], v210 offset:37888
    ds_read_b64_tr_b16 a[16:17], v214 offset:32768
    ds_read_b64_tr_b16 a[18:19], v214 offset:33792
    v_lshlrev_b32 v1, 16, v76
    v_and_b32 v2, 0xffff0000, v76
    v_fmac_f32 v228, v1, v1
    v_fmac_f32 v229, v2, v2
    v_mfma_f32_32x32x16_bf16 v[28:43], v[112:115], v[76:79], v[28:43]
    ds_read_b64_tr_b16 v[136:137], v212 offset:36864
    ds_read_b64_tr_b16 v[138:139], v212 offset:37888
    v_lshlrev_b32 v3, 16, v77
    v_and_b32 v4, 0xffff0000, v77
    v_fmac_f32 v228, v3, v3
    v_fmac_f32 v229, v4, v4
    s_waitcnt vmcnt(26)
    ds_read_b128 v[92:95], v224 offset:0
    ds_read_b128 v[96:99], v225 offset:0
    ds_read_b128 v[100:103], v226 offset:0
    ds_read_b128 v[104:107], v227 offset:0
    s_waitcnt lgkmcnt(14)
    v_mfma_f32_32x32x16_bf16 v[44:59], v[116:119], v[76:79], v[44:59]
    ds_read_b64_tr_b16 v[108:109], v206 offset:40960
    ds_read_b64_tr_b16 v[110:111], v206 offset:41984
    v_lshlrev_b32 v1, 16, v78
    v_and_b32 v2, 0xffff0000, v78
    v_fmac_f32 v228, v1, v1
    v_fmac_f32 v229, v2, v2
    s_add_u32 m0, s38, 81920
    s_add_u32 s35, s3, 1105920
    s_mov_b64 exec, s[42:43]
    buffer_load_dwordx4 v220, s[16:19], s35 offen lds
    buffer_load_dwordx4 v221, s[16:19], s35 offen offset:1024 lds
    buffer_load_dwordx4 v222, s[16:19], s35 offen offset:2048 lds
    buffer_load_dwordx4 v223, s[16:19], s35 offen offset:3072 lds
    s_mov_b64 exec, -1
    v_mfma_f32_32x32x16_bf16 v[60:75], v[120:123], v[76:79], v[60:75]
    ds_read_b64_tr_b16 v[112:113], v208 offset:40960
    ds_read_b64_tr_b16 v[114:115], v208 offset:41984
    v_lshlrev_b32 v3, 16, v79
    v_and_b32 v4, 0xffff0000, v79
    v_fmac_f32 v228, v3, v3
    v_fmac_f32 v229, v4, v4
    s_waitcnt lgkmcnt(10)
    v_mfma_f32_32x32x16_bf16 a[0:15], a[16:19], a[32:35], a[0:15]
    s_waitcnt lgkmcnt(14)
    v_mfma_f32_32x32x16_bf16 v[12:27], v[124:127], v[80:83], v[12:27]
    ds_read_b64_tr_b16 v[116:117], v210 offset:40960
    ds_read_b64_tr_b16 v[118:119], v210 offset:41984
    ds_read_b64_tr_b16 a[20:21], v214 offset:36864
    ds_read_b64_tr_b16 a[22:23], v214 offset:37888
    v_lshlrev_b32 v1, 16, v80
    v_and_b32 v2, 0xffff0000, v80
    v_fmac_f32 v228, v1, v1
    v_fmac_f32 v229, v2, v2
    s_waitcnt vmcnt(16)
    v_lshl_or_b32 v156, v141, 16, v140
    v_lshl_or_b32 v157, v143, 16, v142
    v_lshl_or_b32 v158, v145, 16, v144
    v_lshl_or_b32 v159, v147, 16, v146
    s_lshl_b32 s32, s39, 10
    s_add_u32 s32, s32, 5062656
    s_cmp_lt_u32 s39, 648
    s_cselect_b32 s32, s32, 1073741824
    buffer_store_dwordx4 v[156:159], v232, s[20:23], s32 offen sc1
    v_mov_b32 v5, 0
    v_mov_b32 v6, 0
    v_lshlrev_b32 v7, 16, v148
    v_and_b32 v8, 0xffff0000, v148
    v_add_f32 v5, v5, v7
    v_add_f32 v6, v6, v8
    v_lshlrev_b32 v9, 16, v149
    v_and_b32 v10, 0xffff0000, v149
    v_add_f32 v5, v5, v9
    v_add_f32 v6, v6, v10
    v_lshlrev_b32 v7, 16, v150
    v_and_b32 v8, 0xffff0000, v150
    v_add_f32 v5, v5, v7
    v_add_f32 v6, v6, v8
    v_lshlrev_b32 v9, 16, v151
    v_and_b32 v10, 0xffff0000, v151
    v_add_f32 v5, v5, v9
    v_add_f32 v6, v6, v10
    v_lshlrev_b32 v7, 16, v152
    v_and_b32 v8, 0xffff0000, v152
    v_add_f32 v5, v5, v7
    v_add_f32 v6, v6, v8
    v_add_f32 v5, v5, v6
    s_nop 1
    v_add_f32_dpp v5, v5, v5 quad_perm:[1,0,3,2] row_mask:0xf bank_mask:0xf
    s_nop 1
    v_add_f32_dpp v5, v5, v5 quad_perm:[2,3,0,1] row_mask:0xf bank_mask:0xf
    s_nop 1
    v_add_f32_dpp v5, v5, v5 row_half_mirror row_mask:0xf bank_mask:0xf
    s_nop 1
    v_add_f32_dpp v5, v5, v5 row_mirror row_mask:0xf bank_mask:0xf
    s_nop 1
    v_readlane_b32 s56, v5, 0
    v_readlane_b32 s57, v5, 16
    v_readlane_b32 s58, v5, 32
    v_readlane_b32 s59, v5, 48
    s_mul_hi_u32 s32, s39, 238609295
    v_mov_b32 v5, s56
    v_add_f32 v5, s57, v5
    v_add_f32 v5, s58, v5
    v_add_f32 v5, s59, v5
    s_mul_i32 s33, s32, 18
    s_sub_u32 s33, s39, s33
    s_cmp_ge_u32 s33, 9
    s_cselect_b32 s56, 9, 0
    s_cselect_b32 s57, 512, 0
    s_sub_u32 s33, s33, s56
    s_mul_i32 s32, s32, 9
    s_add_u32 s32, s32, s33
    s_lshr_b32 s33, s32, 3
    s_lshl_b32 s33, s33, 10
    s_and_b32 s32, s32, 7
    s_lshl_b32 s32, s32, 1
    s_add_u32 s32, s32, s33
    s_add_u32 s32, s32, s57
    s_add_u32 s32, s32, 5726208
    s_cmp_lt_u32 s39, 576
    s_cselect_b32 s32, s32, 1073741824
    v_mul_f32 v5, 0.001736111111111111, v5
    v_cvt_pk_bf16_f32 v7, v5, v5
    v_lshlrev_b32 v8, 16, v7
    v_sub_f32 v8, v5, v8
    v_cvt_pk_bf16_f32 v8, v8, v8
    v_and_b32 v9, 1, v0
    v_cmp_eq_u32 vcc, 1, v9
    v_bfe_u32 v10, v0, 1, 1
    v_lshl_add_u32 v9, v10, 2, v9
    v_cndmask_b32 v7, v7, v8, vcc
    v_lshlrev_b32 v9, 4, v9
    v_lshrrev_b32 v10, 2, v0
    v_min_u32 v10, 1, v10
    v_lshl_add_u32 v9, v10, 30, v9
    buffer_store_short v7, v9, s[20:23], s32 offen sc1
    v_min_u32 v233, 15, v0
    v_lshlrev_b32 v233, 2, v233
    global_load_dword v234, v233, s[50:51] sc0 sc1
    v_mfma_f32_32x32x16_bf16 v[28:43], v[128:131], v[80:83], v[28:43]
    ds_read_b64_tr_b16 v[120:121], v212 offset:40960
    ds_read_b64_tr_b16 v[122:123], v212 offset:41984
    v_lshlrev_b32 v3, 16, v81
    v_and_b32 v4, 0xffff0000, v81
    v_fmac_f32 v228, v3, v3
    v_fmac_f32 v229, v4, v4
    s_waitcnt lgkmcnt(14)
    v_mfma_f32_32x32x16_bf16 v[44:59], v[132:135], v[80:83], v[44:59]
    ds_read_b64_tr_b16 v[124:125], v206 offset:45056
    ds_read_b64_tr_b16 v[126:127], v206 offset:46080
    v_lshlrev_b32 v1, 16, v82
    v_and_b32 v2, 0xffff0000, v82
    v_fmac_f32 v228, v1, v1
    v_fmac_f32 v229, v2, v2
    s_waitcnt lgkmcnt(12)
    s_add_u32 m0, s37, 0
    s_add_u32 s35, s36, 768
    buffer_load_dwordx4 v216, s[12:15], s35 offen lds
    buffer_load_dwordx4 v217, s[12:15], s35 offen offset:1024 lds
    buffer_load_dwordx4 v218, s[12:15], s35 offen offset:2048 lds
    buffer_load_dwordx4 v219, s[12:15], s35 offen offset:3072 lds
    v_mfma_f32_32x32x16_bf16 v[60:75], v[136:139], v[80:83], v[60:75]
    ds_read_b64_tr_b16 v[128:129], v208 offset:45056
    ds_read_b64_tr_b16 v[130:131], v208 offset:46080
    v_lshlrev_b32 v3, 16, v83
    v_and_b32 v4, 0xffff0000, v83
    v_fmac_f32 v228, v3, v3
    v_fmac_f32 v229, v4, v4
    s_waitcnt lgkmcnt(6)
    v_mfma_f32_32x32x16_bf16 a[0:15], a[20:23], a[32:35], a[0:15]
    s_waitcnt lgkmcnt(10)
    v_mfma_f32_32x32x16_bf16 v[12:27], v[108:111], v[84:87], v[12:27]
    ds_read_b64_tr_b16 v[132:133], v210 offset:45056
    ds_read_b64_tr_b16 v[134:135], v210 offset:46080
    ds_read_b64_tr_b16 a[24:25], v214 offset:40960
    ds_read_b64_tr_b16 a[26:27], v214 offset:41984
    v_lshlrev_b32 v1, 16, v84
    v_and_b32 v2, 0xffff0000, v84
    v_fmac_f32 v228, v1, v1
    v_fmac_f32 v229, v2, v2
    v_mfma_f32_32x32x16_bf16 v[28:43], v[112:115], v[84:87], v[28:43]
    ds_read_b64_tr_b16 v[136:137], v212 offset:45056
    ds_read_b64_tr_b16 v[138:139], v212 offset:46080
    v_lshlrev_b32 v3, 16, v85
    v_and_b32 v4, 0xffff0000, v85
    v_fmac_f32 v228, v3, v3
    v_fmac_f32 v229, v4, v4
    s_waitcnt lgkmcnt(10)
    v_mfma_f32_32x32x16_bf16 v[44:59], v[116:119], v[84:87], v[44:59]
    ds_read_b64_tr_b16 v[108:109], v207 offset:0
    ds_read_b64_tr_b16 v[110:111], v207 offset:1024
    v_lshlrev_b32 v1, 16, v86
    v_and_b32 v2, 0xffff0000, v86
    v_fmac_f32 v228, v1, v1
    v_fmac_f32 v229, v2, v2
    s_add_u32 m0, s38, 0
    s_add_u32 s35, s3, 1327104
    s_mov_b64 exec, s[42:43]
    buffer_load_dwordx4 v220, s[16:19], s35 offen lds
    buffer_load_dwordx4 v221, s[16:19], s35 offen offset:1024 lds
    buffer_load_dwordx4 v222, s[16:19], s35 offen offset:2048 lds
    buffer_load_dwordx4 v223, s[16:19], s35 offen offset:3072 lds
    s_mov_b64 exec, -1
    v_mfma_f32_32x32x16_bf16 v[60:75], v[120:123], v[84:87], v[60:75]
    ds_read_b64_tr_b16 v[112:113], v209 offset:0
    ds_read_b64_tr_b16 v[114:115], v209 offset:1024
    v_lshlrev_b32 v3, 16, v87
    v_and_b32 v4, 0xffff0000, v87
    v_fmac_f32 v228, v3, v3
    v_fmac_f32 v229, v4, v4
    s_waitcnt lgkmcnt(6)
    v_mfma_f32_32x32x16_bf16 a[0:15], a[24:27], a[32:35], a[0:15]
    s_waitcnt lgkmcnt(10)
    v_mfma_f32_32x32x16_bf16 v[12:27], v[124:127], v[88:91], v[12:27]
    ds_read_b64_tr_b16 v[116:117], v211 offset:0
    ds_read_b64_tr_b16 v[118:119], v211 offset:1024
    ds_read_b64_tr_b16 a[28:29], v214 offset:45056
    ds_read_b64_tr_b16 a[30:31], v214 offset:46080
    v_lshlrev_b32 v1, 16, v88
    v_and_b32 v2, 0xffff0000, v88
    v_fmac_f32 v228, v1, v1
    v_fmac_f32 v229, v2, v2
    v_mfma_f32_32x32x16_bf16 v[28:43], v[128:131], v[88:91], v[28:43]
    ds_read_b64_tr_b16 v[120:121], v213 offset:0
    ds_read_b64_tr_b16 v[122:123], v213 offset:1024
    v_lshlrev_b32 v3, 16, v89
    v_and_b32 v4, 0xffff0000, v89
    v_fmac_f32 v228, v3, v3
    v_fmac_f32 v229, v4, v4
    s_waitcnt lgkmcnt(10)
    v_mfma_f32_32x32x16_bf16 v[44:59], v[132:135], v[88:91], v[44:59]
    ds_read_b64_tr_b16 v[124:125], v207 offset:4096
    ds_read_b64_tr_b16 v[126:127], v207 offset:5120
    v_lshlrev_b32 v1, 16, v90
    v_and_b32 v2, 0xffff0000, v90
    v_fmac_f32 v228, v1, v1
    v_fmac_f32 v229, v2, v2
    v_mfma_f32_32x32x16_bf16 v[60:75], v[136:139], v[88:91], v[60:75]
    ds_read_b64_tr_b16 v[128:129], v209 offset:4096
    ds_read_b64_tr_b16 v[130:131], v209 offset:5120
    v_lshlrev_b32 v3, 16, v91
    v_and_b32 v4, 0xffff0000, v91
    v_fmac_f32 v228, v3, v3
    v_fmac_f32 v229, v4, v4
    s_waitcnt lgkmcnt(6)
    v_mfma_f32_32x32x16_bf16 a[0:15], a[28:31], a[32:35], a[0:15]
    s_waitcnt vmcnt(19)
    s_barrier
    s_waitcnt lgkmcnt(10)
    v_mfma_f32_32x32x16_bf16 v[12:27], v[108:111], v[92:95], v[12:27]
    ds_read_b64_tr_b16 v[132:133], v211 offset:4096
    ds_read_b64_tr_b16 v[134:135], v211 offset:5120
    ds_read_b64_tr_b16 a[16:17], v215 offset:0
    ds_read_b64_tr_b16 a[18:19], v215 offset:1024
    v_lshlrev_b32 v1, 16, v92
    v_and_b32 v2, 0xffff0000, v92
    v_fmac_f32 v228, v1, v1
    v_fmac_f32 v229, v2, v2
    v_mfma_f32_32x32x16_bf16 v[28:43], v[112:115], v[92:95], v[28:43]
    ds_read_b64_tr_b16 v[136:137], v213 offset:4096
    ds_read_b64_tr_b16 v[138:139], v213 offset:5120
    v_lshlrev_b32 v3, 16, v93
    v_and_b32 v4, 0xffff0000, v93
    v_fmac_f32 v228, v3, v3
    v_fmac_f32 v229, v4, v4
    s_waitcnt vmcnt(23)
    ds_read_b128 v[76:79], v224 offset:4096
    ds_read_b128 v[80:83], v225 offset:4096
    ds_read_b128 v[84:87], v226 offset:4096
    ds_read_b128 v[88:91], v227 offset:4096
    s_waitcnt lgkmcnt(14)
    v_mfma_f32_32x32x16_bf16 v[44:59], v[116:119], v[92:95], v[44:59]
    ds_read_b64_tr_b16 v[108:109], v207 offset:8192
    ds_read_b64_tr_b16 v[110:111], v207 offset:9216
    v_lshlrev_b32 v1, 16, v94
    v_and_b32 v2, 0xffff0000, v94
    v_fmac_f32 v228, v1, v1
    v_fmac_f32 v229, v2, v2
    s_add_u32 m0, s38, 16384
    s_add_u32 s35, s3, 1548288
    s_mov_b64 exec, s[42:43]
    buffer_load_dwordx4 v220, s[16:19], s35 offen lds
    buffer_load_dwordx4 v221, s[16:19], s35 offen offset:1024 lds
    buffer_load_dwordx4 v222, s[16:19], s35 offen offset:2048 lds
    buffer_load_dwordx4 v223, s[16:19], s35 offen offset:3072 lds
    s_mov_b64 exec, -1
    v_mfma_f32_32x32x16_bf16 v[60:75], v[120:123], v[92:95], v[60:75]
    ds_read_b64_tr_b16 v[112:113], v209 offset:8192
    ds_read_b64_tr_b16 v[114:115], v209 offset:9216
    v_lshlrev_b32 v3, 16, v95
    v_and_b32 v4, 0xffff0000, v95
    v_fmac_f32 v228, v3, v3
    v_fmac_f32 v229, v4, v4
    s_waitcnt lgkmcnt(10)
    v_mfma_f32_32x32x16_bf16 a[0:15], a[16:19], a[32:35], a[0:15]
    s_waitcnt lgkmcnt(14)
    v_mfma_f32_32x32x16_bf16 v[12:27], v[124:127], v[96:99], v[12:27]
    ds_read_b64_tr_b16 v[116:117], v211 offset:8192
    ds_read_b64_tr_b16 v[118:119], v211 offset:9216
    ds_read_b64_tr_b16 a[20:21], v215 offset:4096
    ds_read_b64_tr_b16 a[22:23], v215 offset:5120
    v_lshlrev_b32 v1, 16, v96
    v_and_b32 v2, 0xffff0000, v96
    v_fmac_f32 v228, v1, v1
    v_fmac_f32 v229, v2, v2
    v_mfma_f32_32x32x16_bf16 v[28:43], v[128:131], v[96:99], v[28:43]
    ds_read_b64_tr_b16 v[120:121], v213 offset:8192
    ds_read_b64_tr_b16 v[122:123], v213 offset:9216
    v_lshlrev_b32 v3, 16, v97
    v_and_b32 v4, 0xffff0000, v97
    v_fmac_f32 v228, v3, v3
    v_fmac_f32 v229, v4, v4
    s_waitcnt lgkmcnt(14)
    v_mfma_f32_32x32x16_bf16 v[44:59], v[132:135], v[96:99], v[44:59]
    ds_read_b64_tr_b16 v[124:125], v207 offset:12288
    ds_read_b64_tr_b16 v[126:127], v207 offset:13312
    v_lshlrev_b32 v1, 16, v98
    v_and_b32 v2, 0xffff0000, v98
    v_fmac_f32 v228, v1, v1
    v_fmac_f32 v229, v2, v2
    s_waitcnt lgkmcnt(12)
    s_add_u32 m0, s37, 4096
    s_add_u32 s35, s36, 896
    buffer_load_dwordx4 v216, s[12:15], s35 offen lds
    buffer_load_dwordx4 v217, s[12:15], s35 offen offset:1024 lds
    buffer_load_dwordx4 v218, s[12:15], s35 offen offset:2048 lds
    buffer_load_dwordx4 v219, s[12:15], s35 offen offset:3072 lds
    v_mfma_f32_32x32x16_bf16 v[60:75], v[136:139], v[96:99], v[60:75]
    ds_read_b64_tr_b16 v[128:129], v209 offset:12288
    ds_read_b64_tr_b16 v[130:131], v209 offset:13312
    v_lshlrev_b32 v3, 16, v99
    v_and_b32 v4, 0xffff0000, v99
    v_fmac_f32 v228, v3, v3
    v_fmac_f32 v229, v4, v4
    s_waitcnt lgkmcnt(6)
    v_mfma_f32_32x32x16_bf16 a[0:15], a[20:23], a[32:35], a[0:15]
    s_waitcnt lgkmcnt(10)
    v_mfma_f32_32x32x16_bf16 v[12:27], v[108:111], v[100:103], v[12:27]
    ds_read_b64_tr_b16 v[132:133], v211 offset:12288
    ds_read_b64_tr_b16 v[134:135], v211 offset:13312
    ds_read_b64_tr_b16 a[24:25], v215 offset:8192
    ds_read_b64_tr_b16 a[26:27], v215 offset:9216
    v_lshlrev_b32 v1, 16, v100
    v_and_b32 v2, 0xffff0000, v100
    v_fmac_f32 v228, v1, v1
    v_fmac_f32 v229, v2, v2
    v_mfma_f32_32x32x16_bf16 v[28:43], v[112:115], v[100:103], v[28:43]
    ds_read_b64_tr_b16 v[136:137], v213 offset:12288
    ds_read_b64_tr_b16 v[138:139], v213 offset:13312
    v_lshlrev_b32 v3, 16, v101
    v_and_b32 v4, 0xffff0000, v101
    v_fmac_f32 v228, v3, v3
    v_fmac_f32 v229, v4, v4
    s_waitcnt lgkmcnt(10)
    v_mfma_f32_32x32x16_bf16 v[44:59], v[116:119], v[100:103], v[44:59]
    ds_read_b64_tr_b16 v[108:109], v207 offset:16384
    ds_read_b64_tr_b16 v[110:111], v207 offset:17408
    v_lshlrev_b32 v1, 16, v102
    v_and_b32 v2, 0xffff0000, v102
    v_fmac_f32 v228, v1, v1
    v_fmac_f32 v229, v2, v2
    v_mfma_f32_32x32x16_bf16 v[60:75], v[120:123], v[100:103], v[60:75]
    ds_read_b64_tr_b16 v[112:113], v209 offset:16384
    ds_read_b64_tr_b16 v[114:115], v209 offset:17408
    v_lshlrev_b32 v3, 16, v103
    v_and_b32 v4, 0xffff0000, v103
    v_fmac_f32 v228, v3, v3
    v_fmac_f32 v229, v4, v4
    s_waitcnt lgkmcnt(6)
    v_mfma_f32_32x32x16_bf16 a[0:15], a[24:27], a[32:35], a[0:15]
    s_waitcnt lgkmcnt(10)
    v_mfma_f32_32x32x16_bf16 v[12:27], v[124:127], v[104:107], v[12:27]
    ds_read_b64_tr_b16 v[116:117], v211 offset:16384
    ds_read_b64_tr_b16 v[118:119], v211 offset:17408
    ds_read_b64_tr_b16 a[28:29], v215 offset:12288
    ds_read_b64_tr_b16 a[30:31], v215 offset:13312
    v_lshlrev_b32 v1, 16, v104
    v_and_b32 v2, 0xffff0000, v104
    v_fmac_f32 v228, v1, v1
    v_fmac_f32 v229, v2, v2
    s_waitcnt vmcnt(16)
    s_mov_b32 s33, 0x40000
L_p1_poll:
    v_cmp_eq_u32 vcc, 0, v234
    s_sub_u32 s33, s33, 1
    s_cbranch_scc1 L_p1_polled
    s_cmp_eq_u64 vcc, 0
    s_cbranch_scc1 L_p1_polled
    global_load_dword v234, v233, s[50:51] sc0 sc1
    s_waitcnt vmcnt(0)
    s_branch L_p1_poll
L_p1_polled:
    v_mfma_f32_32x32x16_bf16 v[28:43], v[128:131], v[104:107], v[28:43]
    ds_read_b64_tr_b16 v[120:121], v213 offset:16384
    ds_read_b64_tr_b16 v[122:123], v213 offset:17408
    v_lshlrev_b32 v3, 16, v105
    v_and_b32 v4, 0xffff0000, v105
    v_fmac_f32 v228, v3, v3
    v_fmac_f32 v229, v4, v4
    s_waitcnt lgkmcnt(10)
    v_mfma_f32_32x32x16_bf16 v[44:59], v[132:135], v[104:107], v[44:59]
    ds_read_b64_tr_b16 v[124:125], v207 offset:20480
    ds_read_b64_tr_b16 v[126:127], v207 offset:21504
    v_lshlrev_b32 v1, 16, v106
    v_and_b32 v2, 0xffff0000, v106
    v_fmac_f32 v228, v1, v1
    v_fmac_f32 v229, v2, v2
    v_mfma_f32_32x32x16_bf16 v[60:75], v[136:139], v[104:107], v[60:75]
    ds_read_b64_tr_b16 v[128:129], v209 offset:20480
    ds_read_b64_tr_b16 v[130:131], v209 offset:21504
    v_lshlrev_b32 v3, 16, v107
    v_and_b32 v4, 0xffff0000, v107
    v_fmac_f32 v228, v3, v3
    v_fmac_f32 v229, v4, v4
    s_waitcnt lgkmcnt(6)
    v_mfma_f32_32x32x16_bf16 a[0:15], a[28:31], a[32:35], a[0:15]
    s_waitcnt vmcnt(17)
    s_barrier
    v_cmp_eq_u32 vcc, 0, v0
    v_mov_b32 v5, 1073741824
    v_mov_b32 v6, 1
    v_cndmask_b32 v5, v5, 0, vcc
    s_lshl_b32 s32, s30, 7
    s_add_u32 s32, s32, 5046272
    s_cmp_eq_u32 s28, 0
    s_cselect_b32 s32, s32, 1073741824
    buffer_atomic_add v6, v5, s[20:23], s32 offen sc1
    s_waitcnt lgkmcnt(10)
    v_mfma_f32_32x32x16_bf16 v[12:27], v[108:111], v[76:79], v[12:27]
    ds_read_b64_tr_b16 v[132:133], v211 offset:20480
    ds_read_b64_tr_b16 v[134:135], v211 offset:21504
    ds_read_b64_tr_b16 a[16:17], v215 offset:16384
    ds_read_b64_tr_b16 a[18:19], v215 offset:17408
    v_lshlrev_b32 v1, 16, v76
    v_and_b32 v2, 0xffff0000, v76
    v_fmac_f32 v228, v1, v1
    v_fmac_f32 v229, v2, v2
    v_mfma_f32_32x32x16_bf16 v[28:43], v[112:115], v[76:79], v[28:43]
    ds_read_b64_tr_b16 v[136:137], v213 offset:20480
    ds_read_b64_tr_b16 v[138:139], v213 offset:21504
    v_lshlrev_b32 v3, 16, v77
    v_and_b32 v4, 0xffff0000, v77
    v_fmac_f32 v228, v3, v3
    v_fmac_f32 v229, v4, v4
    s_waitcnt vmcnt(24)
    ds_read_b128 v[92:95], v224 offset:8192
    ds_read_b128 v[96:99], v225 offset:8192
    ds_read_b128 v[100:103], v226 offset:8192
    ds_read_b128 v[104:107], v227 offset:8192
    s_waitcnt lgkmcnt(14)
    v_mfma_f32_32x32x16_bf16 v[44:59], v[116:119], v[76:79], v[44:59]
    ds_read_b64_tr_b16 v[108:109], v207 offset:24576
    ds_read_b64_tr_b16 v[110:111], v207 offset:25600
    v_lshlrev_b32 v1, 16, v78
    v_and_b32 v2, 0xffff0000, v78
    v_fmac_f32 v228, v1, v1
    v_fmac_f32 v229, v2, v2
    s_add_u32 m0, s38, 32768
    s_add_u32 s35, s3, 1769472
    s_mov_b64 exec, s[42:43]
    buffer_load_dwordx4 v220, s[16:19], s35 offen lds
    buffer_load_dwordx4 v221, s[16:19], s35 offen offset:1024 lds
    buffer_load_dwordx4 v222, s[16:19], s35 offen offset:2048 lds
    buffer_load_dwordx4 v223, s[16:19], s35 offen offset:3072 lds
    s_mov_b64 exec, -1
    v_mfma_f32_32x32x16_bf16 v[60:75], v[120:123], v[76:79], v[60:75]
    ds_read_b64_tr_b16 v[112:113], v209 offset:24576
    ds_read_b64_tr_b16 v[114:115], v209 offset:25600
    v_lshlrev_b32 v3, 16, v79
    v_and_b32 v4, 0xffff0000, v79
    v_fmac_f32 v228, v3, v3
    v_fmac_f32 v229, v4, v4
    s_waitcnt lgkmcnt(10)
    v_mfma_f32_32x32x16_bf16 a[0:15], a[16:19], a[32:35], a[0:15]
    s_waitcnt lgkmcnt(14)
    v_mfma_f32_32x32x16_bf16 v[12:27], v[124:127], v[80:83], v[12:27]
    ds_read_b64_tr_b16 v[116:117], v211 offset:24576
    ds_read_b64_tr_b16 v[118:119], v211 offset:25600
    ds_read_b64_tr_b16 a[20:21], v215 offset:20480
    ds_read_b64_tr_b16 a[22:23], v215 offset:21504
    v_lshlrev_b32 v1, 16, v80
    v_and_b32 v2, 0xffff0000, v80
    v_fmac_f32 v228, v1, v1
    v_fmac_f32 v229, v2, v2
    v_lshrrev_b32 v5, 3, v231
    v_and_b32 v6, 3, v231
    v_lshl_add_u32 v7, v5, 2, v6
    s_and_b32 s32, s28, 1
    s_lshl_b32 s33, s32, 4
    v_add_u32 v7, s33, v7
    v_bfe_u32 v8, v231, 2, 1
    v_cmp_eq_u32 vcc, v8, v230
    v_cmp_gt_u32 s[54:55], 18, v7
    s_and_b64 s[54:55], vcc, s[54:55]
    s_andn2_b64 s[56:57], s[54:55], s[40:41]
    s_and_b64 s[58:59], s[54:55], s[40:41]
    v_mov_b32 v9, 576
    v_mul_u32_u24 v9, v9, v230
    v_lshl_add_u32 v9, v7, 1, v9
    v_add_u32 v9, 154112, v9
    ds_read_u16 v140, v9 offset:0
    ds_read_u16 v141, v9 offset:36
    ds_read_u16 v142, v9 offset:72
    ds_read_u16 v143, v9 offset:108
    ds_read_u16 v144, v9 offset:144
    ds_read_u16 v145, v9 offset:180
    ds_read_u16 v146, v9 offset:216
    ds_read_u16 v147, v9 offset:252
    ds_read_u16 v148, v9 offset:288
    ds_read_u16 v149, v9 offset:324
    ds_read_u16 v150, v9 offset:360
    ds_read_u16 v151, v9 offset:396
    ds_read_u16 v152, v9 offset:432
    ds_read_u16 v153, v9 offset:468
    ds_read_u16 v154, v9 offset:504
    ds_read_u16 v155, v9 offset:540
    ds_read_u16 v156, v9 offset:576
    ds_read_u16 v157, v9 offset:612
    ds_read_u16 v158, v9 offset:648
    ds_read_u16 v159, v9 offset:684
    v_mfma_f32_32x32x16_bf16 v[28:43], v[128:131], v[80:83], v[28:43]
    ds_read_b64_tr_b16 v[120:121], v213 offset:24576
    ds_read_b64_tr_b16 v[122:123], v213 offset:25600
    v_lshlrev_b32 v3, 16, v81
    v_and_b32 v4, 0xffff0000, v81
    v_fmac_f32 v228, v3, v3
    v_fmac_f32 v229, v4, v4
    s_waitcnt lgkmcnt(15)
    v_mfma_f32_32x32x16_bf16 v[44:59], v[132:135], v[80:83], v[44:59]
    ds_read_b64_tr_b16 v[124:125], v207 offset:28672
    ds_read_b64_tr_b16 v[126:127], v207 offset:29696
    v_lshlrev_b32 v1, 16, v82
    v_and_b32 v2, 0xffff0000, v82
    v_fmac_f32 v228, v1, v1
    v_fmac_f32 v229, v2, v2
    s_waitcnt lgkmcnt(15)
    s_add_u32 m0, s37, 8192
    s_add_u32 s35, s36, 1024
    buffer_load_dwordx4 v216, s[12:15], s35 offen lds
    buffer_load_dwordx4 v217, s[12:15], s35 offen offset:1024 lds
    buffer_load_dwordx4 v218, s[12:15], s35 offen offset:2048 lds
    buffer_load_dwordx4 v219, s[12:15], s35 offen offset:3072 lds
    v_mfma_f32_32x32x16_bf16 v[60:75], v[136:139], v[80:83], v[60:75]
    ds_read_b64_tr_b16 v[128:129], v209 offset:28672
    ds_read_b64_tr_b16 v[130:131], v209 offset:29696
    v_lshlrev_b32 v3, 16, v83
    v_and_b32 v4, 0xffff0000, v83
    v_fmac_f32 v228, v3, v3
    v_fmac_f32 v229, v4, v4
    s_waitcnt lgkmcnt(15)
    v_mfma_f32_32x32x16_bf16 a[0:15], a[20:23], a[32:35], a[0:15]
    s_waitcnt lgkmcnt(15)
    v_mfma_f32_32x32x16_bf16 v[12:27], v[108:111], v[84:87], v[12:27]
    ds_read_b64_tr_b16 v[132:133], v211 offset:28672
    ds_read_b64_tr_b16 v[134:135], v211 offset:29696
    ds_read_b64_tr_b16 a[24:25], v215 offset:24576
    ds_read_b64_tr_b16 a[26:27], v215 offset:25600
    v_lshlrev_b32 v1, 16, v84
    v_and_b32 v2, 0xffff0000, v84
    v_fmac_f32 v228, v1, v1
    v_fmac_f32 v229, v2, v2
    v_mfma_f32_32x32x16_bf16 v[28:43], v[112:115], v[84:87], v[28:43]
    ds_read_b64_tr_b16 v[136:137], v213 offset:28672
    ds_read_b64_tr_b16 v[138:139], v213 offset:29696
    v_lshlrev_b32 v3, 16, v85
    v_and_b32 v4, 0xffff0000, v85
    v_fmac_f32 v228, v3, v3
    v_fmac_f32 v229, v4, v4
    s_waitcnt lgkmcnt(10)
    v_mfma_f32_32x32x16_bf16 v[44:59], v[116:119], v[84:87], v[44:59]
    ds_read_b64_tr_b16 v[108:109], v207 offset:32768
    ds_read_b64_tr_b16 v[110:111], v207 offset:33792
    v_lshlrev_b32 v1, 16, v86
    v_and_b32 v2, 0xffff0000, v86
    v_fmac_f32 v228, v1, v1
    v_fmac_f32 v229, v2, v2
    v_mfma_f32_32x32x16_bf16 v[60:75], v[120:123], v[84:87], v[60:75]
    ds_read_b64_tr_b16 v[112:113], v209 offset:32768
    ds_read_b64_tr_b16 v[114:115], v209 offset:33792
    v_lshlrev_b32 v3, 16, v87
    v_and_b32 v4, 0xffff0000, v87
    v_fmac_f32 v228, v3, v3
    v_fmac_f32 v229, v4, v4
    s_waitcnt lgkmcnt(6)
    v_mfma_f32_32x32x16_bf16 a[0:15], a[24:27], a[32:35], a[0:15]
    s_waitcnt lgkmcnt(10)
    v_mfma_f32_32x32x16_bf16 v[12:27], v[124:127], v[88:91], v[12:27]
    ds_read_b64_tr_b16 v[116:117], v211 offset:32768
    ds_read_b64_tr_b16 v[118:119], v211 offset:33792
    ds_read_b64_tr_b16 a[28:29], v215 offset:28672
    ds_read_b64_tr_b16 a[30:31], v215 offset:29696
    v_lshlrev_b32 v1, 16, v88
    v_and_b32 v2, 0xffff0000, v88
    v_fmac_f32 v228, v1, v1
    v_fmac_f32 v229, v2, v2
    s_waitcnt lgkmcnt(15)
    v_lshl_or_b32 v164, v141, 16, v140
    v_cndmask_b32 v164, 0, v164, s[56:57]
    v_lshl_or_b32 v165, v143, 16, v142
    v_cndmask_b32 v165, 0, v165, s[54:55]
    v_lshl_or_b32 v166, v145, 16, v144
    v_cndmask_b32 v166, 0, v166, s[54:55]
    v_lshl_or_b32 v167, v147, 16, v146
    v_cndmask_b32 v167, 0, v167, s[54:55]
    v_lshl_or_b32 v168, v149, 16, v148
    v_cndmask_b32 v168, 0, v168, s[54:55]
    v_lshl_or_b32 v169, v151, 16, v150
    v_cndmask_b32 v169, 0, v169, s[54:55]
    v_lshl_or_b32 v170, v153, 16, v152
    v_cndmask_b32 v170, 0, v170, s[54:55]
    v_lshl_or_b32 v171, v155, 16, v154
    v_cndmask_b32 v171, 0, v171, s[54:55]
    v_lshl_or_b32 v172, v157, 16, v156
    v_cndmask_b32 v172, 0, v172, s[54:55]
    v_lshl_or_b32 v173, v159, 16, v158
    v_cndmask_b32 v173, 0, v173, s[58:59]
    v_mov_b32 v174, 0
    v_mov_b32 v175, 0
    s_and_b32 s32, s28, 1
    s_mul_i32 s32, s32, 3072
    s_add_u32 s32, s32, 147456
    v_add_u32 v5, s32, v232
    ds_write_b128 v5, v[164:167] offset:0
    ds_write_b128 v5, v[168:171] offset:1024
    ds_write_b128 v5, v[172:175] offset:2048
    v_mfma_f32_32x32x16_bf16 v[28:43], v[128:131], v[88:91], v[28:43]
    ds_read_b64_tr_b16 v[120:121], v213 offset:32768
    ds_read_b64_tr_b16 v[122:123], v213 offset:33792
    v_lshlrev_b32 v3, 16, v89
    v_and_b32 v4, 0xffff0000, v89
    v_fmac_f32 v228, v3, v3
    v_fmac_f32 v229, v4, v4
    s_waitcnt lgkmcnt(13)
    v_mfma_f32_32x32x16_bf16 v[44:59], v[132:135], v[88:91], v[44:59]
    ds_read_b64_tr_b16 v[124:125], v207 offset:36864
    ds_read_b64_tr_b16 v[126:127], v207 offset:37888
    v_lshlrev_b32 v1, 16, v90
    v_and_b32 v2, 0xffff0000, v90
    v_fmac_f32 v228, v1, v1
    v_fmac_f32 v229, v2, v2
    v_mfma_f32_32x32x16_bf16 v[60:75], v[136:139], v[88:91], v[60:75]
    ds_read_b64_tr_b16 v[128:129], v209 offset:36864
    ds_read_b64_tr_b16 v[130:131], v209 offset:37888
    v_lshlrev_b32 v3, 16, v91
    v_and_b32 v4, 0xffff0000, v91
    v_fmac_f32 v228, v3, v3
    v_fmac_f32 v229, v4, v4
    s_waitcnt lgkmcnt(9)
    v_mfma_f32_32x32x16_bf16 a[0:15], a[28:31], a[32:35], a[0:15]
    s_waitcnt vmcnt(17)
    s_barrier
    s_waitcnt lgkmcnt(13)
    v_mfma_f32_32x32x16_bf16 v[12:27], v[108:111], v[92:95], v[12:27]
    ds_read_b64_tr_b16 v[132:133], v211 offset:36864
    ds_read_b64_tr_b16 v[134:135], v211 offset:37888
    ds_read_b64_tr_b16 a[16:17], v215 offset:32768
    ds_read_b64_tr_b16 a[18:19], v215 offset:33792
    v_lshlrev_b32 v1, 16, v92
    v_and_b32 v2, 0xffff0000, v92
    v_fmac_f32 v228, v1, v1
    v_fmac_f32 v229, v2, v2
    v_mfma_f32_32x32x16_bf16 v[28:43], v[112:115], v[92:95], v[28:43]
    ds_read_b64_tr_b16 v[136:137], v213 offset:36864
    ds_read_b64_tr_b16 v[138:139], v213 offset:37888
    v_lshlrev_b32 v3, 16, v93
    v_and_b32 v4, 0xffff0000, v93
    v_fmac_f32 v228, v3, v3
    v_fmac_f32 v229, v4, v4
    s_waitcnt vmcnt(21)
    ds_read_b128 v[76:79], v224 offset:0
    ds_read_b128 v[80:83], v225 offset:0
    ds_read_b128 v[84:87], v226 offset:0
    ds_read_b128 v[88:91], v227 offset:0
    s_waitcnt lgkmcnt(14)
    v_mfma_f32_32x32x16_bf16 v[44:59], v[116:119], v[92:95], v[44:59]
    ds_read_b64_tr_b16 v[108:109], v207 offset:40960
    ds_read_b64_tr_b16 v[110:111], v207 offset:41984
    v_lshlrev_b32 v1, 16, v94
    v_and_b32 v2, 0xffff0000, v94
    v_fmac_f32 v228, v1, v1
    v_fmac_f32 v229, v2, v2
    v_mfma_f32_32x32x16_bf16 v[60:75], v[120:123], v[92:95], v[60:75]
    ds_read_b64_tr_b16 v[112:113], v209 offset:40960
    ds_read_b64_tr_b16 v[114:115], v209 offset:41984
    v_lshlrev_b32 v3, 16, v95
    v_and_b32 v4, 0xffff0000, v95
    v_fmac_f32 v228, v3, v3
    v_fmac_f32 v229, v4, v4
    s_waitcnt lgkmcnt(10)
    v_mfma_f32_32x32x16_bf16 a[0:15], a[16:19], a[32:35], a[0:15]
    s_waitcnt lgkmcnt(14)
    v_mfma_f32_32x32x16_bf16 v[12:27], v[124:127], v[96:99], v[12:27]
    ds_read_b64_tr_b16 v[116:117], v211 offset:40960
    ds_read_b64_tr_b16 v[118:119], v211 offset:41984
    ds_read_b64_tr_b16 a[20:21], v215 offset:36864
    ds_read_b64_tr_b16 a[22:23], v215 offset:37888
    v_lshlrev_b32 v1, 16, v96
    v_and_b32 v2, 0xffff0000, v96
    v_fmac_f32 v228, v1, v1
    v_fmac_f32 v229, v2, v2
    v_mfma_f32_32x32x16_bf16 v[28:43], v[128:131], v[96:99], v[28:43]
    ds_read_b64_tr_b16 v[120:121], v213 offset:40960
    ds_read_b64_tr_b16 v[122:123], v213 offset:41984
    v_lshlrev_b32 v3, 16, v97
    v_and_b32 v4, 0xffff0000, v97
    v_fmac_f32 v228, v3, v3
    v_fmac_f32 v229, v4, v4
    s_waitcnt lgkmcnt(14)
    v_mfma_f32_32x32x16_bf16 v[44:59], v[132:135], v[96:99], v[44:59]
    ds_read_b64_tr_b16 v[124:125], v207 offset:45056
    ds_read_b64_tr_b16 v[126:127], v207 offset:46080
    v_lshlrev_b32 v1, 16, v98
    v_and_b32 v2, 0xffff0000, v98
    v_fmac_f32 v228, v1, v1
    v_fmac_f32 v229, v2, v2
    v_mfma_f32_32x32x16_bf16 v[60:75], v[136:139], v[96:99], v[60:75]
    ds_read_b64_tr_b16 v[128:129], v209 offset:45056
    ds_read_b64_tr_b16 v[130:131], v209 offset:46080
    v_lshlrev_b32 v3, 16, v99
    v_and_b32 v4, 0xffff0000, v99
    v_fmac_f32 v228, v3, v3
    v_fmac_f32 v229, v4, v4
    s_waitcnt lgkmcnt(6)
    v_mfma_f32_32x32x16_bf16 a[0:15], a[20:23], a[32:35], a[0:15]
    s_waitcnt lgkmcnt(10)
    v_mfma_f32_32x32x16_bf16 v[12:27], v[108:111], v[100:103], v[12:27]
    ds_read_b64_tr_b16 v[132:133], v211 offset:45056
    ds_read_b64_tr_b16 v[134:135], v211 offset:46080
    ds_read_b64_tr_b16 a[24:25], v215 offset:40960
    ds_read_b64_tr_b16 a[26:27], v215 offset:41984
    v_lshlrev_b32 v1, 16, v100
    v_and_b32 v2, 0xffff0000, v100
    v_fmac_f32 v228, v1, v1
    v_fmac_f32 v229, v2, v2
    v_mfma_f32_32x32x16_bf16 v[28:43], v[112:115], v[100:103], v[28:43]
    ds_read_b64_tr_b16 v[136:137], v213 offset:45056
    ds_read_b64_tr_b16 v[138:139], v213 offset:46080
    v_lshlrev_b32 v3, 16, v101
    v_and_b32 v4, 0xffff0000, v101
    v_fmac_f32 v228, v3, v3
    v_fmac_f32 v229, v4, v4
    s_waitcnt lgkmcnt(10)
    v_mfma_f32_32x32x16_bf16 v[44:59], v[116:119], v[100:103], v[44:59]
    ds_read_b64_tr_b16 v[108:109], v206 offset:0
    ds_read_b64_tr_b16 v[110:111], v206 offset:1024
    v_lshlrev_b32 v1, 16, v102
    v_and_b32 v2, 0xffff0000, v102
    v_fmac_f32 v228, v1, v1
    v_fmac_f32 v229, v2, v2
    v_mfma_f32_32x32x16_bf16 v[60:75], v[120:123], v[100:103], v[60:75]
    ds_read_b64_tr_b16 v[112:113], v208 offset:0
    ds_read_b64_tr_b16 v[114:115], v208 offset:1024
    v_lshlrev_b32 v3, 16, v103
    v_and_b32 v4, 0xffff0000, v103
    v_fmac_f32 v228, v3, v3
    v_fmac_f32 v229, v4, v4
    s_waitcnt lgkmcnt(6)
    v_mfma_f32_32x32x16_bf16 a[0:15], a[24:27], a[32:35], a[0:15]
    s_waitcnt lgkmcnt(10)
    v_mfma_f32_32x32x16_bf16 v[12:27], v[124:127], v[104:107], v[12:27]
    ds_read_b64_tr_b16 v[116:117], v210 offset:0
    ds_read_b64_tr_b16 v[118:119], v210 offset:1024
    ds_read_b64_tr_b16 a[28:29], v215 offset:45056
    ds_read_b64_tr_b16 a[30:31], v215 offset:46080
    v_lshlrev_b32 v1, 16, v104
    v_and_b32 v2, 0xffff0000, v104
    v_fmac_f32 v228, v1, v1
    v_fmac_f32 v229, v2, v2
    v_mfma_f32_32x32x16_bf16 v[28:43], v[128:131], v[104:107], v[28:43]
    ds_read_b64_tr_b16 v[120:121], v212 offset:0
    ds_read_b64_tr_b16 v[122:123], v212 offset:1024
    v_lshlrev_b32 v3, 16, v105
    v_and_b32 v4, 0xffff0000, v105
    v_fmac_f32 v228, v3, v3
    v_fmac_f32 v229, v4, v4
    s_waitcnt lgkmcnt(10)
    v_mfma_f32_32x32x16_bf16 v[44:59], v[132:135], v[104:107], v[44:59]
    ds_read_b64_tr_b16 v[124:125], v206 offset:4096
    ds_read_b64_tr_b16 v[126:127], v206 offset:5120
    v_lshlrev_b32 v1, 16, v106
    v_and_b32 v2, 0xffff0000, v106
    v_fmac_f32 v228, v1, v1
    v_fmac_f32 v229, v2, v2
    v_mfma_f32_32x32x16_bf16 v[60:75], v[136:139], v[104:107], v[60:75]
    ds_read_b64_tr_b16 v[128:129], v208 offset:4096
    ds_read_b64_tr_b16 v[130:131], v208 offset:5120
    v_lshlrev_b32 v3, 16, v107
    v_and_b32 v4, 0xffff0000, v107
    v_fmac_f32 v228, v3, v3
    v_fmac_f32 v229, v4, v4
    s_waitcnt lgkmcnt(6)
    v_mfma_f32_32x32x16_bf16 a[0:15], a[28:31], a[32:35], a[0:15]
    s_waitcnt vmcnt(13)
    s_barrier
    s_waitcnt lgkmcnt(10)
    v_mfma_f32_32x32x16_bf16 v[12:27], v[108:111], v[76:79], v[12:27]
    ds_read_b64_tr_b16 v[132:133], v210 offset:4096
    ds_read_b64_tr_b16 v[134:135], v210 offset:5120
    ds_read_b64_tr_b16 a[16:17], v214 offset:0
    ds_read_b64_tr_b16 a[18:19], v214 offset:1024
    v_lshlrev_b32 v1, 16, v76
    v_and_b32 v2, 0xffff0000, v76
    v_fmac_f32 v228, v1, v1
    v_fmac_f32 v229, v2, v2
    v_mfma_f32_32x32x16_bf16 v[28:43], v[112:115], v[76:79], v[28:43]
    ds_read_b64_tr_b16 v[136:137], v212 offset:4096
    ds_read_b64_tr_b16 v[138:139], v212 offset:5120
    v_lshlrev_b32 v3, 16, v77
    v_and_b32 v4, 0xffff0000, v77
    v_fmac_f32 v228, v3, v3
    v_fmac_f32 v229, v4, v4
    s_waitcnt vmcnt(9)
    ds_read_b128 v[92:95], v224 offset:4096
    ds_read_b128 v[96:99], v225 offset:4096
    ds_read_b128 v[100:103], v226 offset:4096
    ds_read_b128 v[104:107], v227 offset:4096
    s_waitcnt lgkmcnt(14)
    v_mfma_f32_32x32x16_bf16 v[44:59], v[116:119], v[76:79], v[44:59]
    ds_read_b64_tr_b16 v[108:109], v206 offset:8192
    ds_read_b64_tr_b16 v[110:111], v206 offset:9216
    v_lshlrev_b32 v1, 16, v78
    v_and_b32 v2, 0xffff0000, v78
    v_fmac_f32 v228, v1, v1
    v_fmac_f32 v229, v2, v2
    v_mfma_f32_32x32x16_bf16 v[60:75], v[120:123], v[76:79], v[60:75]
    ds_read_b64_tr_b16 v[112:113], v208 offset:8192
    ds_read_b64_tr_b16 v[114:115], v208 offset:9216
    v_lshlrev_b32 v3, 16, v79
    v_and_b32 v4, 0xffff0000, v79
    v_fmac_f32 v228, v3, v3
    v_fmac_f32 v229, v4, v4
    s_waitcnt lgkmcnt(10)
    v_mfma_f32_32x32x16_bf16 a[0:15], a[16:19], a[32:35], a[0:15]
    s_waitcnt lgkmcnt(14)
    v_mfma_f32_32x32x16_bf16 v[12:27], v[124:127], v[80:83], v[12:27]
    ds_read_b64_tr_b16 v[116:117], v210 offset:8192
    ds_read_b64_tr_b16 v[118:119], v210 offset:9216
    ds_read_b64_tr_b16 a[20:21], v214 offset:4096
    ds_read_b64_tr_b16 a[22:23], v214 offset:5120
    v_lshlrev_b32 v1, 16, v80
    v_and_b32 v2, 0xffff0000, v80
    v_fmac_f32 v228, v1, v1
    v_fmac_f32 v229, v2, v2
    v_mfma_f32_32x32x16_bf16 v[28:43], v[128:131], v[80:83], v[28:43]
    ds_read_b64_tr_b16 v[120:121], v212 offset:8192
    ds_read_b64_tr_b16 v[122:123], v212 offset:9216
    v_lshlrev_b32 v3, 16, v81
    v_and_b32 v4, 0xffff0000, v81
    v_fmac_f32 v228, v3, v3
    v_fmac_f32 v229, v4, v4
    s_waitcnt lgkmcnt(14)
    v_mfma_f32_32x32x16_bf16 v[44:59], v[132:135], v[80:83], v[44:59]
    ds_read_b64_tr_b16 v[124:125], v206 offset:12288
    ds_read_b64_tr_b16 v[126:127], v206 offset:13312
    v_lshlrev_b32 v1, 16, v82
    v_and_b32 v2, 0xffff0000, v82
    v_fmac_f32 v228, v1, v1
    v_fmac_f32 v229, v2, v2
    v_mfma_f32_32x32x16_bf16 v[60:75], v[136:139], v[80:83], v[60:75]
    ds_read_b64_tr_b16 v[128:129], v208 offset:12288
    ds_read_b64_tr_b16 v[130:131], v208 offset:13312
    v_lshlrev_b32 v3, 16, v83
    v_and_b32 v4, 0xffff0000, v83
    v_fmac_f32 v228, v3, v3
    v_fmac_f32 v229, v4, v4
    s_waitcnt lgkmcnt(6)
    v_mfma_f32_32x32x16_bf16 a[0:15], a[20:23], a[32:35], a[0:15]
    s_waitcnt lgkmcnt(10)
    v_mfma_f32_32x32x16_bf16 v[12:27], v[108:111], v[84:87], v[12:27]
    ds_read_b64_tr_b16 v[132:133], v210 offset:12288
    ds_read_b64_tr_b16 v[134:135], v210 offset:13312
    ds_read_b64_tr_b16 a[24:25], v214 offset:8192
    ds_read_b64_tr_b16 a[26:27], v214 offset:9216
    v_lshlrev_b32 v1, 16, v84
    v_and_b32 v2, 0xffff0000, v84
    v_fmac_f32 v228, v1, v1
    v_fmac_f32 v229, v2, v2
    v_mfma_f32_32x32x16_bf16 v[28:43], v[112:115], v[84:87], v[28:43]
    ds_read_b64_tr_b16 v[136:137], v212 offset:12288
    ds_read_b64_tr_b16 v[138:139], v212 offset:13312
    v_lshlrev_b32 v3, 16, v85
    v_and_b32 v4, 0xffff0000, v85
    v_fmac_f32 v228, v3, v3
    v_fmac_f32 v229, v4, v4
    s_waitcnt lgkmcnt(10)
    v_mfma_f32_32x32x16_bf16 v[44:59], v[116:119], v[84:87], v[44:59]
    ds_read_b64_tr_b16 v[108:109], v206 offset:16384
    ds_read_b64_tr_b16 v[110:111], v206 offset:17408
    v_lshlrev_b32 v1, 16, v86
    v_and_b32 v2, 0xffff0000, v86
    v_fmac_f32 v228, v1, v1
    v_fmac_f32 v229, v2, v2
    v_mfma_f32_32x32x16_bf16 v[60:75], v[120:123], v[84:87], v[60:75]
    ds_read_b64_tr_b16 v[112:113], v208 offset:16384
    ds_read_b64_tr_b16 v[114:115], v208 offset:17408
    v_lshlrev_b32 v3, 16, v87
    v_and_b32 v4, 0xffff0000, v87
    v_fmac_f32 v228, v3, v3
    v_fmac_f32 v229, v4, v4
    s_waitcnt lgkmcnt(6)
    v_mfma_f32_32x32x16_bf16 a[0:15], a[24:27], a[32:35], a[0:15]
    s_waitcnt lgkmcnt(10)
    v_mfma_f32_32x32x16_bf16 v[12:27], v[124:127], v[88:91], v[12:27]
    ds_read_b64_tr_b16 v[116:117], v210 offset:16384
    ds_read_b64_tr_b16 v[118:119], v210 offset:17408
    ds_read_b64_tr_b16 a[28:29], v214 offset:12288
    ds_read_b64_tr_b16 a[30:31], v214 offset:13312
    v_lshlrev_b32 v1, 16, v88
    v_and_b32 v2, 0xffff0000, v88
    v_fmac_f32 v228, v1, v1
    v_fmac_f32 v229, v2, v2
    v_mfma_f32_32x32x16_bf16 v[28:43], v[128:131], v[88:91], v[28:43]
    ds_read_b64_tr_b16 v[120:121], v212 offset:16384
    ds_read_b64_tr_b16 v[122:123], v212 offset:17408
    v_lshlrev_b32 v3, 16, v89
    v_and_b32 v4, 0xffff0000, v89
    v_fmac_f32 v228, v3, v3
    v_fmac_f32 v229, v4, v4
    s_waitcnt lgkmcnt(10)
    v_mfma_f32_32x32x16_bf16 v[44:59], v[132:135], v[88:91], v[44:59]
    ds_read_b64_tr_b16 v[124:125], v206 offset:20480
    ds_read_b64_tr_b16 v[126:127], v206 offset:21504
    v_lshlrev_b32 v1, 16, v90
    v_and_b32 v2, 0xffff0000, v90
    v_fmac_f32 v228, v1, v1
    v_fmac_f32 v229, v2, v2
    v_mfma_f32_32x32x16_bf16 v[60:75], v[136:139], v[88:91], v[60:75]
    ds_read_b64_tr_b16 v[128:129], v208 offset:20480
    ds_read_b64_tr_b16 v[130:131], v208 offset:21504
    v_lshlrev_b32 v3, 16, v91
    v_and_b32 v4, 0xffff0000, v91
    v_fmac_f32 v228, v3, v3
    v_fmac_f32 v229, v4, v4
    s_waitcnt lgkmcnt(6)
    v_mfma_f32_32x32x16_bf16 a[0:15], a[28:31], a[32:35], a[0:15]
    s_waitcnt vmcnt(4)
    s_barrier
    s_waitcnt lgkmcnt(10)
    v_mfma_f32_32x32x16_bf16 v[12:27], v[108:111], v[92:95], v[12:27]
    ds_read_b64_tr_b16 v[132:133], v210 offset:20480
    ds_read_b64_tr_b16 v[134:135], v210 offset:21504
    ds_read_b64_tr_b16 a[16:17], v214 offset:16384
    ds_read_b64_tr_b16 a[18:19], v214 offset:17408
    v_lshlrev_b32 v1, 16, v92
    v_and_b32 v2, 0xffff0000, v92
    v_fmac_f32 v228, v1, v1
    v_fmac_f32 v229, v2, v2
    v_mfma_f32_32x32x16_bf16 v[28:43], v[112:115], v[92:95], v[28:43]
    ds_read_b64_tr_b16 v[136:137], v212 offset:20480
    ds_read_b64_tr_b16 v[138:139], v212 offset:21504
    v_lshlrev_b32 v3, 16, v93
    v_and_b32 v4, 0xffff0000, v93
    v_fmac_f32 v228, v3, v3
    v_fmac_f32 v229, v4, v4
    s_waitcnt vmcnt(0)
    ds_read_b128 v[76:79], v224 offset:8192
    ds_read_b128 v[80:83], v225 offset:8192
    ds_read_b128 v[84:87], v226 offset:8192
    ds_read_b128 v[88:91], v227 offset:8192
    s_waitcnt lgkmcnt(14)
    v_mfma_f32_32x32x16_bf16 v[44:59], v[116:119], v[92:95], v[44:59]
    ds_read_b64_tr_b16 v[108:109], v206 offset:24576
    ds_read_b64_tr_b16 v[110:111], v206 offset:25600
    v_lshlrev_b32 v1, 16, v94
    v_and_b32 v2, 0xffff0000, v94
    v_fmac_f32 v228, v1, v1
    v_fmac_f32 v229, v2, v2
    v_mfma_f32_32x32x16_bf16 v[60:75], v[120:123], v[92:95], v[60:75]
    ds_read_b64_tr_b16 v[112:113], v208 offset:24576
    ds_read_b64_tr_b16 v[114:115], v208 offset:25600
    v_lshlrev_b32 v3, 16, v95
    v_and_b32 v4, 0xffff0000, v95
    v_fmac_f32 v228, v3, v3
    v_fmac_f32 v229, v4, v4
    s_waitcnt lgkmcnt(10)
    v_mfma_f32_32x32x16_bf16 a[0:15], a[16:19], a[32:35], a[0:15]
    s_waitcnt lgkmcnt(14)
    v_mfma_f32_32x32x16_bf16 v[12:27], v[124:127], v[96:99], v[12:27]
    ds_read_b64_tr_b16 v[116:117], v210 offset:24576
    ds_read_b64_tr_b16 v[118:119], v210 offset:25600
    ds_read_b64_tr_b16 a[20:21], v214 offset:20480
    ds_read_b64_tr_b16 a[22:23], v214 offset:21504
    v_lshlrev_b32 v1, 16, v96
    v_and_b32 v2, 0xffff0000, v96
    v_fmac_f32 v228, v1, v1
    v_fmac_f32 v229, v2, v2
    v_mfma_f32_32x32x16_bf16 v[28:43], v[128:131], v[96:99], v[28:43]
    ds_read_b64_tr_b16 v[120:121], v212 offset:24576
    ds_read_b64_tr_b16 v[122:123], v212 offset:25600
    v_lshlrev_b32 v3, 16, v97
    v_and_b32 v4, 0xffff0000, v97
    v_fmac_f32 v228, v3, v3
    v_fmac_f32 v229, v4, v4
    s_waitcnt lgkmcnt(14)
    v_mfma_f32_32x32x16_bf16 v[44:59], v[132:135], v[96:99], v[44:59]
    ds_read_b64_tr_b16 v[124:125], v206 offset:28672
    ds_read_b64_tr_b16 v[126:127], v206 offset:29696
    v_lshlrev_b32 v1, 16, v98
    v_and_b32 v2, 0xffff0000, v98
    v_fmac_f32 v228, v1, v1
    v_fmac_f32 v229, v2, v2
    v_mfma_f32_32x32x16_bf16 v[60:75], v[136:139], v[96:99], v[60:75]
    ds_read_b64_tr_b16 v[128:129], v208 offset:28672
    ds_read_b64_tr_b16 v[130:131], v208 offset:29696
    v_lshlrev_b32 v3, 16, v99
    v_and_b32 v4, 0xffff0000, v99
    v_fmac_f32 v228, v3, v3
    v_fmac_f32 v229, v4, v4
    s_waitcnt lgkmcnt(6)
    v_mfma_f32_32x32x16_bf16 a[0:15], a[20:23], a[32:35], a[0:15]
    s_waitcnt lgkmcnt(10)
    v_mfma_f32_32x32x16_bf16 v[12:27], v[108:111], v[100:103], v[12:27]
    ds_read_b64_tr_b16 v[132:133], v210 offset:28672
    ds_read_b64_tr_b16 v[134:135], v210 offset:29696
    ds_read_b64_tr_b16 a[24:25], v214 offset:24576
    ds_read_b64_tr_b16 a[26:27], v214 offset:25600
    v_lshlrev_b32 v1, 16, v100
    v_and_b32 v2, 0xffff0000, v100
    v_fmac_f32 v228, v1, v1
    v_fmac_f32 v229, v2, v2
    v_mfma_f32_32x32x16_bf16 v[28:43], v[112:115], v[100:103], v[28:43]
    ds_read_b64_tr_b16 v[136:137], v212 offset:28672
    ds_read_b64_tr_b16 v[138:139], v212 offset:29696
    v_lshlrev_b32 v3, 16, v101
    v_and_b32 v4, 0xffff0000, v101
    v_fmac_f32 v228, v3, v3
    v_fmac_f32 v229, v4, v4
    s_waitcnt lgkmcnt(10)
    v_mfma_f32_32x32x16_bf16 v[44:59], v[116:119], v[100:103], v[44:59]
    ds_read_b64_tr_b16 v[108:109], v206 offset:32768
    ds_read_b64_tr_b16 v[110:111], v206 offset:33792
    v_lshlrev_b32 v1, 16, v102
    v_and_b32 v2, 0xffff0000, v102
    v_fmac_f32 v228, v1, v1
    v_fmac_f32 v229, v2, v2
    v_mfma_f32_32x32x16_bf16 v[60:75], v[120:123], v[100:103], v[60:75]
    ds_read_b64_tr_b16 v[112:113], v208 offset:32768
    ds_read_b64_tr_b16 v[114:115], v208 offset:33792
    v_lshlrev_b32 v3, 16, v103
    v_and_b32 v4, 0xffff0000, v103
    v_fmac_f32 v228, v3, v3
    v_fmac_f32 v229, v4, v4
    s_waitcnt lgkmcnt(6)
    v_mfma_f32_32x32x16_bf16 a[0:15], a[24:27], a[32:35], a[0:15]
    s_waitcnt lgkmcnt(10)
    v_mfma_f32_32x32x16_bf16 v[12:27], v[124:127], v[104:107], v[12:27]
    ds_read_b64_tr_b16 v[116:117], v210 offset:32768
    ds_read_b64_tr_b16 v[118:119], v210 offset:33792
    ds_read_b64_tr_b16 a[28:29], v214 offset:28672
    ds_read_b64_tr_b16 a[30:31], v214 offset:29696
    v_lshlrev_b32 v1, 16, v104
    v_and_b32 v2, 0xffff0000, v104
    v_fmac_f32 v228, v1, v1
    v_fmac_f32 v229, v2, v2
    s_lshr_b32 s59, s2, 3
    s_lshl_b32 s59, s59, 2
    s_add_u32 s59, s59, s28
    s_mul_i32 s59, s59, 18
    v_min_u32 v5, 17, v0
    v_add_u32 v5, s59, v5
    v_lshrrev_b32 v6, 2, v5
    v_mul_u32_u24 v6, 9216, v6
    v_bfe_u32 v7, v5, 1, 1
    v_and_b32 v5, 1, v5
    v_mad_u32_u24 v5, v7, 5, v5
    v_lshlrev_b32 v5, 7, v5
    s_and_b32 s59, s2, 3
    s_lshl_b32 s59, s59, 1
    s_bfe_u32 s60, s2, 0x10002
    s_add_u32 s59, s59, s60
    s_mul_i32 s60, s59, 1152
    v_add3_u32 v6, v6, v5, s60
    global_load_dword a40, v6, s[44:45]
    global_load_dword a41, v6, s[46:47]
    v_mfma_f32_32x32x16_bf16 v[28:43], v[128:131], v[104:107], v[28:43]
    ds_read_b64_tr_b16 v[120:121], v212 offset:32768
    ds_read_b64_tr_b16 v[122:123], v212 offset:33792
    v_lshlrev_b32 v3, 16, v105
    v_and_b32 v4, 0xffff0000, v105
    v_fmac_f32 v228, v3, v3
    v_fmac_f32 v229, v4, v4
    s_waitcnt lgkmcnt(10)
    v_mfma_f32_32x32x16_bf16 v[44:59], v[132:135], v[104:107], v[44:59]
    ds_read_b64_tr_b16 v[124:125], v206 offset:36864
    ds_read_b64_tr_b16 v[126:127], v206 offset:37888
    v_lshlrev_b32 v1, 16, v106
    v_and_b32 v2, 0xffff0000, v106
    v_fmac_f32 v228, v1, v1
    v_fmac_f32 v229, v2, v2
    v_mfma_f32_32x32x16_bf16 v[60:75], v[136:139], v[104:107], v[60:75]
    ds_read_b64_tr_b16 v[128:129], v208 offset:36864
    ds_read_b64_tr_b16 v[130:131], v208 offset:37888
    v_lshlrev_b32 v3, 16, v107
    v_and_b32 v4, 0xffff0000, v107
    v_fmac_f32 v228, v3, v3
    v_fmac_f32 v229, v4, v4
    s_waitcnt lgkmcnt(6)
    v_mfma_f32_32x32x16_bf16 a[0:15], a[28:31], a[32:35], a[0:15]
    s_waitcnt lgkmcnt(10)
    v_mfma_f32_32x32x16_bf16 v[12:27], v[108:111], v[76:79], v[12:27]
    ds_read_b64_tr_b16 v[132:133], v210 offset:36864
    ds_read_b64_tr_b16 v[134:135], v210 offset:37888
    ds_read_b64_tr_b16 a[16:17], v214 offset:32768
    ds_read_b64_tr_b16 a[18:19], v214 offset:33792
    v_lshlrev_b32 v1, 16, v76
    v_and_b32 v2, 0xffff0000, v76
    v_fmac_f32 v228, v1, v1
    v_fmac_f32 v229, v2, v2
    v_mfma_f32_32x32x16_bf16 v[28:43], v[112:115], v[76:79], v[28:43]
    ds_read_b64_tr_b16 v[136:137], v212 offset:36864
    ds_read_b64_tr_b16 v[138:139], v212 offset:37888
    v_lshlrev_b32 v3, 16, v77
    v_and_b32 v4, 0xffff0000, v77
    v_fmac_f32 v228, v3, v3
    v_fmac_f32 v229, v4, v4
    s_waitcnt lgkmcnt(10)
    v_mfma_f32_32x32x16_bf16 v[44:59], v[116:119], v[76:79], v[44:59]
    ds_read_b64_tr_b16 v[108:109], v206 offset:40960
    ds_read_b64_tr_b16 v[110:111], v206 offset:41984
    v_lshlrev_b32 v1, 16, v78
    v_and_b32 v2, 0xffff0000, v78
    v_fmac_f32 v228, v1, v1
    v_fmac_f32 v229, v2, v2
    v_mfma_f32_32x32x16_bf16 v[60:75], v[120:123], v[76:79], v[60:75]
    ds_read_b64_tr_b16 v[112:113], v208 offset:40960
    ds_read_b64_tr_b16 v[114:115], v208 offset:41984
    v_lshlrev_b32 v3, 16, v79
    v_and_b32 v4, 0xffff0000, v79
    v_fmac_f32 v228, v3, v3
    v_fmac_f32 v229, v4, v4
    s_waitcnt lgkmcnt(6)
    v_mfma_f32_32x32x16_bf16 a[0:15], a[16:19], a[32:35], a[0:15]
    s_waitcnt lgkmcnt(10)
    v_mfma_f32_32x32x16_bf16 v[12:27], v[124:127], v[80:83], v[12:27]
    ds_read_b64_tr_b16 v[116:117], v210 offset:40960
    ds_read_b64_tr_b16 v[118:119], v210 offset:41984
    ds_read_b64_tr_b16 a[20:21], v214 offset:36864
    ds_read_b64_tr_b16 a[22:23], v214 offset:37888
    v_lshlrev_b32 v1, 16, v80
    v_and_b32 v2, 0xffff0000, v80
    v_fmac_f32 v228, v1, v1
    v_fmac_f32 v229, v2, v2
    v_mfma_f32_32x32x16_bf16 v[28:43], v[128:131], v[80:83], v[28:43]
    ds_read_b64_tr_b16 v[120:121], v212 offset:40960
    ds_read_b64_tr_b16 v[122:123], v212 offset:41984
    v_lshlrev_b32 v3, 16, v81
    v_and_b32 v4, 0xffff0000, v81
    v_fmac_f32 v228, v3, v3
    v_fmac_f32 v229, v4, v4
    s_waitcnt lgkmcnt(10)
    v_mfma_f32_32x32x16_bf16 v[44:59], v[132:135], v[80:83], v[44:59]
    ds_read_b64_tr_b16 v[124:125], v206 offset:45056
    ds_read_b64_tr_b16 v[126:127], v206 offset:46080
    v_lshlrev_b32 v1, 16, v82
    v_and_b32 v2, 0xffff0000, v82
    v_fmac_f32 v228, v1, v1
    v_fmac_f32 v229, v2, v2
    v_lshlrev_b32 v233, 5, v233
    s_mov_b32 s61, 5046272
    buffer_load_dword v234, v233, s[20:23], s61 offen sc1
    s_bfe_u32 s58, s2, 0x20003
    s_mul_i32 s54, s58, 5
    s_cmp_eq_u32 s58, 3
    s_cselect_b32 s54, 14, s54
    s_mul_i32 s54, s54, 36864
    s_mul_i32 s55, s28, 9216
    s_add_u32 s55, s55, 5062656
    s_add_u32 s54, s54, s55
    s_cmp_lt_u32 s58, 2
    s_cselect_b32 s48, s54, 1073741824
    v_and_b32 v216, 5, v231
    v_lshl_add_u32 v216, v230, 5, v216
    v_lshlrev_b32 v216, 4, v216
    v_mfma_f32_32x32x16_bf16 v[60:75], v[136:139], v[80:83], v[60:75]
    ds_read_b64_tr_b16 v[128:129], v208 offset:45056
    ds_read_b64_tr_b16 v[130:131], v208 offset:46080
    v_lshlrev_b32 v3, 16, v83
    v_and_b32 v4, 0xffff0000, v83
    v_fmac_f32 v228, v3, v3
    v_fmac_f32 v229, v4, v4
    s_waitcnt lgkmcnt(6)
    v_mfma_f32_32x32x16_bf16 a[0:15], a[20:23], a[32:35], a[0:15]
    s_waitcnt lgkmcnt(10)
    v_mfma_f32_32x32x16_bf16 v[12:27], v[108:111], v[84:87], v[12:27]
    ds_read_b64_tr_b16 v[132:133], v210 offset:45056
    ds_read_b64_tr_b16 v[134:135], v210 offset:46080
    ds_read_b64_tr_b16 a[24:25], v214 offset:40960
    ds_read_b64_tr_b16 a[26:27], v214 offset:41984
    v_lshlrev_b32 v1, 16, v84
    v_and_b32 v2, 0xffff0000, v84
    v_fmac_f32 v228, v1, v1
    v_fmac_f32 v229, v2, v2
    v_mfma_f32_32x32x16_bf16 v[28:43], v[112:115], v[84:87], v[28:43]
    ds_read_b64_tr_b16 v[136:137], v212 offset:45056
    ds_read_b64_tr_b16 v[138:139], v212 offset:46080
    v_lshlrev_b32 v3, 16, v85
    v_and_b32 v4, 0xffff0000, v85
    v_fmac_f32 v228, v3, v3
    v_fmac_f32 v229, v4, v4
    s_waitcnt lgkmcnt(10)
    v_mfma_f32_32x32x16_bf16 v[44:59], v[116:119], v[84:87], v[44:59]
    v_lshlrev_b32 v1, 16, v86
    v_and_b32 v2, 0xffff0000, v86
    v_fmac_f32 v228, v1, v1
    v_fmac_f32 v229, v2, v2
    v_mfma_f32_32x32x16_bf16 v[60:75], v[120:123], v[84:87], v[60:75]
    v_lshlrev_b32 v3, 16, v87
    v_and_b32 v4, 0xffff0000, v87
    v_fmac_f32 v228, v3, v3
    v_fmac_f32 v229, v4, v4
    s_waitcnt lgkmcnt(2)
    v_mfma_f32_32x32x16_bf16 a[0:15], a[24:27], a[32:35], a[0:15]
    s_waitcnt lgkmcnt(6)
    v_mfma_f32_32x32x16_bf16 v[12:27], v[124:127], v[88:91], v[12:27]
    ds_read_b64_tr_b16 a[28:29], v214 offset:45056
    ds_read_b64_tr_b16 a[30:31], v214 offset:46080
    v_lshlrev_b32 v1, 16, v88
    v_and_b32 v2, 0xffff0000, v88
    v_fmac_f32 v228, v1, v1
    v_fmac_f32 v229, v2, v2
    v_mfma_f32_32x32x16_bf16 v[28:43], v[128:131], v[88:91], v[28:43]
    v_lshlrev_b32 v3, 16, v89
    v_and_b32 v4, 0xffff0000, v89
    v_fmac_f32 v228, v3, v3
    v_fmac_f32 v229, v4, v4
    s_waitcnt lgkmcnt(2)
    v_mfma_f32_32x32x16_bf16 v[44:59], v[132:135], v[88:91], v[44:59]
    v_lshlrev_b32 v1, 16, v90
    v_and_b32 v2, 0xffff0000, v90
    v_fmac_f32 v228, v1, v1
    v_fmac_f32 v229, v2, v2
    v_mfma_f32_32x32x16_bf16 v[60:75], v[136:139], v[88:91], v[60:75]
    v_lshlrev_b32 v3, 16, v91
    v_and_b32 v4, 0xffff0000, v91
    v_fmac_f32 v228, v3, v3
    v_fmac_f32 v229, v4, v4
    s_waitcnt lgkmcnt(0)
    v_mfma_f32_32x32x16_bf16 a[0:15], a[28:31], a[32:35], a[0:15]
    v_add_f32 v228, v228, v229
    v_mov_b32 v229, v228
    v_lshlrev_b32 v4, 4, v230
    v_add_u32 v4, 153600, v4
    v_permlane32_swap_b32 v228, v229
    v_add_u32 v5, 147456, v232
    s_lshl_b32 s32, s28, 7
    v_add_u32 v6, s32, v4
    ds_read_b128 v[164:167], v5 offset:0
    ds_read_b128 v[168:171], v5 offset:1024
    ds_read_b128 v[172:175], v5 offset:2048
    ds_read_b128 v[176:179], v5 offset:3072
    ds_read_b128 v[180:183], v5 offset:4096
    ds_read_b128 v[184:187], v5 offset:5120
    s_mov_b32 s56, 1
    s_mov_b32 s57, 1
    s_mov_b64 exec, s[56:57]
    ds_write_b128 v6, a[0:3] offset:0
    ds_write_b128 v6, a[4:7] offset:32
    ds_write_b128 v6, a[8:11] offset:64
    ds_write_b128 v6, a[12:15] offset:96
    s_mov_b64 exec, -1
    v_add_f32 v228, v228, v229
    v_mul_f32 v1, -0.001736111111111111, v72
    v_mul_f32 v2, 0.001736111111111111, v228
    v_fma_f32 v2, -v1, v1, v2
    v_max_f32 v2, 0, v2
    v_add_f32 v2, 1e-5, v2
    v_rsq_f32 v2, v2
    s_waitcnt lgkmcnt(0)
    v_mul_f32 v3, 1.4426950408889634, v2
    s_barrier
    s_waitcnt vmcnt(0)
    s_mov_b32 s33, 0x40000
L_p1_wq:
    v_cmp_gt_u32 vcc, 16, v234
    s_sub_u32 s33, s33, 1
    s_cbranch_scc1 L_p1_wqd
    s_cmp_eq_u64 vcc, 0
    s_cbranch_scc1 L_p1_wqd
    buffer_load_dword v234, v233, s[20:23], s61 offen sc1
    s_waitcnt vmcnt(0)
    s_branch L_p1_wq
L_p1_wqd:
    ds_read_b128 v[92:95], v4 offset:128
    ds_read_b128 v[96:99], v4 offset:160
    ds_read_b128 v[100:103], v4 offset:192
    ds_read_b128 v[104:107], v4 offset:224
    ds_read_b128 v[124:127], v4 offset:384
    ds_read_b128 v[128:131], v4 offset:416
    ds_read_b128 v[132:135], v4 offset:448
    s_add_u32 s49, s55, 663552
    buffer_load_dwordx4 a[72:75], v216, s[20:23], s49 offen sc1
    ds_read_b128 v[76:79], v4 offset:0
    ds_read_b128 v[80:83], v4 offset:32
    ds_read_b128 v[84:87], v4 offset:64
    ds_read_b128 v[88:91], v4 offset:96
    ds_read_b128 v[108:111], v4 offset:256
    ds_read_b128 v[112:115], v4 offset:288
    ds_read_b128 v[116:119], v4 offset:320
    s_add_u32 s49, s55, 663552
    buffer_load_dwordx4 a[76:79], v216, s[20:23], s49 offen offset:1024 sc1
    ds_read_b128 v[120:123], v4 offset:352
    s_waitcnt lgkmcnt(11)
    v_fmac_f32 v28, v92, v1
    v_fmac_f32 v29, v93, v1
    v_fmac_f32 v30, v94, v1
    v_fmac_f32 v31, v95, v1
    v_fmac_f32 v32, v96, v1
    s_add_u32 s49, s55, 663552
    buffer_load_dwordx4 a[80:83], v216, s[20:23], s49 offen offset:2048 sc1
    v_fmac_f32 v33, v97, v1
    v_fmac_f32 v34, v98, v1
    v_fmac_f32 v35, v99, v1
    v_fmac_f32 v36, v100, v1
    v_fmac_f32 v37, v101, v1
    v_fmac_f32 v38, v102, v1
    v_fmac_f32 v39, v103, v1
    s_add_u32 s49, s55, 663552
    buffer_load_dwordx4 a[84:87], v216, s[20:23], s49 offen offset:3072 sc1
    v_fmac_f32 v40, v104, v1
    v_fmac_f32 v41, v105, v1
    v_fmac_f32 v42, v106, v1
    v_fmac_f32 v43, v107, v1
    v_cvt_pk_bf16_f32 v148, v28, v29
    v_cvt_pk_bf16_f32 v149, v30, v31
    v_cvt_pk_bf16_f32 v150, v32, v33
    s_add_u32 s49, s55, 667648
    buffer_load_dwordx4 a[88:91], v216, s[20:23], s49 offen sc1
    v_cvt_pk_bf16_f32 v151, v34, v35
    v_cvt_pk_bf16_f32 v152, v36, v37
    v_cvt_pk_bf16_f32 v153, v38, v39
    v_cvt_pk_bf16_f32 v154, v40, v41
    v_cvt_pk_bf16_f32 v155, v42, v43
    s_waitcnt lgkmcnt(8)
    v_fmac_f32 v60, v124, v1
    s_add_u32 s49, s55, 667648
    buffer_load_dwordx4 a[92:95], v216, s[20:23], s49 offen offset:1024 sc1
    v_fmac_f32 v61, v125, v1
    v_fmac_f32 v62, v126, v1
    v_fmac_f32 v63, v127, v1
    v_fmac_f32 v64, v128, v1
    v_fmac_f32 v65, v129, v1
    v_fmac_f32 v66, v130, v1
    v_fmac_f32 v67, v131, v1
    s_add_u32 s49, s55, 667648
    buffer_load_dwordx4 a[96:99], v216, s[20:23], s49 offen offset:2048 sc1
    v_fmac_f32 v68, v132, v1
    v_fmac_f32 v69, v133, v1
    v_fmac_f32 v70, v134, v1
    v_fmac_f32 v71, v135, v1
    v_cvt_pk_bf16_f32 v156, v60, v61
    v_cvt_pk_bf16_f32 v157, v62, v63
    v_cvt_pk_bf16_f32 v158, v64, v65
    s_add_u32 s49, s55, 667648
    buffer_load_dwordx4 a[100:103], v216, s[20:23], s49 offen offset:3072 sc1
    v_cvt_pk_bf16_f32 v159, v66, v67
    v_cvt_pk_bf16_f32 v160, v68, v69
    v_cvt_pk_bf16_f32 v161, v70, v71
    s_waitcnt lgkmcnt(4)
    v_fmac_f32 v12, v76, v1
    v_fmac_f32 v13, v77, v1
    v_fmac_f32 v14, v78, v1
    s_add_u32 s49, s55, 671744
    buffer_load_dwordx4 a[104:107], v216, s[20:23], s49 offen sc1
    v_fmac_f32 v15, v79, v1
    v_fmac_f32 v16, v80, v1
    v_fmac_f32 v17, v81, v1
    v_fmac_f32 v18, v82, v1
    v_fmac_f32 v19, v83, v1
    v_fmac_f32 v20, v84, v1
    v_fmac_f32 v21, v85, v1
    s_add_u32 s49, s48, 147456
    buffer_load_dwordx4 a[108:111], v232, s[20:23], s49 offen sc1
    v_fmac_f32 v22, v86, v1
    v_fmac_f32 v23, v87, v1
    v_fmac_f32 v24, v88, v1
    v_fmac_f32 v25, v89, v1
    v_fmac_f32 v26, v90, v1
    v_fmac_f32 v27, v91, v1
    v_cvt_pk_bf16_f32 v140, v12, v13
    s_add_u32 s49, s48, 147456
    buffer_load_dwordx4 a[112:115], v232, s[20:23], s49 offen offset:1024 sc1
    v_cvt_pk_bf16_f32 v141, v14, v15
    v_cvt_pk_bf16_f32 v142, v16, v17
    v_cvt_pk_bf16_f32 v143, v18, v19
    v_cvt_pk_bf16_f32 v144, v20, v21
    v_cvt_pk_bf16_f32 v145, v22, v23
    v_cvt_pk_bf16_f32 v146, v24, v25
    v_cvt_pk_bf16_f32 v147, v26, v27
    s_add_u32 s49, s48, 147456
    buffer_load_dwordx4 a[116:119], v232, s[20:23], s49 offen offset:2048 sc1
    s_waitcnt lgkmcnt(0)
    v_fmac_f32 v44, v108, v1
    v_fmac_f32 v45, v109, v1
    v_fmac_f32 v46, v110, v1
    v_fmac_f32 v47, v111, v1
    v_fmac_f32 v48, v112, v1
    v_fmac_f32 v49, v113, v1
    s_add_u32 s49, s48, 147456
    buffer_load_dwordx4 a[120:123], v232, s[20:23], s49 offen offset:3072 sc1
    v_fmac_f32 v50, v114, v1
    v_fmac_f32 v51, v115, v1
    v_fmac_f32 v52, v116, v1
    v_fmac_f32 v53, v117, v1
    v_fmac_f32 v54, v118, v1
    v_fmac_f32 v55, v119, v1
    v_fmac_f32 v56, v120, v1
    s_add_u32 s49, s48, 151552
    buffer_load_dwordx4 a[124:127], v232, s[20:23], s49 offen sc1
    v_fmac_f32 v57, v121, v1
    v_fmac_f32 v58, v122, v1
    v_fmac_f32 v59, v123, v1
    v_mfma_f32_32x32x16_bf16 v[76:91], v[164:167], v[148:151], 0
    v_mfma_f32_32x32x16_bf16 v[76:91], v[168:171], v[152:155], v[76:91]
    v_mfma_f32_32x32x16_bf16 v[76:91], v[172:175], v[158:161], v[76:91]
    v_mul_f32 v44, v2, v44
    s_add_u32 s49, s48, 151552
    buffer_load_dwordx4 a[128:131], v232, s[20:23], s49 offen offset:1024 sc1
    v_mul_f32 v45, v2, v45
    v_mul_f32 v46, v2, v46
    v_mul_f32 v47, v2, v47
    v_mul_f32 v48, v2, v48
    v_mul_f32 v49, v2, v49
    v_mul_f32 v50, v2, v50
    v_mul_f32 v51, v2, v51
    s_add_u32 s49, s48, 151552
    buffer_load_dwordx4 a[132:135], v232, s[20:23], s49 offen offset:2048 sc1
    v_mul_f32 v52, v2, v52
    v_mul_f32 v53, v2, v53
    v_mul_f32 v54, v2, v54
    v_mul_f32 v55, v2, v55
    v_mul_f32 v56, v2, v56
    v_mul_f32 v57, v2, v57
    v_mul_f32 v58, v2, v58
    s_add_u32 s49, s48, 151552
    buffer_load_dwordx4 a[136:139], v232, s[20:23], s49 offen offset:3072 sc1
    v_mul_f32 v59, v2, v59
    v_mfma_f32_32x32x16_bf16 v[92:107], v[176:179], v[148:151], 0
    v_mfma_f32_32x32x16_bf16 v[92:107], v[180:183], v[152:155], v[92:107]
    v_mfma_f32_32x32x16_bf16 v[92:107], v[184:187], v[158:161], v[92:107]
    v_mul_f32 v68, v2, v68
    v_mul_f32 v69, v2, v69
    v_mul_f32 v70, v2, v70
    s_add_u32 s49, s48, 155648
    buffer_load_dwordx4 a[140:143], v232, s[20:23], s49 offen sc1
    v_mul_f32 v71, v2, v71
    v_cndmask_b32 v44, v44, 1.0, s[40:41]
    v_cndmask_b32 v70, 1.0, v70, s[40:41]
    v_cvt_pk_bf16_f32 v12, v44, v45
    v_cvt_pk_bf16_f32 v13, v46, v47
    v_cvt_pk_bf16_f32 v14, v48, v49
    v_cvt_pk_bf16_f32 v15, v50, v51
    s_add_u32 s60, s28, 0
    s_and_b32 s60, s60, 3
    s_mul_i32 s60, s60, 9216
    s_mul_i32 s49, s28, 27648
    s_add_u32 s60, s60, s49
    s_add_u32 s60, s60, s54
    s_add_u32 s49, s60, 0
    buffer_load_dwordx4 a[144:147], v232, s[20:23], s49 offen sc1
    v_cvt_pk_bf16_f32 v16, v52, v53
    v_cvt_pk_bf16_f32 v17, v54, v55
    v_cvt_pk_bf16_f32 v18, v56, v57
    v_cvt_pk_bf16_f32 v19, v58, v59
    v_cvt_pk_bf16_f32 v20, v68, v69
    v_cvt_pk_bf16_f32 v21, v70, v71
    v_mfma_f32_32x32x16_bf16 v[108:123], v[164:167], v[140:143], 0
    s_add_u32 s49, s60, 0
    buffer_load_dwordx4 a[148:151], v232, s[20:23], s49 offen offset:1024 sc1
    v_mfma_f32_32x32x16_bf16 v[108:123], v[168:171], v[144:147], v[108:123]
    v_mfma_f32_32x32x16_bf16 v[108:123], v[172:175], v[156:159], v[108:123]
    s_lshl_b32 s32, s28, 5
    v_add_u32 v4, s32, v231
    v_mul_u32_u24 v4, 320, v4
    v_mad_u32_u24 v5, v230, 40, v4
    v_mov_b32 v6, 72
    s_add_u32 s49, s60, 0
    buffer_load_dwordx4 a[152:155], v232, s[20:23], s49 offen offset:2048 sc1
    v_mad_u32_u24 v4, v230, v6, v4
    ds_write_b64 v5, v[12:13] offset:144
    ds_write_b64 v5, v[14:15] offset:152
    ds_write_b64 v5, v[16:17] offset:160
    ds_write_b64 v5, v[18:19] offset:168
    ds_write_b64 v5, v[20:21] offset:176
    v_mfma_f32_32x32x16_bf16 v[124:139], v[176:179], v[140:143], 0
    s_add_u32 s49, s60, 0
    buffer_load_dwordx4 a[156:159], v232, s[20:23], s49 offen offset:3072 sc1
    v_mfma_f32_32x32x16_bf16 v[124:139], v[180:183], v[144:147], v[124:139]
    v_mfma_f32_32x32x16_bf16 v[124:139], v[184:187], v[156:159], v[124:139]
    v_max3_f32 v6, v76, v77, v78
    v_min3_f32 v7, v76, v77, v78
    v_max3_f32 v6, v6, v79, v80
    v_min3_f32 v7, v7, v79, v80
    v_max3_f32 v6, v6, v81, v82
    s_add_u32 s49, s60, 4096
    buffer_load_dwordx4 a[160:163], v232, s[20:23], s49 offen sc1
    v_min3_f32 v7, v7, v81, v82
    v_max3_f32 v6, v6, v83, v84
    v_min3_f32 v7, v7, v83, v84
    v_max3_f32 v6, v6, v85, v86
    v_min3_f32 v7, v7, v85, v86
    v_max3_f32 v6, v6, v87, v88
    v_min3_f32 v7, v7, v87, v88
    s_add_u32 s49, s60, 4096
    buffer_load_dwordx4 a[164:167], v232, s[20:23], s49 offen offset:1024 sc1
    v_max3_f32 v6, v6, v89, v90
    v_min3_f32 v7, v7, v89, v90
    v_max3_f32 v6, v6, v91, v92
    v_min3_f32 v7, v7, v91, v92
    v_max_f32 v6, v6, v93
    v_min_f32 v7, v7, v93
    v_mul_f32 v6, v3, v6
    s_add_u32 s49, s60, 4096
    buffer_load_dwordx4 a[168:171], v232, s[20:23], s49 offen offset:2048 sc1
    v_mul_f32 v7, v3, v7
    v_fma_f32 v188, -v76, v3, v7
    v_fma_f32 v76, v76, v3, -v6
    v_fma_f32 v189, -v77, v3, v7
    v_fma_f32 v77, v77, v3, -v6
    v_fma_f32 v190, -v78, v3, v7
    v_fma_f32 v78, v78, v3, -v6
    s_add_u32 s49, s60, 4096
    buffer_load_dwordx4 a[172:175], v232, s[20:23], s49 offen offset:3072 sc1
    v_fma_f32 v191, -v79, v3, v7
    v_fma_f32 v79, v79, v3, -v6
    v_fma_f32 v192, -v80, v3, v7
    v_fma_f32 v80, v80, v3, -v6
    v_fma_f32 v193, -v81, v3, v7
    v_fma_f32 v81, v81, v3, -v6
    v_fma_f32 v194, -v82, v3, v7
    s_add_u32 s49, s60, 8192
    buffer_load_dwordx4 a[176:179], v232, s[20:23], s49 offen sc1
    v_fma_f32 v82, v82, v3, -v6
    v_fma_f32 v195, -v83, v3, v7
    v_fma_f32 v83, v83, v3, -v6
    v_fma_f32 v196, -v84, v3, v7
    v_fma_f32 v84, v84, v3, -v6
    v_fma_f32 v197, -v85, v3, v7
    v_fma_f32 v85, v85, v3, -v6
    s_add_u32 s60, s28, 1
    s_and_b32 s60, s60, 3
    s_mul_i32 s60, s60, 9216
    s_mul_i32 s49, s28, 27648
    s_add_u32 s60, s60, s49
    s_add_u32 s60, s60, s54
    s_add_u32 s49, s60, 0
    buffer_load_dwordx4 a[180:183], v232, s[20:23], s49 offen sc1
    v_fma_f32 v198, -v86, v3, v7
    v_fma_f32 v86, v86, v3, -v6
    v_fma_f32 v199, -v87, v3, v7
    v_fma_f32 v87, v87, v3, -v6
    v_fma_f32 v200, -v88, v3, v7
    v_fma_f32 v88, v88, v3, -v6
    v_fma_f32 v201, -v89, v3, v7
    s_add_u32 s49, s60, 0
    buffer_load_dwordx4 a[184:187], v232, s[20:23], s49 offen offset:1024 sc1
    v_fma_f32 v89, v89, v3, -v6
    v_fma_f32 v202, -v90, v3, v7
    v_fma_f32 v90, v90, v3, -v6
    v_fma_f32 v203, -v91, v3, v7
    v_fma_f32 v91, v91, v3, -v6
    v_fma_f32 v204, -v92, v3, v7
    v_fma_f32 v92, v92, v3, -v6
    s_add_u32 s49, s60, 0
    buffer_load_dwordx4 a[188:191], v232, s[20:23], s49 offen offset:2048 sc1
    v_fma_f32 v205, -v93, v3, v7
    v_fma_f32 v93, v93, v3, -v6
    v_exp_f32 v188, v188
    v_exp_f32 v76, v76
    v_exp_f32 v189, v189
    v_exp_f32 v77, v77
    v_exp_f32 v190, v190
    s_add_u32 s49, s60, 0
    buffer_load_dwordx4 a[192:195], v232, s[20:23], s49 offen offset:3072 sc1
    v_exp_f32 v78, v78
    v_exp_f32 v191, v191
    v_exp_f32 v79, v79
    v_exp_f32 v192, v192
    v_exp_f32 v80, v80
    v_exp_f32 v193, v193
    v_exp_f32 v81, v81
    s_add_u32 s49, s60, 4096
    buffer_load_dwordx4 a[196:199], v232, s[20:23], s49 offen sc1
    v_exp_f32 v194, v194
    v_exp_f32 v82, v82
    v_exp_f32 v195, v195
    v_exp_f32 v83, v83
    v_exp_f32 v196, v196
    v_exp_f32 v84, v84
    v_exp_f32 v197, v197
    s_add_u32 s49, s60, 4096
    buffer_load_dwordx4 a[200:203], v232, s[20:23], s49 offen offset:1024 sc1
    v_exp_f32 v85, v85
    v_exp_f32 v198, v198
    v_exp_f32 v86, v86
    v_exp_f32 v199, v199
    v_exp_f32 v87, v87
    v_exp_f32 v200, v200
    v_exp_f32 v88, v88
    s_add_u32 s49, s60, 4096
    buffer_load_dwordx4 a[204:207], v232, s[20:23], s49 offen offset:2048 sc1
    v_exp_f32 v201, v201
    v_exp_f32 v89, v89
    v_exp_f32 v202, v202
    v_exp_f32 v90, v90
    v_exp_f32 v203, v203
    v_exp_f32 v91, v91
    v_exp_f32 v204, v204
    s_add_u32 s49, s60, 4096
    buffer_load_dwordx4 a[208:211], v232, s[20:23], s49 offen offset:3072 sc1
    v_exp_f32 v92, v92
    v_exp_f32 v205, v205
    v_exp_f32 v93, v93
    v_add_f32 v8, v76, v77
    v_add_f32 v9, v188, v189
    v_add_f32 v8, v8, v78
    v_add_f32 v9, v9, v190
    s_add_u32 s49, s60, 8192
    buffer_load_dwordx4 a[212:215], v232, s[20:23], s49 offen sc1
    v_add_f32 v8, v8, v79
    v_add_f32 v9, v9, v191
    v_add_f32 v8, v8, v80
    v_add_f32 v9, v9, v192
    v_add_f32 v8, v8, v81
    v_add_f32 v9, v9, v193
    v_add_f32 v8, v8, v82
    s_add_u32 s60, s28, 2
    s_and_b32 s60, s60, 3
    s_mul_i32 s60, s60, 9216
    s_mul_i32 s49, s28, 27648
    s_add_u32 s60, s60, s49
    s_add_u32 s60, s60, s54
    s_add_u32 s49, s60, 0
    buffer_load_dwordx4 a[216:219], v232, s[20:23], s49 offen sc1
    v_add_f32 v9, v9, v194
    v_add_f32 v8, v8, v83
    v_add_f32 v9, v9, v195
    v_add_f32 v8, v8, v84
    v_add_f32 v9, v9, v196
    v_add_f32 v8, v8, v85
    v_add_f32 v9, v9, v197
    s_add_u32 s49, s60, 0
    buffer_load_dwordx4 a[220:223], v232, s[20:23], s49 offen offset:1024 sc1
    v_add_f32 v8, v8, v86
    v_add_f32 v9, v9, v198
    v_add_f32 v8, v8, v87
    v_add_f32 v9, v9, v199
    v_add_f32 v8, v8, v88
    v_add_f32 v9, v9, v200
    v_add_f32 v8, v8, v89
    s_add_u32 s49, s60, 0
    buffer_load_dwordx4 a[224:227], v232, s[20:23], s49 offen offset:2048 sc1
    v_add_f32 v9, v9, v201
    v_add_f32 v8, v8, v90
    v_add_f32 v9, v9, v202
    v_add_f32 v8, v8, v91
    v_add_f32 v9, v9, v203
    v_add_f32 v8, v8, v92
    v_add_f32 v9, v9, v204
    s_add_u32 s49, s60, 0
    buffer_load_dwordx4 a[228:231], v232, s[20:23], s49 offen offset:3072 sc1
    v_add_f32 v8, v8, v93
    v_add_f32 v9, v9, v205
    v_rcp_f32 v8, v8
    v_rcp_f32 v9, v9
    s_nop 0
    v_mul_f32 v76, v8, v76
    v_mul_f32 v188, v9, v188
    s_add_u32 s49, s60, 4096
    buffer_load_dwordx4 a[232:235], v232, s[20:23], s49 offen sc1
    v_mul_f32 v77, v8, v77
    v_mul_f32 v189, v9, v189
    v_mul_f32 v78, v8, v78
    v_mul_f32 v190, v9, v190
    v_mul_f32 v79, v8, v79
    v_mul_f32 v191, v9, v191
    v_mul_f32 v80, v8, v80
    s_add_u32 s49, s60, 4096
    buffer_load_dwordx4 a[236:239], v232, s[20:23], s49 offen offset:1024 sc1
    v_mul_f32 v192, v9, v192
    v_mul_f32 v81, v8, v81
    v_mul_f32 v193, v9, v193
    v_mul_f32 v82, v8, v82
    v_mul_f32 v194, v9, v194
    v_mul_f32 v83, v8, v83
    v_mul_f32 v195, v9, v195
    s_add_u32 s49, s60, 4096
    buffer_load_dwordx4 a[240:243], v232, s[20:23], s49 offen offset:2048 sc1
    v_mul_f32 v84, v8, v84
    v_mul_f32 v196, v9, v196
    v_mul_f32 v85, v8, v85
    v_mul_f32 v197, v9, v197
    v_mul_f32 v86, v8, v86
    v_mul_f32 v198, v9, v198
    v_mul_f32 v87, v8, v87
    s_add_u32 s49, s60, 4096
    buffer_load_dwordx4 a[244:247], v232, s[20:23], s49 offen offset:3072 sc1
    v_mul_f32 v199, v9, v199
    v_mul_f32 v88, v8, v88
    v_mul_f32 v200, v9, v200
    v_mul_f32 v89, v8, v89
    v_mul_f32 v201, v9, v201
    v_mul_f32 v90, v8, v90
    v_mul_f32 v202, v9, v202
    s_add_u32 s49, s60, 8192
    buffer_load_dwordx4 a[248:251], v232, s[20:23], s49 offen sc1
    v_mul_f32 v91, v8, v91
    v_mul_f32 v203, v9, v203
    v_mul_f32 v92, v8, v92
    v_mul_f32 v204, v9, v204
    v_mul_f32 v93, v8, v93
    v_mul_f32 v205, v9, v205
    v_cvt_pk_bf16_f32 v164, v76, v77
    s_add_u32 s60, s28, 3
    s_and_b32 s60, s60, 3
    s_mul_i32 s60, s60, 9216
    s_mul_i32 s49, s28, 27648
    s_add_u32 s60, s60, s49
    s_add_u32 s60, s60, s54
    s_add_u32 s49, s60, 0
    buffer_load_dwordx4 a[252:255], v232, s[20:23], s49 offen sc1
    v_cvt_pk_bf16_f32 v165, v78, v79
    v_cvt_pk_bf16_f32 v166, v80, v81
    v_cvt_pk_bf16_f32 v167, v82, v83
    v_cvt_pk_bf16_f32 v168, v84, v85
    v_cvt_pk_bf16_f32 v169, v86, v87
    v_cvt_pk_bf16_f32 v170, v88, v89
    v_cvt_pk_bf16_f32 v171, v90, v91
    v_cvt_pk_bf16_f32 v172, v92, v93
    v_cvt_pk_bf16_f32 v173, v188, v189
    v_cvt_pk_bf16_f32 v174, v190, v191
    v_cvt_pk_bf16_f32 v175, v192, v193
    v_cvt_pk_bf16_f32 v176, v194, v195
    v_cvt_pk_bf16_f32 v177, v196, v197
    v_cvt_pk_bf16_f32 v178, v198, v199
    v_cvt_pk_bf16_f32 v179, v200, v201
    v_cvt_pk_bf16_f32 v180, v202, v203
    v_cvt_pk_bf16_f32 v181, v204, v205
    ds_write_b64 v4, v[164:165] offset:0
    ds_write_b64 v4, v[166:167] offset:8
    ds_write_b64 v4, v[168:169] offset:16
    ds_write_b64 v4, v[170:171] offset:24
    ds_write_b64 v4, v[172:173] offset:32
    ds_write_b64 v4, v[174:175] offset:40
    ds_write_b64 v4, v[176:177] offset:48
    ds_write_b64 v4, v[178:179] offset:56
    ds_write_b64 v4, v[180:181] offset:64
    v_bfe_u32 v4, v0, 2, 2
    v_lshl_add_u32 v4, v230, 3, v4
    v_mul_u32_u24 v4, 320, v4
    v_bfe_u32 v5, v0, 4, 1
    v_lshl_add_u32 v4, v5, 5, v4
    v_and_b32 v5, 3, v0
    v_lshl_add_u32 v4, v5, 3, v4
    s_lshr_b32 s56, s28, 1
    s_and_b32 s57, s28, 1
    s_mul_i32 s35, s56, 40
    s_add_u32 s35, s35, 144
    v_add_u32 v5, s35, v4
    s_mul_i32 s35, s56, 72
    s_lshl_b32 s36, s57, 6
    s_add_u32 s35, s35, s36
    v_add_u32 v4, s35, v4
    s_waitcnt lgkmcnt(0)
    s_barrier
    ds_read_b64_tr_b16 v[12:13], v5 offset:0
    ds_read_b64_tr_b16 v[14:15], v5 offset:1280
    ds_read_b64_tr_b16 v[44:45], v4 offset:0
    ds_read_b64_tr_b16 v[46:47], v4 offset:1280
    ds_read_b64_tr_b16 v[16:17], v5 offset:5120
    ds_read_b64_tr_b16 v[18:19], v5 offset:6400
    ds_read_b64_tr_b16 v[48:49], v4 offset:5120
    ds_read_b64_tr_b16 v[50:51], v4 offset:6400
    ds_read_b64_tr_b16 v[20:21], v5 offset:10240
    ds_read_b64_tr_b16 v[22:23], v5 offset:11520
    ds_read_b64_tr_b16 v[52:53], v4 offset:10240
    ds_read_b64_tr_b16 v[54:55], v4 offset:11520
    s_waitcnt lgkmcnt(8)
    v_mfma_f32_32x32x16_bf16 v[76:91], v[12:15], v[44:47], 0
    ds_read_b64_tr_b16 v[24:25], v5 offset:15360
    ds_read_b64_tr_b16 v[26:27], v5 offset:16640
    ds_read_b64_tr_b16 v[56:57], v4 offset:15360
    ds_read_b64_tr_b16 v[58:59], v4 offset:16640
    s_waitcnt lgkmcnt(8)
    v_mfma_f32_32x32x16_bf16 v[76:91], v[16:19], v[48:51], v[76:91]
    ds_read_b64_tr_b16 v[28:29], v5 offset:20480
    ds_read_b64_tr_b16 v[30:31], v5 offset:21760
    ds_read_b64_tr_b16 v[60:61], v4 offset:20480
    ds_read_b64_tr_b16 v[62:63], v4 offset:21760
    s_waitcnt lgkmcnt(8)
    v_mfma_f32_32x32x16_bf16 v[76:91], v[20:23], v[52:55], v[76:91]
    ds_read_b64_tr_b16 v[32:33], v5 offset:25600
    ds_read_b64_tr_b16 v[34:35], v5 offset:26880
    ds_read_b64_tr_b16 v[64:65], v4 offset:25600
    ds_read_b64_tr_b16 v[66:67], v4 offset:26880
    s_waitcnt lgkmcnt(8)
    v_mfma_f32_32x32x16_bf16 v[76:91], v[24:27], v[56:59], v[76:91]
    ds_read_b64_tr_b16 v[36:37], v5 offset:30720
    ds_read_b64_tr_b16 v[38:39], v5 offset:32000
    ds_read_b64_tr_b16 v[68:69], v4 offset:30720
    ds_read_b64_tr_b16 v[70:71], v4 offset:32000
    s_waitcnt lgkmcnt(8)
    v_mfma_f32_32x32x16_bf16 v[76:91], v[28:31], v[60:63], v[76:91]
    ds_read_b64_tr_b16 v[40:41], v5 offset:35840
    ds_read_b64_tr_b16 v[42:43], v5 offset:37120
    ds_read_b64_tr_b16 v[72:73], v4 offset:35840
    ds_read_b64_tr_b16 v[74:75], v4 offset:37120
    s_waitcnt lgkmcnt(8)
    v_mfma_f32_32x32x16_bf16 v[76:91], v[32:35], v[64:67], v[76:91]
    s_waitcnt lgkmcnt(4)
    v_mfma_f32_32x32x16_bf16 v[76:91], v[36:39], v[68:71], v[76:91]
    s_waitcnt lgkmcnt(0)
    v_mfma_f32_32x32x16_bf16 v[76:91], v[40:43], v[72:75], v[76:91]
    s_lshl_b32 s35, s56, 3
    s_cmp_eq_u32 s56, 0
    s_cselect_b32 s36, 32, 4
    s_cmp_eq_u32 s57, 0
    s_cselect_b32 s35, s35, s36
    s_cselect_b32 s36, 32, 4
    s_lshl_b32 s37, s31, 3
    s_add_u32 s35, s35, s37
    v_add_u32 v4, s35, v231
    v_mov_b32 v5, 192
    v_mad_u32_u24 v4, v230, v5, v4
    v_lshlrev_b32 v4, 2, v4
    v_cmp_gt_u32 vcc, s36, v231
    v_mov_b32 v5, 1073741824
    s_lshl_b32 s35, s30, 1
    v_cndmask_b32 v4, v5, v4, vcc
    v_cndmask_b32 v5, v4, v5, s[40:41]
    s_add_u32 s35, s35, s56
    s_mul_i32 s35, s35, 3840
    s_add_u32 s35, s35, 4718592
    buffer_atomic_add_f32 v76, v4, s[20:23], s35 offen offset:0 sc1
    buffer_atomic_add_f32 v77, v4, s[20:23], s35 offen offset:192 sc1
    buffer_atomic_add_f32 v78, v4, s[20:23], s35 offen offset:384 sc1
    buffer_atomic_add_f32 v79, v4, s[20:23], s35 offen offset:576 sc1
    buffer_atomic_add_f32 v80, v4, s[20:23], s35 offen offset:1536 sc1
    buffer_atomic_add_f32 v81, v4, s[20:23], s35 offen offset:1728 sc1
    buffer_atomic_add_f32 v82, v4, s[20:23], s35 offen offset:1920 sc1
    buffer_atomic_add_f32 v83, v4, s[20:23], s35 offen offset:2112 sc1
    buffer_atomic_add_f32 v84, v5, s[20:23], s35 offen offset:3072 sc1
    buffer_atomic_add_f32 v85, v5, s[20:23], s35 offen offset:3264 sc1
    buffer_atomic_add_f32 v86, v5, s[20:23], s35 offen offset:3456 sc1
    buffer_atomic_add_f32 v87, v5, s[20:23], s35 offen offset:3648 sc1
    v_sub_f32 v10, 0, v1
    v_lshlrev_b32 v11, 2, v231
    v_lshl_add_u32 v11, v230, 30, v11
    s_lshl_b32 s33, s34, 7
    s_add_u32 s33, s33, 4849664
    s_cmp_eq_u32 s30, 0
    s_cselect_b32 s33, s33, 1073741824
    buffer_store_dword v10, v11, s[20:23], s33 offen sc1
    v_max3_f32 v6, v108, v109, v110
    v_min3_f32 v7, v108, v109, v110
    v_max3_f32 v6, v6, v111, v112
    v_min3_f32 v7, v7, v111, v112
    v_max3_f32 v6, v6, v113, v114
    v_min3_f32 v7, v7, v113, v114
    v_max3_f32 v6, v6, v115, v116
    v_min3_f32 v7, v7, v115, v116
    v_max3_f32 v6, v6, v117, v118
    v_min3_f32 v7, v7, v117, v118
    v_max3_f32 v6, v6, v119, v120
    v_min3_f32 v7, v7, v119, v120
    v_max3_f32 v6, v6, v121, v122
    v_min3_f32 v7, v7, v121, v122
    v_max3_f32 v6, v6, v123, v124
    v_min3_f32 v7, v7, v123, v124
    v_max_f32 v6, v6, v125
    v_min_f32 v7, v7, v125
    v_mul_f32 v6, v3, v6
    v_mul_f32 v7, v3, v7
    v_fma_f32 v188, -v108, v3, v7
    v_fma_f32 v108, v108, v3, -v6
    v_fma_f32 v189, -v109, v3, v7
    v_fma_f32 v109, v109, v3, -v6
    v_fma_f32 v190, -v110, v3, v7
    v_fma_f32 v110, v110, v3, -v6
    v_fma_f32 v191, -v111, v3, v7
    v_fma_f32 v111, v111, v3, -v6
    v_fma_f32 v192, -v112, v3, v7
    v_fma_f32 v112, v112, v3, -v6
    v_fma_f32 v193, -v113, v3, v7
    v_fma_f32 v113, v113, v3, -v6
    v_fma_f32 v194, -v114, v3, v7
    v_fma_f32 v114, v114, v3, -v6
    v_fma_f32 v195, -v115, v3, v7
    v_fma_f32 v115, v115, v3, -v6
    v_fma_f32 v196, -v116, v3, v7
    v_fma_f32 v116, v116, v3, -v6
    v_fma_f32 v197, -v117, v3, v7
    v_fma_f32 v117, v117, v3, -v6
    v_fma_f32 v198, -v118, v3, v7
    v_fma_f32 v118, v118, v3, -v6
    v_fma_f32 v199, -v119, v3, v7
    v_fma_f32 v119, v119, v3, -v6
    v_fma_f32 v200, -v120, v3, v7
    v_fma_f32 v120, v120, v3, -v6
    v_fma_f32 v201, -v121, v3, v7
    v_fma_f32 v121, v121, v3, -v6
    v_fma_f32 v202, -v122, v3, v7
    v_fma_f32 v122, v122, v3, -v6
    v_fma_f32 v203, -v123, v3, v7
    v_fma_f32 v123, v123, v3, -v6
    v_fma_f32 v204, -v124, v3, v7
    v_fma_f32 v124, v124, v3, -v6
    v_fma_f32 v205, -v125, v3, v7
    v_fma_f32 v125, v125, v3, -v6
    v_exp_f32 v188, v188
    v_exp_f32 v108, v108
    v_exp_f32 v189, v189
    v_exp_f32 v109, v109
    v_exp_f32 v190, v190
    v_exp_f32 v110, v110
    v_exp_f32 v191, v191
    v_exp_f32 v111, v111
    v_exp_f32 v192, v192
    v_exp_f32 v112, v112
    v_exp_f32 v193, v193
    v_exp_f32 v113, v113
    v_exp_f32 v194, v194
    v_exp_f32 v114, v114
    v_exp_f32 v195, v195
    v_exp_f32 v115, v115
    v_exp_f32 v196, v196
    v_exp_f32 v116, v116
    v_exp_f32 v197, v197
    v_exp_f32 v117, v117
    v_exp_f32 v198, v198
    v_exp_f32 v118, v118
    v_exp_f32 v199, v199
    v_exp_f32 v119, v119
    v_exp_f32 v200, v200
    v_exp_f32 v120, v120
    v_exp_f32 v201, v201
    v_exp_f32 v121, v121
    v_exp_f32 v202, v202
    v_exp_f32 v122, v122
    v_exp_f32 v203, v203
    v_exp_f32 v123, v123
    v_exp_f32 v204, v204
    v_exp_f32 v124, v124
    v_exp_f32 v205, v205
    v_exp_f32 v125, v125
    v_add_f32 v8, v108, v109
    v_add_f32 v9, v188, v189
    v_add_f32 v8, v8, v110
    v_add_f32 v9, v9, v190
    v_add_f32 v8, v8, v111
    v_add_f32 v9, v9, v191
    v_add_f32 v8, v8, v112
    v_add_f32 v9, v9, v192
    v_add_f32 v8, v8, v113
    v_add_f32 v9, v9, v193
    v_add_f32 v8, v8, v114
    v_add_f32 v9, v9, v194
    v_add_f32 v8, v8, v115
    v_add_f32 v9, v9, v195
    v_add_f32 v8, v8, v116
    v_add_f32 v9, v9, v196
    v_add_f32 v8, v8, v117
    v_add_f32 v9, v9, v197
    v_add_f32 v8, v8, v118
    v_add_f32 v9, v9, v198
    v_add_f32 v8, v8, v119
    v_add_f32 v9, v9, v199
    v_add_f32 v8, v8, v120
    v_add_f32 v9, v9, v200
    v_add_f32 v8, v8, v121
    v_add_f32 v9, v9, v201
    v_add_f32 v8, v8, v122
    v_add_f32 v9, v9, v202
    v_add_f32 v8, v8, v123
    v_add_f32 v9, v9, v203
    v_add_f32 v8, v8, v124
    v_add_f32 v9, v9, v204
    v_add_f32 v8, v8, v125
    v_add_f32 v9, v9, v205
    v_rcp_f32 v8, v8
    v_rcp_f32 v9, v9
    s_nop 0
    v_mul_f32 v108, v8, v108
    v_mul_f32 v188, v9, v188
    v_mul_f32 v109, v8, v109
    v_mul_f32 v189, v9, v189
    v_mul_f32 v110, v8, v110
    v_mul_f32 v190, v9, v190
    v_mul_f32 v111, v8, v111
    v_mul_f32 v191, v9, v191
    v_mul_f32 v112, v8, v112
    v_mul_f32 v192, v9, v192
    v_mul_f32 v113, v8, v113
    v_mul_f32 v193, v9, v193
    v_mul_f32 v114, v8, v114
    v_mul_f32 v194, v9, v194
    v_mul_f32 v115, v8, v115
    v_mul_f32 v195, v9, v195
    v_mul_f32 v116, v8, v116
    v_mul_f32 v196, v9, v196
    v_mul_f32 v117, v8, v117
    v_mul_f32 v197, v9, v197
    v_mul_f32 v118, v8, v118
    v_mul_f32 v198, v9, v198
    v_mul_f32 v119, v8, v119
    v_mul_f32 v199, v9, v199
    v_mul_f32 v120, v8, v120
    v_mul_f32 v200, v9, v200
    v_mul_f32 v121, v8, v121
    v_mul_f32 v201, v9, v201
    v_mul_f32 v122, v8, v122
    v_mul_f32 v202, v9, v202
    v_mul_f32 v123, v8, v123
    v_mul_f32 v203, v9, v203
    v_mul_f32 v124, v8, v124
    v_mul_f32 v204, v9, v204
    v_mul_f32 v125, v8, v125
    v_mul_f32 v205, v9, v205
    v_cvt_pk_bf16_f32 v164, v108, v109
    v_cvt_pk_bf16_f32 v165, v110, v111
    v_cvt_pk_bf16_f32 v166, v112, v113
    v_cvt_pk_bf16_f32 v167, v114, v115
    v_cvt_pk_bf16_f32 v168, v116, v117
    v_cvt_pk_bf16_f32 v169, v118, v119
    v_cvt_pk_bf16_f32 v170, v120, v121
    v_cvt_pk_bf16_f32 v171, v122, v123
    v_cvt_pk_bf16_f32 v172, v124, v125
    v_cvt_pk_bf16_f32 v173, v188, v189
    v_cvt_pk_bf16_f32 v174, v190, v191
    v_cvt_pk_bf16_f32 v175, v192, v193
    v_cvt_pk_bf16_f32 v176, v194, v195
    v_cvt_pk_bf16_f32 v177, v196, v197
    v_cvt_pk_bf16_f32 v178, v198, v199
    v_cvt_pk_bf16_f32 v179, v200, v201
    v_cvt_pk_bf16_f32 v180, v202, v203
    v_cvt_pk_bf16_f32 v181, v204, v205
    v_lshlrev_b32 v4, 4, v231
    v_lshl_add_u32 v5, v230, 3, v4
    v_mov_b32 v6, 2560
    v_mad_u32_u24 v4, v230, v6, v4
    s_mul_i32 s35, s34, 73728
    s_mul_i32 s32, s30, 4608
    s_add_u32 s35, s35, s32
    s_add_u32 s35, s35, 0
    buffer_store_dwordx4 v[164:167], v4, s[20:23], s35 offen offset:0 sc1
    buffer_store_dwordx4 v[168:171], v4, s[20:23], s35 offen offset:512 sc1
    buffer_store_dwordx4 v[172:175], v4, s[20:23], s35 offen offset:1024 sc1
    buffer_store_dwordx4 v[176:179], v4, s[20:23], s35 offen offset:1536 sc1
    v_permlane32_swap_b32 v180, v182
    v_permlane32_swap_b32 v181, v183
    v_lshlrev_b32 v5, 4, v231
    v_lshl_add_u32 v5, v230, 30, v5
    buffer_store_dwordx4 v[180:183], v5, s[20:23], s35 offen offset:2048 sc1
    s_mov_b32 s61, s30
    s_load_dwordx2 s[4:5], s[0:1], 0
    s_load_dwordx2 s[6:7], s[0:1], 80
    s_load_dwordx4 s[48:51], s[0:1], 40
    s_load_dwordx2 s[52:53], s[0:1], 56
    s_mov_b32 s20, s28
    s_and_b32 s23, s2, 4
    s_lshl_b32 s23, s23, 1
    s_lshr_b32 s24, s2, 5
    s_add_u32 s23, s23, s24
    s_lshl_b32 s23, s23, 2
    s_and_b32 s24, s2, 3
    s_add_u32 s21, s23, s24
    s_bfe_u32 s22, s2, 0x20003
    s_mul_i32 s26, s22, 5
    s_cmp_eq_u32 s22, 3
    s_cselect_b32 s26, 14, s26
    v_lshlrev_b32 v222, 4, v0
    s_mul_i32 s28, s20, 30720
    s_waitcnt lgkmcnt(0)
    s_mov_b32 s8, s4
    s_mov_b32 s9, s5
    s_mov_b32 s10, 2359296
    s_mov_b32 s11, 0x00020000
    s_mov_b32 s12, s6
    s_mov_b32 s13, s7
    s_mov_b32 s14, 46137344
    s_mov_b32 s15, 0x00020000
    s_add_u32 s54, s28, 4718592
    s_mov_b32 m0, s28
    s_mul_i32 s56, s21, 73728
    s_mul_i32 s24, s20, 18432
    s_add_u32 s56, s56, s24
    s_add_u32 s56, s56, 0
    v_and_b32 v1, 31, v0
    v_lshrrev_b32 v2, 5, v0
    v_lshrrev_b32 v3, 3, v1
    v_and_b32 v4, 3, v1
    v_lshl_add_u32 v3, v3, 2, v4
    v_bfe_u32 v4, v1, 2, 1
    v_mad_u32_u24 v4, v4, 9, v3
    v_cmp_lt_u32 vcc, 8, v3
    v_add_u32 v5, 2, v4
    s_nop 0
    v_cndmask_b32 v4, v4, 18, vcc
    v_cndmask_b32 v5, v5, 0, vcc
    v_lshlrev_b32 v6, 5, v2
    v_add_u32 v6, s28, v6
    v_mov_b32 v7, 192
    v_mad_u32_u24 v223, v4, v7, v6
    v_mad_u32_u24 v224, v5, v7, v6
    v_and_b32 v233, 5, v1
    v_lshl_add_u32 v233, v2, 5, v233
    v_lshlrev_b32 v233, 4, v233
    v_add_u32 v225, s28, v222
    s_lshl_b32 s24, s20, 11
    v_add_u32 v226, s24, v222
    v_lshlrev_b32 v227, 3, v0
    v_mul_u32_u24 v228, 1152, v1
    v_lshl_add_u32 v228, v2, 3, v228
    s_lshl_b32 s24, s20, 5
    v_add_u32 v228, s24, v228
    s_lshl_b32 s24, s20, 10
    v_add_u32 v229, s24, v222
    v_lshlrev_b32 v230, 2, v1
    s_lshl_b32 s24, s22, 2
    s_add_u32 s24, s24, s20
    s_lshl_b32 s24, s24, 7
    v_add_u32 v231, s24, v230
    v_lshlrev_b32 v3, 30, v2
    v_add_u32 v231, v231, v3
    s_mul_i32 s23, s26, 36864
    s_mul_i32 s24, s20, 9216
    s_add_u32 s24, s24, 5062656
    s_add_u32 s30, s23, s24
    s_add_u32 s31, s30, 36864
    s_add_u32 s32, s31, 36864
    s_add_u32 s33, s32, 36864
    s_add_u32 s34, s33, 36864
    s_add_u32 s35, s24, 663552
    s_mul_i32 s23, s21, 36864
    s_lshl_b32 s24, s26, 6
    s_add_u32 s36, s23, s24
    s_mul_i32 s23, s21, 36864
    s_lshl_b32 s24, s26, 11
    s_add_u32 s23, s23, s24
    s_add_u32 s42, s23, 5767168
    s_add_u32 s37, s36, 128
    s_add_u32 s43, s42, 4096
    s_add_u32 s38, s37, 128
    s_add_u32 s44, s43, 4096
    s_cmp_lt_u32 s22, 2
    s_cselect_b32 s34, s34, 1073741824
    s_or_b32 s27, s22, s20
    s_cmp_lt_u32 s27, 2
    s_cselect_b32 s38, s38, 1073741824
    v_cmp_eq_u32 vcc, 0, v0
    v_mov_b32 v136, 1073741824
    v_mov_b32 v137, 1
    v_cndmask_b32 v136, v136, 0, vcc
    v_min_u32 v138, 15, v0
    v_lshlrev_b32 v138, 7, v138
    v_mov_b32 v139, 1
    s_lshl_b32 s57, s61, 7
    s_add_u32 s57, s57, 5038080
    s_and_b32 s58, s2, 15
    s_lshl_b32 s58, s58, 7
    s_add_u32 s58, s58, 5042176
    s_mov_b32 s59, 5040128
    s_mov_b32 s60, 0x100000
    s_waitcnt vmcnt(0)
    s_barrier
    s_cmp_lg_u32 s20, 0
    s_cbranch_scc1 L_gb_arrived
    buffer_atomic_add v137, v136, s[12:15], s57 offen sc0 sc1
    s_waitcnt vmcnt(0)
    v_readfirstlane_b32 s57, v137
    s_nop 0
    s_cmp_eq_u32 s57, 15
    s_cbranch_scc0 L_gb_arrived
    buffer_atomic_add v139, v136, s[12:15], s59 offen sc0 sc1
    s_waitcnt vmcnt(0)
    v_readfirstlane_b32 s57, v139
    v_mov_b32 v139, 1
    s_cmp_eq_u32 s57, 15
    s_cbranch_scc0 L_gb_arrived
    s_mov_b32 s59, 5042176
    buffer_store_dword v139, v138, s[12:15], s59 offen sc1
L_gb_arrived:
    s_cmp_lg_u32 s20, 0
    s_cbranch_scc1 L_gb_done
L_gb_poll:
    buffer_load_dword v137, off, s[12:15], s58 sc1
    s_waitcnt vmcnt(0)
    v_readfirstlane_b32 s57, v137
    s_sub_u32 s60, s60, 1
    s_cbranch_scc1 L_gb_done
    s_cmp_lg_u32 s57, 0
    s_cbranch_scc1 L_gb_done
    s_branch L_gb_poll
L_gb_done:
    s_barrier
    buffer_load_dwordx4 v222, s[12:15], s54 offen sc1 lds
    buffer_load_dwordx4 v222, s[12:15], s54 offen offset:1024 sc1 lds
    buffer_load_dwordx4 v222, s[12:15], s54 offen offset:2048 sc1 lds
    buffer_load_dwordx4 v222, s[12:15], s54 offen offset:3072 sc1 lds
    buffer_load_dwordx4 a[0:3], v222, s[12:15], s56 offen sc1
    buffer_load_dwordx4 a[4:7], v222, s[12:15], s56 offen offset:1024 sc1
    buffer_load_dwordx4 a[8:11], v222, s[12:15], s56 offen offset:2048 sc1
    s_add_u32 m0, m0, 4096
    s_add_u32 s54, s54, 4096
    buffer_load_dwordx4 v222, s[12:15], s54 offen sc1 lds
    buffer_load_dwordx4 v222, s[12:15], s54 offen offset:1024 sc1 lds
    buffer_load_dwordx4 v222, s[12:15], s54 offen offset:2048 sc1 lds
    buffer_load_dwordx4 v222, s[12:15], s54 offen offset:3072 sc1 lds
    buffer_load_dwordx4 a[12:15], v222, s[12:15], s56 offen offset:3072 sc1
    s_add_u32 s56, s56, 4096
    buffer_load_dwordx4 a[16:19], v222, s[12:15], s56 offen sc1
    s_add_u32 m0, m0, 4096
    s_add_u32 s54, s54, 4096
    buffer_load_dwordx4 v222, s[12:15], s54 offen sc1 lds
    buffer_load_dwordx4 v222, s[12:15], s54 offen offset:1024 sc1 lds
    buffer_load_dwordx4 v222, s[12:15], s54 offen offset:2048 sc1 lds
    buffer_load_dwordx4 v222, s[12:15], s54 offen offset:3072 sc1 lds
    buffer_load_dwordx4 a[20:23], v222, s[12:15], s56 offen offset:1024 sc1
    buffer_load_dwordx4 a[24:27], v222, s[12:15], s56 offen offset:2048 sc1
    s_add_u32 m0, m0, 4096
    s_add_u32 s54, s54, 4096
    buffer_load_dwordx4 v222, s[12:15], s54 offen sc1 lds
    buffer_load_dwordx4 v222, s[12:15], s54 offen offset:1024 sc1 lds
    buffer_load_dwordx4 v222, s[12:15], s54 offen offset:2048 sc1 lds
    buffer_load_dwordx4 v222, s[12:15], s54 offen offset:3072 sc1 lds
    buffer_load_dwordx4 a[28:31], v222, s[12:15], s56 offen offset:3072 sc1
    s_add_u32 s56, s56, 4096
    buffer_load_dwordx4 a[32:35], v222, s[12:15], s56 offen sc1
    s_add_u32 m0, m0, 4096
    s_add_u32 s54, s54, 4096
    buffer_load_dwordx4 v222, s[12:15], s54 offen sc1 lds
    buffer_load_dwordx4 v222, s[12:15], s54 offen offset:1024 sc1 lds
    buffer_load_dwordx4 v222, s[12:15], s54 offen offset:2048 sc1 lds
    s_add_u32 s23, s26, s20
    s_mul_i32 s30, s23, 36864
    s_add_u32 s24, s20, 3
    s_and_b32 s24, s24, 3
    s_mul_i32 s24, s24, 9216
    s_add_u32 s30, s30, s24
    s_add_u32 s30, s30, 5062656
    s_add_u32 s31, s20, 1
    s_and_b32 s31, s31, 3
    s_mul_i32 s31, s31, 30720
    s_add_u32 s32, s20, 2
    s_and_b32 s32, s32, 3
    s_mul_i32 s32, s32, 30720
    s_add_u32 s33, s20, 3
    s_and_b32 s33, s33, 3
    s_mul_i32 s33, s33, 30720
    s_lshl_b32 s24, s20, 5
    s_add_u32 s37, s36, s24
    s_lshl_b32 s24, s20, 10
    s_add_u32 s43, s42, s24
    s_lshl_b32 s23, s21, 7
    s_add_u32 s24, s23, 4849664
    s_waitcnt vmcnt(24)
    ds_read_b128 v[136:139], v223 offset:0
    ds_read_b128 v[140:143], v223 offset:16
    ds_read_b128 v[144:147], v223 offset:64
    ds_read_b128 v[148:151], v223 offset:80
    s_waitcnt lgkmcnt(2)
    v_cvt_pk_bf16_f32 v152, v136, v137
    v_cvt_pk_bf16_f32 v153, v138, v139
    v_cvt_pk_bf16_f32 v154, v140, v141
    v_cvt_pk_bf16_f32 v155, v142, v143
    s_waitcnt vmcnt(23)
    s_nop 0
    v_mfma_f32_32x32x16_bf16 v[104:119], v[152:155], a[0:3], 0
    buffer_load_dwordx4 v222, s[12:15], s54 offen offset:3072 sc1 lds
    buffer_load_dwordx4 a[36:39], v222, s[12:15], s56 offen offset:1024 sc1
    ds_read_b128 v[136:139], v223 offset:128
    ds_read_b128 v[140:143], v223 offset:144
    s_waitcnt lgkmcnt(2)
    v_cvt_pk_bf16_f32 v156, v144, v145
    v_cvt_pk_bf16_f32 v157, v146, v147
    v_cvt_pk_bf16_f32 v158, v148, v149
    v_cvt_pk_bf16_f32 v159, v150, v151
    s_waitcnt vmcnt(24)
    s_nop 0
    v_mfma_f32_32x32x16_bf16 v[104:119], v[156:159], a[4:7], v[104:119]
    buffer_load_dwordx4 a[40:43], v222, s[12:15], s56 offen offset:2048 sc1
    buffer_load_dwordx4 a[44:47], v222, s[12:15], s56 offen offset:3072 sc1
    s_waitcnt vmcnt(21)
    ds_read_b128 v[144:147], v224 offset:3840
    ds_read_b128 v[148:151], v224 offset:3856
    s_waitcnt lgkmcnt(2)
    v_cvt_pk_bf16_f32 v160, v136, v137
    v_cvt_pk_bf16_f32 v161, v138, v139
    v_cvt_pk_bf16_f32 v162, v140, v141
    v_cvt_pk_bf16_f32 v163, v142, v143
    s_waitcnt vmcnt(25)
    s_nop 0
    v_mfma_f32_32x32x16_bf16 v[104:119], v[160:163], a[8:11], v[104:119]
    s_add_u32 m0, m0, 4096
    s_add_u32 s54, s54, 4096
    buffer_load_dwordx4 v222, s[12:15], s54 offen sc1 lds
    buffer_load_dwordx4 v222, s[12:15], s54 offen offset:1024 sc1 lds
    ds_read_b128 v[136:139], v224 offset:3904
    ds_read_b128 v[140:143], v224 offset:3920
    s_waitcnt lgkmcnt(2)
    v_cvt_pk_bf16_f32 v152, v144, v145
    v_cvt_pk_bf16_f32 v153, v146, v147
    v_cvt_pk_bf16_f32 v154, v148, v149
    v_cvt_pk_bf16_f32 v155, v150, v151
    s_waitcnt vmcnt(27)
    s_nop 0
    v_mfma_f32_32x32x16_bf16 v[120:135], v[152:155], a[8:11], 0
    buffer_load_dwordx4 v222, s[12:15], s54 offen offset:2048 sc1 lds
    buffer_load_dwordx4 v222, s[12:15], s54 offen offset:3072 sc1 lds
    ds_read_b128 v[144:147], v224 offset:3968
    ds_read_b128 v[148:151], v224 offset:3984
    s_waitcnt lgkmcnt(2)
    v_cvt_pk_bf16_f32 v156, v136, v137
    v_cvt_pk_bf16_f32 v157, v138, v139
    v_cvt_pk_bf16_f32 v158, v140, v141
    v_cvt_pk_bf16_f32 v159, v142, v143
    s_waitcnt vmcnt(24)
    s_nop 0
    v_mfma_f32_32x32x16_bf16 v[120:135], v[156:159], a[12:15], v[120:135]
    s_add_u32 s56, s56, 4096
    buffer_load_dwordx4 a[48:51], v222, s[12:15], s56 offen sc1
    buffer_load_dwordx4 a[52:55], v222, s[12:15], s56 offen offset:1024 sc1
    v_add_f32 v113, 1e-6, v113
    v_rcp_f32 v113, v113
    s_nop 0
    v_mul_f32 v200, v104, v113
    v_mul_f32 v201, v105, v113
    v_cvt_pk_bf16_f32 v164, v200, v201
    v_mul_f32 v202, v106, v113
    v_mul_f32 v203, v107, v113
    v_cvt_pk_bf16_f32 v165, v202, v203
    v_mul_f32 v204, v108, v113
    v_mul_f32 v205, v109, v113
    v_cvt_pk_bf16_f32 v166, v204, v205
    v_mul_f32 v206, v110, v113
    v_mul_f32 v207, v111, v113
    v_cvt_pk_bf16_f32 v167, v206, v207
    v_mul_f32 v208, v112, v113
    s_nop 0
    ds_write_b128 v225, v[164:167] offset:0
    v_mfma_f32_32x32x16_bf16 v[40:55], a[72:75], v[164:167], 0
    v_mfma_f32_32x32x16_bf16 v[24:39], a[108:111], v[164:167], 0
    v_mfma_f32_32x32x16_bf16 v[8:23], a[144:147], v[164:167], 0
    s_waitcnt vmcnt(21)
    ds_read_b128 v[136:139], v223 offset:7680
    ds_read_b128 v[140:143], v223 offset:7696
    s_waitcnt lgkmcnt(3)
    v_cvt_pk_bf16_f32 v160, v144, v145
    v_cvt_pk_bf16_f32 v161, v146, v147
    v_cvt_pk_bf16_f32 v162, v148, v149
    v_cvt_pk_bf16_f32 v163, v150, v151
    s_waitcnt vmcnt(25)
    s_nop 0
    v_mfma_f32_32x32x16_bf16 v[120:135], v[160:163], a[16:19], v[120:135]
    s_add_u32 m0, m0, 4096
    s_add_u32 s54, s54, 4096
    buffer_load_dwordx4 v222, s[12:15], s54 offen sc1 lds
    buffer_load_dwordx4 v222, s[12:15], s54 offen offset:1024 sc1 lds
    ds_read_b128 v[144:147], v223 offset:7744
    ds_read_b128 v[148:151], v223 offset:7760
    s_waitcnt lgkmcnt(2)
    v_cvt_pk_bf16_f32 v152, v136, v137
    v_cvt_pk_bf16_f32 v153, v138, v139
    v_cvt_pk_bf16_f32 v154, v140, v141
    v_cvt_pk_bf16_f32 v155, v142, v143
    s_waitcnt vmcnt(27)
    s_nop 0
    v_mfma_f32_32x32x16_bf16 v[104:119], v[152:155], a[16:19], 0
    buffer_load_dwordx4 v222, s[12:15], s54 offen offset:2048 sc1 lds
    buffer_load_dwordx4 v222, s[12:15], s54 offen offset:3072 sc1 lds
    ds_read_b128 v[136:139], v223 offset:7808
    ds_read_b128 v[140:143], v223 offset:7824
    s_waitcnt lgkmcnt(2)
    v_cvt_pk_bf16_f32 v156, v144, v145
    v_cvt_pk_bf16_f32 v157, v146, v147
    v_cvt_pk_bf16_f32 v158, v148, v149
    v_cvt_pk_bf16_f32 v159, v150, v151
    s_waitcnt vmcnt(24)
    s_nop 0
    v_mfma_f32_32x32x16_bf16 v[104:119], v[156:159], a[20:23], v[104:119]
    buffer_load_dwordx4 a[56:59], v222, s[12:15], s56 offen offset:2048 sc1
    buffer_load_dwordx4 a[60:63], v222, s[12:15], s56 offen offset:3072 sc1
    v_add_f32 v129, 1e-6, v129
    v_rcp_f32 v129, v129
    s_nop 0
    v_mul_f32 v209, v120, v129
    v_cvt_pk_bf16_f32 v168, v208, v209
    v_mul_f32 v200, v121, v129
    v_mul_f32 v201, v122, v129
    v_cvt_pk_bf16_f32 v169, v200, v201
    v_mul_f32 v202, v123, v129
    v_mul_f32 v203, v124, v129
    v_cvt_pk_bf16_f32 v170, v202, v203
    v_mul_f32 v204, v125, v129
    v_mul_f32 v205, v126, v129
    v_cvt_pk_bf16_f32 v171, v204, v205
    v_mul_f32 v206, v127, v129
    v_mul_f32 v207, v128, v129
    v_cvt_pk_bf16_f32 v172, v206, v207
    s_nop 0
    ds_write_b128 v225, v[168:171] offset:1024
    v_mfma_f32_32x32x16_bf16 v[40:55], a[76:79], v[168:171], v[40:55]
    v_mfma_f32_32x32x16_bf16 v[24:39], a[112:115], v[168:171], v[24:39]
    v_mfma_f32_32x32x16_bf16 v[8:23], a[148:151], v[168:171], v[8:23]
    s_waitcnt vmcnt(22)
    ds_read_b128 v[144:147], v224 offset:11520
    ds_read_b128 v[148:151], v224 offset:11536
    s_waitcnt lgkmcnt(3)
    v_cvt_pk_bf16_f32 v160, v136, v137
    v_cvt_pk_bf16_f32 v161, v138, v139
    v_cvt_pk_bf16_f32 v162, v140, v141
    v_cvt_pk_bf16_f32 v163, v142, v143
    s_waitcnt vmcnt(25)
    s_nop 0
    v_mfma_f32_32x32x16_bf16 v[104:119], v[160:163], a[24:27], v[104:119]
    s_add_u32 m0, m0, 4096
    s_add_u32 s54, s54, 4096
    buffer_load_dwordx4 v222, s[12:15], s54 offen sc1 lds
    buffer_load_dwordx4 v222, s[12:15], s54 offen offset:1024 sc1 lds
    ds_read_b128 v[136:139], v224 offset:11584
    ds_read_b128 v[140:143], v224 offset:11600
    s_waitcnt lgkmcnt(2)
    v_cvt_pk_bf16_f32 v152, v144, v145
    v_cvt_pk_bf16_f32 v153, v146, v147
    v_cvt_pk_bf16_f32 v154, v148, v149
    v_cvt_pk_bf16_f32 v155, v150, v151
    s_waitcnt vmcnt(27)
    s_nop 0
    v_mfma_f32_32x32x16_bf16 v[120:135], v[152:155], a[24:27], 0
    s_add_u32 s56, s56, 4096
    buffer_load_dwordx4 a[64:67], v222, s[12:15], s56 offen sc1
    buffer_load_dwordx4 a[68:71], v222, s[12:15], s56 offen offset:1024 sc1
    ds_read_b128 v[144:147], v224 offset:11648
    ds_read_b128 v[148:151], v224 offset:11664
    s_waitcnt lgkmcnt(2)
    v_cvt_pk_bf16_f32 v156, v136, v137
    v_cvt_pk_bf16_f32 v157, v138, v139
    v_cvt_pk_bf16_f32 v158, v140, v141
    v_cvt_pk_bf16_f32 v159, v142, v143
    s_waitcnt vmcnt(24)
    s_nop 0
    v_mfma_f32_32x32x16_bf16 v[120:135], v[156:159], a[28:31], v[120:135]
    v_add_f32 v113, 1e-6, v113
    v_rcp_f32 v113, v113
    s_nop 0
    v_mul_f32 v208, v104, v113
    v_mul_f32 v209, v105, v113
    v_cvt_pk_bf16_f32 v173, v208, v209
    v_mul_f32 v200, v106, v113
    v_mul_f32 v201, v107, v113
    v_cvt_pk_bf16_f32 v174, v200, v201
    v_mul_f32 v202, v108, v113
    v_mul_f32 v203, v109, v113
    v_cvt_pk_bf16_f32 v175, v202, v203
    v_mul_f32 v204, v110, v113
    v_mul_f32 v205, v111, v113
    v_cvt_pk_bf16_f32 v176, v204, v205
    v_mul_f32 v206, v112, v113
    s_nop 0
    ds_write_b128 v225, v[172:175] offset:2048
    v_mfma_f32_32x32x16_bf16 v[40:55], a[80:83], v[172:175], v[40:55]
    v_mfma_f32_32x32x16_bf16 v[24:39], a[116:119], v[172:175], v[24:39]
    v_mfma_f32_32x32x16_bf16 v[8:23], a[152:155], v[172:175], v[8:23]
    s_waitcnt vmcnt(20)
    ds_read_b128 v[136:139], v223 offset:15360
    ds_read_b128 v[140:143], v223 offset:15376
    s_waitcnt lgkmcnt(3)
    v_cvt_pk_bf16_f32 v160, v144, v145
    v_cvt_pk_bf16_f32 v161, v146, v147
    v_cvt_pk_bf16_f32 v162, v148, v149
    v_cvt_pk_bf16_f32 v163, v150, v151
    s_waitcnt vmcnt(23)
    s_nop 0
    v_mfma_f32_32x32x16_bf16 v[120:135], v[160:163], a[32:35], v[120:135]
    ds_read_b128 v[144:147], v223 offset:15424
    ds_read_b128 v[148:151], v223 offset:15440
    s_waitcnt lgkmcnt(2)
    v_cvt_pk_bf16_f32 v152, v136, v137
    v_cvt_pk_bf16_f32 v153, v138, v139
    v_cvt_pk_bf16_f32 v154, v140, v141
    v_cvt_pk_bf16_f32 v155, v142, v143
    s_waitcnt vmcnt(18)
    s_nop 0
    v_mfma_f32_32x32x16_bf16 v[104:119], v[152:155], a[36:39], 0
    buffer_load_dwordx4 a[0:3], v222, s[12:15], s30 offen offset:1024 sc1
    buffer_load_dwordx4 a[4:7], v222, s[12:15], s30 offen offset:2048 sc1
    ds_read_b128 v[136:139], v223 offset:15488
    ds_read_b128 v[140:143], v223 offset:15504
    s_waitcnt lgkmcnt(2)
    v_cvt_pk_bf16_f32 v156, v144, v145
    v_cvt_pk_bf16_f32 v157, v146, v147
    v_cvt_pk_bf16_f32 v158, v148, v149
    v_cvt_pk_bf16_f32 v159, v150, v151
    s_waitcnt vmcnt(19)
    s_nop 0
    v_mfma_f32_32x32x16_bf16 v[104:119], v[156:159], a[40:43], v[104:119]
    buffer_load_dwordx4 a[8:11], v222, s[12:15], s30 offen offset:3072 sc1
    s_add_u32 s30, s30, 4096
    buffer_load_dwordx4 a[12:15], v222, s[12:15], s30 offen sc1
    v_add_f32 v129, 1e-6, v129
    v_rcp_f32 v129, v129
    s_nop 0
    v_mul_f32 v207, v120, v129
    v_cvt_pk_bf16_f32 v177, v206, v207
    v_mul_f32 v208, v121, v129
    v_mul_f32 v209, v122, v129
    v_cvt_pk_bf16_f32 v178, v208, v209
    v_mul_f32 v200, v123, v129
    v_mul_f32 v201, v124, v129
    v_cvt_pk_bf16_f32 v179, v200, v201
    v_mul_f32 v202, v125, v129
    v_mul_f32 v203, v126, v129
    v_cvt_pk_bf16_f32 v180, v202, v203
    v_mul_f32 v204, v127, v129
    v_mul_f32 v205, v128, v129
    v_cvt_pk_bf16_f32 v181, v204, v205
    s_nop 0
    ds_write_b128 v225, v[176:179] offset:3072
    v_mfma_f32_32x32x16_bf16 v[40:55], a[84:87], v[176:179], v[40:55]
    v_mfma_f32_32x32x16_bf16 v[24:39], a[120:123], v[176:179], v[24:39]
    v_mfma_f32_32x32x16_bf16 v[8:23], a[156:159], v[176:179], v[8:23]
    s_waitcnt vmcnt(17)
    ds_read_b128 v[144:147], v224 offset:19200
    ds_read_b128 v[148:151], v224 offset:19216
    s_waitcnt lgkmcnt(3)
    v_cvt_pk_bf16_f32 v160, v136, v137
    v_cvt_pk_bf16_f32 v161, v138, v139
    v_cvt_pk_bf16_f32 v162, v140, v141
    v_cvt_pk_bf16_f32 v163, v142, v143
    s_waitcnt vmcnt(20)
    s_nop 0
    v_mfma_f32_32x32x16_bf16 v[104:119], v[160:163], a[44:47], v[104:119]
    buffer_load_dwordx4 a[16:19], v222, s[12:15], s30 offen offset:1024 sc1
    buffer_load_dwordx4 a[20:23], v222, s[12:15], s30 offen offset:2048 sc1
    ds_read_b128 v[136:139], v224 offset:19264
    ds_read_b128 v[140:143], v224 offset:19280
    s_waitcnt lgkmcnt(2)
    v_cvt_pk_bf16_f32 v152, v144, v145
    v_cvt_pk_bf16_f32 v153, v146, v147
    v_cvt_pk_bf16_f32 v154, v148, v149
    v_cvt_pk_bf16_f32 v155, v150, v151
    s_waitcnt vmcnt(22)
    s_nop 0
    v_mfma_f32_32x32x16_bf16 v[120:135], v[152:155], a[44:47], 0
    buffer_load_dwordx4 a[24:27], v222, s[12:15], s30 offen offset:3072 sc1
    s_add_u32 s30, s30, 4096
    buffer_load_dwordx4 a[28:31], v222, s[12:15], s30 offen sc1
    ds_read_b128 v[144:147], v224 offset:19328
    ds_read_b128 v[148:151], v224 offset:19344
    s_waitcnt lgkmcnt(2)
    v_cvt_pk_bf16_f32 v156, v136, v137
    v_cvt_pk_bf16_f32 v157, v138, v139
    v_cvt_pk_bf16_f32 v158, v140, v141
    v_cvt_pk_bf16_f32 v159, v142, v143
    s_waitcnt vmcnt(19)
    s_nop 0
    v_mfma_f32_32x32x16_bf16 v[120:135], v[156:159], a[48:51], v[120:135]
    buffer_load_dwordx2 v[210:211], v228, s[8:11], s37 offen offset:0
    buffer_load_dwordx2 v[212:213], v228, s[8:11], s37 offen offset:16
    v_add_f32 v113, 1e-6, v113
    v_rcp_f32 v113, v113
    s_nop 0
    v_mul_f32 v206, v104, v113
    v_mul_f32 v207, v105, v113
    v_cvt_pk_bf16_f32 v182, v206, v207
    v_mul_f32 v208, v106, v113
    v_mul_f32 v209, v107, v113
    v_cvt_pk_bf16_f32 v183, v208, v209
    v_mul_f32 v200, v108, v113
    v_mul_f32 v201, v109, v113
    v_cvt_pk_bf16_f32 v184, v200, v201
    v_mul_f32 v202, v110, v113
    v_mul_f32 v203, v111, v113
    v_cvt_pk_bf16_f32 v185, v202, v203
    v_mul_f32 v204, v112, v113
    s_nop 0
    ds_write_b128 v225, v[180:183] offset:4096
    v_mfma_f32_32x32x16_bf16 v[40:55], a[88:91], v[180:183], v[40:55]
    v_mfma_f32_32x32x16_bf16 v[24:39], a[124:127], v[180:183], v[24:39]
    v_mfma_f32_32x32x16_bf16 v[8:23], a[160:163], v[180:183], v[8:23]
    s_waitcnt vmcnt(17)
    ds_read_b128 v[136:139], v223 offset:23040
    ds_read_b128 v[140:143], v223 offset:23056
    s_waitcnt lgkmcnt(3)
    v_cvt_pk_bf16_f32 v160, v144, v145
    v_cvt_pk_bf16_f32 v161, v146, v147
    v_cvt_pk_bf16_f32 v162, v148, v149
    v_cvt_pk_bf16_f32 v163, v150, v151
    s_waitcnt vmcnt(20)
    s_nop 0
    v_mfma_f32_32x32x16_bf16 v[120:135], v[160:163], a[52:55], v[120:135]
    buffer_load_dwordx2 v[214:215], v228, s[8:11], s37 offen offset:32
    buffer_load_dwordx2 v[216:217], v228, s[8:11], s37 offen offset:48
    ds_read_b128 v[144:147], v223 offset:23104
    ds_read_b128 v[148:151], v223 offset:23120
    s_waitcnt lgkmcnt(2)
    v_cvt_pk_bf16_f32 v152, v136, v137
    v_cvt_pk_bf16_f32 v153, v138, v139
    v_cvt_pk_bf16_f32 v154, v140, v141
    v_cvt_pk_bf16_f32 v155, v142, v143
    s_waitcnt vmcnt(22)
    s_nop 0
    v_mfma_f32_32x32x16_bf16 v[104:119], v[152:155], a[52:55], 0
    buffer_load_dwordx2 v[218:219], v228, s[8:11], s38 offen offset:0
    buffer_load_dwordx2 v[220:221], v228, s[8:11], s38 offen offset:16
    ds_read_b128 v[136:139], v223 offset:23168
    ds_read_b128 v[140:143], v223 offset:23184
    s_waitcnt lgkmcnt(2)
    v_cvt_pk_bf16_f32 v156, v144, v145
    v_cvt_pk_bf16_f32 v157, v146, v147
    v_cvt_pk_bf16_f32 v158, v148, v149
    v_cvt_pk_bf16_f32 v159, v150, v151
    s_waitcnt vmcnt(19)
    s_nop 0
    v_mfma_f32_32x32x16_bf16 v[104:119], v[156:159], a[56:59], v[104:119]
    buffer_load_dword v232, v230, s[12:15], s24 offen sc1
    v_add_f32 v129, 1e-6, v129
    v_rcp_f32 v129, v129
    s_nop 0
    v_mul_f32 v205, v120, v129
    v_cvt_pk_bf16_f32 v186, v204, v205
    v_mul_f32 v206, v121, v129
    v_mul_f32 v207, v122, v129
    v_cvt_pk_bf16_f32 v187, v206, v207
    v_mul_f32 v208, v123, v129
    v_mul_f32 v209, v124, v129
    v_cvt_pk_bf16_f32 v188, v208, v209
    v_mul_f32 v200, v125, v129
    v_mul_f32 v201, v126, v129
    v_cvt_pk_bf16_f32 v189, v200, v201
    v_mul_f32 v202, v127, v129
    v_mul_f32 v203, v128, v129
    v_cvt_pk_bf16_f32 v190, v202, v203
    s_nop 0
    ds_write_b128 v225, v[184:187] offset:5120
    v_mfma_f32_32x32x16_bf16 v[40:55], a[92:95], v[184:187], v[40:55]
    v_mfma_f32_32x32x16_bf16 v[24:39], a[128:131], v[184:187], v[24:39]
    v_mfma_f32_32x32x16_bf16 v[8:23], a[164:167], v[184:187], v[8:23]
    s_waitcnt vmcnt(17)
    ds_read_b128 v[144:147], v224 offset:26880
    ds_read_b128 v[148:151], v224 offset:26896
    s_waitcnt lgkmcnt(3)
    v_cvt_pk_bf16_f32 v160, v136, v137
    v_cvt_pk_bf16_f32 v161, v138, v139
    v_cvt_pk_bf16_f32 v162, v140, v141
    v_cvt_pk_bf16_f32 v163, v142, v143
    s_waitcnt vmcnt(19)
    s_nop 0
    v_mfma_f32_32x32x16_bf16 v[104:119], v[160:163], a[60:63], v[104:119]
    ds_read_b128 v[136:139], v224 offset:26944
    ds_read_b128 v[140:143], v224 offset:26960
    s_waitcnt lgkmcnt(2)
    v_cvt_pk_bf16_f32 v152, v144, v145
    v_cvt_pk_bf16_f32 v153, v146, v147
    v_cvt_pk_bf16_f32 v154, v148, v149
    v_cvt_pk_bf16_f32 v155, v150, v151
    s_waitcnt vmcnt(19)
    s_nop 0
    v_mfma_f32_32x32x16_bf16 v[120:135], v[152:155], a[60:63], 0
    ds_read_b128 v[144:147], v224 offset:27008
    ds_read_b128 v[148:151], v224 offset:27024
    s_waitcnt lgkmcnt(2)
    v_cvt_pk_bf16_f32 v156, v136, v137
    v_cvt_pk_bf16_f32 v157, v138, v139
    v_cvt_pk_bf16_f32 v158, v140, v141
    v_cvt_pk_bf16_f32 v159, v142, v143
    s_waitcnt vmcnt(16)
    s_nop 0
    v_mfma_f32_32x32x16_bf16 v[120:135], v[156:159], a[64:67], v[120:135]
    v_add_f32 v113, 1e-6, v113
    v_rcp_f32 v113, v113
    s_nop 0
    v_mul_f32 v204, v104, v113
    v_mul_f32 v205, v105, v113
    v_cvt_pk_bf16_f32 v191, v204, v205
    v_mul_f32 v206, v106, v113
    v_mul_f32 v207, v107, v113
    v_cvt_pk_bf16_f32 v192, v206, v207
    v_mul_f32 v208, v108, v113
    v_mul_f32 v209, v109, v113
    v_cvt_pk_bf16_f32 v193, v208, v209
    v_mul_f32 v200, v110, v113
    v_mul_f32 v201, v111, v113
    v_cvt_pk_bf16_f32 v194, v200, v201
    v_mul_f32 v202, v112, v113
    s_nop 0
    ds_write_b128 v225, v[188:191] offset:6144
    v_mfma_f32_32x32x16_bf16 v[40:55], a[96:99], v[188:191], v[40:55]
    v_mfma_f32_32x32x16_bf16 v[24:39], a[132:135], v[188:191], v[24:39]
    v_mfma_f32_32x32x16_bf16 v[8:23], a[168:171], v[188:191], v[8:23]
    s_waitcnt lgkmcnt(1)
    v_cvt_pk_bf16_f32 v160, v144, v145
    v_cvt_pk_bf16_f32 v161, v146, v147
    v_cvt_pk_bf16_f32 v162, v148, v149
    v_cvt_pk_bf16_f32 v163, v150, v151
    s_waitcnt vmcnt(15)
    s_nop 0
    v_mfma_f32_32x32x16_bf16 v[120:135], v[160:163], a[68:71], v[120:135]
    v_add_u32 v223, s31, v222
    v_add_u32 v224, s32, v222
    v_add_u32 v233, s33, v222
    v_add_u32 v1, s28, v227
    s_and_b32 s25, s20, 1
    s_lshl_b32 s25, s25, 11
    v_add_u32 v226, s25, v222
    v_add_u32 v2, 61440, v227
    v_add_u32 v3, 61440, v226
    s_nop 2
    v_add_f32 v129, 1e-6, v129
    v_rcp_f32 v129, v129
    s_nop 0
    v_mul_f32 v203, v120, v129
    v_cvt_pk_bf16_f32 v195, v202, v203
    v_mul_f32 v204, v121, v129
    v_mul_f32 v205, v122, v129
    v_cvt_pk_bf16_f32 v196, v204, v205
    v_mul_f32 v206, v123, v129
    v_mul_f32 v207, v124, v129
    v_cvt_pk_bf16_f32 v197, v206, v207
    v_mul_f32 v208, v125, v129
    v_mul_f32 v209, v126, v129
    v_cvt_pk_bf16_f32 v198, v208, v209
    v_mul_f32 v200, v127, v129
    v_mul_f32 v201, v128, v129
    v_cvt_pk_bf16_f32 v199, v200, v201
    s_nop 0
    ds_write_b128 v225, v[192:195] offset:7168
    v_mfma_f32_32x32x16_bf16 v[40:55], a[100:103], v[192:195], v[40:55]
    v_mfma_f32_32x32x16_bf16 v[24:39], a[136:139], v[192:195], v[24:39]
    v_mfma_f32_32x32x16_bf16 v[8:23], a[172:175], v[192:195], v[8:23]
    ds_write_b128 v225, v[196:199] offset:8192
    v_mfma_f32_32x32x16_bf16 v[40:55], a[104:107], v[196:199], v[40:55]
    v_mfma_f32_32x32x16_bf16 v[24:39], a[140:143], v[196:199], v[24:39]
    v_mfma_f32_32x32x16_bf16 v[8:23], a[176:179], v[196:199], v[8:23]
    s_nop 7
    s_nop 1
    ds_write_b64 v1, v[40:41] offset:20480
    ds_write_b128 v225, v[24:27] offset:16384
    ds_write_b128 v225, v[28:31] offset:17408
    ds_write_b128 v225, v[32:35] offset:18432
    ds_write_b128 v225, v[36:39] offset:19456
    s_waitcnt lgkmcnt(0)
    s_barrier
    ds_read_b128 v[56:59], v223 offset:0
    ds_read_b128 v[60:63], v223 offset:1024
    ds_read_b128 v[64:67], v223 offset:2048
    ds_read_b64 v[136:137], v227 offset:20480
    ds_read_b64 v[138:139], v227 offset:51200
    ds_read_b64 v[140:141], v2 offset:20480
    ds_read_b64 v[142:143], v2 offset:51200
    s_waitcnt lgkmcnt(6)
    v_mfma_f32_32x32x16_bf16 v[8:23], a[180:183], v[56:59], v[8:23]
    ds_read_b128 v[68:71], v223 offset:3072
    s_waitcnt lgkmcnt(6)
    v_mfma_f32_32x32x16_bf16 v[8:23], a[184:187], v[60:63], v[8:23]
    ds_read_b128 v[56:59], v223 offset:4096
    s_waitcnt lgkmcnt(6)
    v_mfma_f32_32x32x16_bf16 v[8:23], a[188:191], v[64:67], v[8:23]
    ds_read_b128 v[60:63], v223 offset:5120
    ds_read_b128 v[72:75], v226 offset:16384
    s_waitcnt lgkmcnt(3)
    v_mfma_f32_32x32x16_bf16 v[8:23], a[192:195], v[68:71], v[8:23]
    ds_read_b128 v[64:67], v223 offset:6144
    ds_read_b128 v[76:79], v226 offset:17408
    s_waitcnt lgkmcnt(4)
    v_mfma_f32_32x32x16_bf16 v[8:23], a[196:199], v[56:59], v[8:23]
    ds_read_b128 v[68:71], v223 offset:7168
    ds_read_b128 v[80:83], v226 offset:47104
    s_waitcnt lgkmcnt(5)
    v_mfma_f32_32x32x16_bf16 v[8:23], a[200:203], v[60:63], v[8:23]
    ds_read_b128 v[56:59], v223 offset:8192
    ds_read_b128 v[84:87], v226 offset:48128
    s_waitcnt lgkmcnt(5)
    v_mfma_f32_32x32x16_bf16 v[8:23], a[204:207], v[64:67], v[8:23]
    ds_read_b128 v[60:63], v224 offset:0
    ds_read_b128 v[88:91], v3 offset:16384
    s_waitcnt lgkmcnt(5)
    v_mfma_f32_32x32x16_bf16 v[8:23], a[208:211], v[68:71], v[8:23]
    ds_read_b128 v[64:67], v224 offset:1024
    ds_read_b128 v[92:95], v3 offset:17408
    s_waitcnt lgkmcnt(5)
    v_mfma_f32_32x32x16_bf16 v[8:23], a[212:215], v[56:59], v[8:23]
    ds_read_b128 v[68:71], v224 offset:2048
    ds_read_b128 v[96:99], v3 offset:47104
    s_waitcnt lgkmcnt(5)
    v_mfma_f32_32x32x16_bf16 v[8:23], a[216:219], v[60:63], v[8:23]
    ds_read_b128 v[56:59], v224 offset:3072
    ds_read_b128 v[100:103], v3 offset:48128
    s_waitcnt lgkmcnt(5)
    v_mfma_f32_32x32x16_bf16 v[8:23], a[220:223], v[64:67], v[8:23]
    ds_read_b128 v[60:63], v224 offset:4096
    s_waitcnt lgkmcnt(4)
    v_mfma_f32_32x32x16_bf16 v[8:23], a[224:227], v[68:71], v[8:23]
    ds_read_b128 v[64:67], v224 offset:5120
    s_waitcnt vmcnt(0)
    v_add_f32 v232, v232, v136
    v_add_f32 v232, v232, v137
    v_add_f32 v232, v232, v138
    v_add_f32 v232, v232, v139
    v_add_f32 v232, v232, v140
    v_add_f32 v232, v232, v141
    v_add_f32 v232, v232, v142
    v_add_f32 v232, v232, v143
    s_waitcnt lgkmcnt(3)
    v_mfma_f32_32x32x16_bf16 v[8:23], a[228:231], v[56:59], v[8:23]
    ds_read_b128 v[68:71], v224 offset:6144
    v_lshlrev_b32 v104, 16, v210
    v_and_b32 v105, 0xffff0000, v210
    v_sub_f32 v104, v104, v232
    v_sub_f32 v105, v105, v232
    s_waitcnt lgkmcnt(2)
    v_mfma_f32_32x32x16_bf16 v[8:23], a[232:235], v[60:63], v[8:23]
    ds_read_b128 v[56:59], v224 offset:7168
    v_lshlrev_b32 v106, 16, v211
    v_and_b32 v107, 0xffff0000, v211
    v_sub_f32 v106, v106, v232
    v_sub_f32 v107, v107, v232
    s_waitcnt lgkmcnt(2)
    v_mfma_f32_32x32x16_bf16 v[8:23], a[236:239], v[64:67], v[8:23]
    ds_read_b128 v[60:63], v224 offset:8192
    v_lshlrev_b32 v108, 16, v212
    v_and_b32 v109, 0xffff0000, v212
    v_sub_f32 v108, v108, v232
    v_sub_f32 v109, v109, v232
    s_waitcnt lgkmcnt(2)
    v_mfma_f32_32x32x16_bf16 v[8:23], a[240:243], v[68:71], v[8:23]
    ds_read_b128 v[64:67], v233 offset:0
    v_lshlrev_b32 v110, 16, v213
    v_and_b32 v111, 0xffff0000, v213
    v_sub_f32 v110, v110, v232
    v_sub_f32 v111, v111, v232
    s_waitcnt lgkmcnt(2)
    v_mfma_f32_32x32x16_bf16 v[8:23], a[244:247], v[56:59], v[8:23]
    ds_read_b128 v[68:71], v233 offset:1024
    v_lshlrev_b32 v112, 16, v214
    v_and_b32 v113, 0xffff0000, v214
    v_sub_f32 v112, v112, v232
    v_sub_f32 v113, v113, v232
    s_waitcnt lgkmcnt(2)
    v_mfma_f32_32x32x16_bf16 v[8:23], a[248:251], v[60:63], v[8:23]
    ds_read_b128 v[56:59], v233 offset:2048
    v_lshlrev_b32 v114, 16, v215
    v_and_b32 v115, 0xffff0000, v215
    v_sub_f32 v114, v114, v232
    v_sub_f32 v115, v115, v232
    s_waitcnt lgkmcnt(2)
    v_mfma_f32_32x32x16_bf16 v[8:23], a[252:255], v[64:67], v[8:23]
    ds_read_b128 v[60:63], v233 offset:3072
    v_lshlrev_b32 v116, 16, v216
    v_and_b32 v117, 0xffff0000, v216
    v_sub_f32 v116, v116, v232
    v_sub_f32 v117, v117, v232
    s_waitcnt vmcnt(14)
    s_waitcnt lgkmcnt(2)
    v_mfma_f32_32x32x16_bf16 v[8:23], a[0:3], v[68:71], v[8:23]
    ds_read_b128 v[64:67], v233 offset:4096
    v_lshlrev_b32 v118, 16, v217
    v_and_b32 v119, 0xffff0000, v217
    v_sub_f32 v118, v118, v232
    v_sub_f32 v119, v119, v232
    s_waitcnt vmcnt(13)
    s_waitcnt lgkmcnt(2)
    v_mfma_f32_32x32x16_bf16 v[8:23], a[4:7], v[56:59], v[8:23]
    ds_read_b128 v[68:71], v233 offset:5120
    s_waitcnt vmcnt(12)
    s_waitcnt lgkmcnt(2)
    v_mfma_f32_32x32x16_bf16 v[8:23], a[8:11], v[60:63], v[8:23]
    ds_read_b128 v[56:59], v233 offset:6144
    s_waitcnt vmcnt(11)
    s_waitcnt lgkmcnt(2)
    v_mfma_f32_32x32x16_bf16 v[8:23], a[12:15], v[64:67], v[8:23]
    ds_read_b128 v[60:63], v233 offset:7168
    s_waitcnt vmcnt(10)
    s_waitcnt lgkmcnt(2)
    v_mfma_f32_32x32x16_bf16 v[8:23], a[16:19], v[68:71], v[8:23]
    ds_read_b128 v[64:67], v233 offset:8192
    s_waitcnt vmcnt(9)
    s_waitcnt lgkmcnt(2)
    v_mfma_f32_32x32x16_bf16 v[8:23], a[20:23], v[56:59], v[8:23]
    s_waitcnt vmcnt(8)
    s_waitcnt lgkmcnt(1)
    v_mfma_f32_32x32x16_bf16 v[8:23], a[24:27], v[60:63], v[8:23]
    s_waitcnt vmcnt(7)
    s_waitcnt lgkmcnt(0)
    v_mfma_f32_32x32x16_bf16 v[8:23], a[28:31], v[64:67], v[8:23]
    v_mov_b32 v4, 0
    s_cmp_lt_u32 s27, 2
    s_cbranch_scc0 L_attn_out_kernel_no3
    v_lshlrev_b32 v144, 16, v218
    v_and_b32 v145, 0xffff0000, v218
    v_lshlrev_b32 v146, 16, v219
    v_and_b32 v147, 0xffff0000, v219
    v_lshlrev_b32 v148, 16, v220
    v_and_b32 v149, 0xffff0000, v220
    v_lshlrev_b32 v150, 16, v221
    v_and_b32 v151, 0xffff0000, v221
    v_sub_f32 v144, v144, v232
    v_add_f32 v72, v72, v80
    v_add_f32 v88, v88, v96
    v_sub_f32 v145, v145, v232
    v_add_f32 v73, v73, v81
    v_add_f32 v89, v89, v97
    v_sub_f32 v146, v146, v232
    v_add_f32 v74, v74, v82
    v_add_f32 v90, v90, v98
    v_sub_f32 v147, v147, v232
    v_add_f32 v75, v75, v83
    v_add_f32 v91, v91, v99
    v_sub_f32 v148, v148, v232
    v_add_f32 v76, v76, v84
    v_add_f32 v92, v92, v100
    v_sub_f32 v149, v149, v232
    v_add_f32 v77, v77, v85
    v_add_f32 v93, v93, v101
    v_sub_f32 v150, v150, v232
    v_add_f32 v78, v78, v86
    v_add_f32 v94, v94, v102
    v_sub_f32 v151, v151, v232
    v_add_f32 v79, v79, v87
    v_add_f32 v95, v95, v103
    v_add_f32 v72, v72, v88
    v_add_f32 v73, v73, v89
    v_add_f32 v74, v74, v90
    v_add_f32 v75, v75, v91
    v_add_f32 v76, v76, v92
    v_add_f32 v77, v77, v93
    v_add_f32 v78, v78, v94
    v_add_f32 v79, v79, v95
    v_add_f32 v72, v72, v144
    v_add_f32 v73, v73, v145
    v_add_f32 v74, v74, v146
    v_add_f32 v75, v75, v147
    v_add_f32 v76, v76, v148
    v_add_f32 v77, v77, v149
    v_add_f32 v78, v78, v150
    v_add_f32 v79, v79, v151
    v_cvt_pk_bf16_f32 v80, v72, v73
    v_cvt_pk_bf16_f32 v81, v74, v75
    v_cvt_pk_bf16_f32 v82, v76, v77
    v_cvt_pk_bf16_f32 v83, v78, v79
    buffer_store_dwordx4 v[80:83], v229, s[12:15], s44 offen sc1
    v_fmac_f32 v4, v72, v72
    v_fmac_f32 v4, v73, v73
    v_fmac_f32 v4, v74, v74
    v_fmac_f32 v4, v75, v75
    v_fmac_f32 v4, v76, v76
    v_fmac_f32 v4, v77, v77
    v_fmac_f32 v4, v78, v78
    v_fmac_f32 v4, v79, v79
L_attn_out_kernel_no3:
    s_nop 7
    s_nop 1
    v_add_f32 v8, v8, v104
    v_add_f32 v9, v9, v105
    v_add_f32 v10, v10, v106
    v_add_f32 v11, v11, v107
    v_add_f32 v12, v12, v108
    v_add_f32 v13, v13, v109
    v_add_f32 v14, v14, v110
    v_add_f32 v15, v15, v111
    v_add_f32 v16, v16, v112
    v_add_f32 v17, v17, v113
    v_add_f32 v18, v18, v114
    v_add_f32 v19, v19, v115
    v_add_f32 v20, v20, v116
    v_add_f32 v21, v21, v117
    v_add_f32 v22, v22, v118
    v_add_f32 v23, v23, v119
    v_cvt_pk_bf16_f32 v120, v8, v9
    v_cvt_pk_bf16_f32 v121, v10, v11
    v_cvt_pk_bf16_f32 v122, v12, v13
    v_cvt_pk_bf16_f32 v123, v14, v15
    buffer_store_dwordx4 v[120:123], v229, s[12:15], s43 offen offset:0 sc1
    v_cvt_pk_bf16_f32 v124, v16, v17
    v_cvt_pk_bf16_f32 v125, v18, v19
    v_cvt_pk_bf16_f32 v126, v20, v21
    v_cvt_pk_bf16_f32 v127, v22, v23
    buffer_store_dwordx4 v[124:127], v229, s[12:15], s43 offen offset:1024 sc1
    v_fmac_f32 v4, v8, v8
    v_fmac_f32 v4, v9, v9
    v_fmac_f32 v4, v10, v10
    v_fmac_f32 v4, v11, v11
    v_fmac_f32 v4, v12, v12
    v_fmac_f32 v4, v13, v13
    v_fmac_f32 v4, v14, v14
    v_fmac_f32 v4, v15, v15
    v_fmac_f32 v4, v16, v16
    v_fmac_f32 v4, v17, v17
    v_fmac_f32 v4, v18, v18
    v_fmac_f32 v4, v19, v19
    v_fmac_f32 v4, v20, v20
    v_fmac_f32 v4, v21, v21
    v_fmac_f32 v4, v22, v22
    v_fmac_f32 v4, v23, v23
    v_mov_b32 v5, v4
    s_nop 1
    v_permlane32_swap_b32 v4, v5
    s_nop 1
    v_add_f32 v4, v4, v5
    s_lshl_b32 s24, s21, 11
    s_add_u32 s24, s24, 4866048
    buffer_store_dword v4, v231, s[12:15], s24 offen sc1
    s_add_u32 s24, s23, 4857856
    s_add_u32 s25, s22, s20
    s_cmp_eq_u32 s25, 0
    s_cselect_b32 s24, s24, 1073741824
    buffer_store_dword v232, v230, s[12:15], s24 offen sc1
    s_load_dwordx4 s[4:7], s[0:1], 40
    s_load_dwordx2 s[8:9], s[0:1], 56
    s_load_dwordx2 s[10:11], s[0:1], 80
    s_load_dwordx2 s[42:43], s[0:1], 64
    s_mov_b32 s24, s20
    s_and_b32 s33, s2, 3
    s_lshl_b32 s33, s33, 2
    s_bfe_u32 s34, s2, 0x20003
    s_add_u32 s26, s33, s34
    s_and_b32 s27, s26, 1
    s_and_b32 s33, s2, 4
    s_lshl_b32 s33, s33, 1
    s_lshr_b32 s25, s2, 5
    s_add_u32 s25, s25, s33
    s_mul_i32 s33, s26, 576
    s_lshl_b32 s34, s27, 6
    s_add_u32 s28, s33, s34
    s_cmp_eq_u32 s27, 0
    s_cselect_b32 s34, 512, 0
    s_add_u32 s29, s33, s34
    v_lshrrev_b32 v1, 3, v0
    v_and_b32 v2, 7, v0
    v_lshlrev_b32 v3, 1, v1
    v_and_b32 v3, 4, v3
    v_xor_b32 v2, v2, v3
    v_lshlrev_b32 v2, 4, v2
    s_and_b32 s41, s24, 1
    s_mul_i32 s34, s41, 48
    v_add_u32 v3, s34, v1
    v_mul_u32_u24 v3, 9216, v3
    v_add_u32 v233, v3, v2
    v_add_u32 v234, 72704, v233
    v_add_u32 v235, 72704, v234
    v_lshlrev_b32 v242, 4, v0
    s_mul_i32 s30, s24, 6144
    s_lshl_b32 s33, s25, 2
    s_add_u32 s33, s33, s24
    s_mul_i32 s32, s33, 36864
    s_add_u32 s32, s32, 5767168
    s_waitcnt lgkmcnt(0)
    s_cmp_lt_u32 s24, 2
    s_cselect_b32 s12, s4, s6
    s_cselect_b32 s13, s5, s7
    s_mov_b32 s14, 5308416
    s_mov_b32 s15, 0x00020000
    s_mov_b32 s16, s10
    s_mov_b32 s17, s11
    s_mov_b32 s18, 46137344
    s_mov_b32 s19, 0x00020000
    v_mul_u32_u24 v3, 1152, v1
    v_add_u32 v239, v3, v2
    v_add_u32 v240, 8192, v239
    v_lshrrev_b32 v1, 2, v0
    v_and_b32 v2, 3, v0
    v_mul_u32_u24 v3, 1152, v1
    v_lshl_add_u32 v241, v2, 4, v3
    s_mul_i32 s34, s41, 96
    v_add_u32 v1, s34, v1
    v_mul_u32_u24 v1, 9216, v1
    v_lshl_add_u32 v236, v2, 4, v1
    v_add_u32 v237, 146432, v236
    v_add_u32 v238, 146432, v237
    v_lshrrev_b32 v1, 5, v0
    v_bfe_u32 v3, v0, 2, 2
    v_lshl_add_u32 v4, v1, 2, v3
    v_bfe_u32 v5, v0, 4, 1
    v_lshlrev_b32 v5, 5, v5
    v_lshl_add_u32 v5, v2, 3, v5
    v_lshl_add_u32 v230, v4, 6, v5
    v_lshl_add_u32 v224, v4, 7, v5
    v_lshrrev_b32 v3, 1, v3
    v_lshlrev_b32 v3, 6, v3
    v_add_u32 v224, v224, v3
    v_xor_b32 v227, 64, v224
    v_add_u32 v225, 49152, v224
    v_add_u32 v228, 49152, v227
    v_add_u32 v231, 49152, v230
    v_add_u32 v226, 98304, v224
    v_add_u32 v229, 98304, v227
    v_add_u32 v232, 98304, v230
    v_and_b32 v248, 31, v0
    v_lshlrev_b32 v6, 2, v248
    v_lshl_add_u32 v6, v1, 10, v6
    v_mul_u32_u24 v247, 1152, v248
    v_lshl_add_u32 v247, v1, 4, v247
    v_lshlrev_b32 v248, 2, v248
    v_cmp_eq_u32 vcc, 0, v0
    v_mov_b32 v246, 1073741824
    v_mov_b32 v7, 1
    v_cndmask_b32 v246, v246, 0, vcc
    s_sub_u32 s8, s8, 663552
    s_subb_u32 s9, s9, 0
    s_mov_b32 s20, s8
    s_mov_b32 s21, s9
    s_mov_b32 s22, 5971968
    s_mov_b32 s23, 0x00020000
    s_mov_b32 s44, s42
    s_mov_b32 s45, s43
    s_mov_b32 s46, 2359296
    s_mov_b32 s47, 0x00020000
    s_lshr_b32 s34, s26, 1
    s_mul_i32 s35, s34, 2359296
    s_mul_i32 s31, s33, 36864
    s_add_u32 s35, s35, s31
    s_mul_i32 s31, s27, 20480
    s_add_u32 s35, s35, s31
    s_add_u32 s35, s35, 8126464
    s_mul_i32 s31, s27, 640
    s_add_u32 s31, s31, 663552
    s_mul_i32 s36, s26, 331776
    s_add_u32 s36, s36, s31
    s_xor_b32 s34, s26, 1
    s_mul_i32 s38, s34, 331776
    s_add_u32 s38, s38, s31
    s_sub_u32 s38, s38, 331776
    s_cmp_eq_u32 s27, 0
    s_cselect_b32 s31, 0, 36864
    s_cselect_b32 s40, 36864, 0
    s_movk_i32 s3, -64
    s_cselect_b32 s3, 512, s3
    s_add_u32 s36, s36, s31
    s_add_u32 s38, s38, s40
    s_mul_i32 s31, s31, 9
    s_mul_i32 s40, s40, 9
    s_sub_u32 s37, s36, s31
    s_sub_u32 s39, s38, s40
    s_lshl_b32 s31, s25, 4
    s_add_u32 s34, s34, s31
    s_add_u32 s31, s31, s26
    s_lshl_b32 s34, s34, 2
    s_add_u32 s34, s34, s24
    s_lshl_b32 s31, s31, 2
    s_add_u32 s31, s31, s24
    s_mul_i32 s52, s31, 18432
    s_add_u32 s52, s52, 27000832
    s_mul_i32 s53, s34, 18432
    s_add_u32 s53, s53, 27000832
    s_lshl_b32 s54, s31, 5
    s_add_u32 s54, s54, 5005312
    s_lshl_b32 s55, s34, 5
    s_add_u32 s55, s55, 5005312
    s_mul_i32 s48, s25, 384
    s_add_u32 s48, s48, 4997120
    s_cmp_eq_u32 s24, 0
    s_cselect_b32 s49, s48, 1073741824
    s_mov_b32 s51, 0x100000
    s_lshl_b32 s33, s33, 11
    s_add_u32 s33, s33, 4866048
    s_mul_i32 s40, s24, 3072
    s_mul_i32 s34, s41, 55296
    s_lshr_b32 s31, s24, 1
    s_lshl_b32 s31, s31, 7
    s_add_u32 s34, s34, s31
    v_add_u32 v239, s34, v239
    v_add_u32 v240, s34, v240
    s_mul_i32 s4, s24, 55296
    s_lshl_b32 s31, s4, 1
    s_add_u32 s31, s31, s3
    s_add_u32 s31, s31, 64
    v_add_u32 v241, s31, v241
    s_sub_u32 s4, s4, s34
    s_lshl_b32 s56, s25, 2
    s_lshr_b32 s57, s26, 2
    s_add_u32 s57, s57, s56
    s_lshl_b32 s57, s57, 7
    s_add_u32 s57, s57, 5050368
    s_cmp_eq_u32 s24, 0
    s_cselect_b32 s57, s57, 1073741824
    s_add_u32 s56, s56, s24
    s_lshl_b32 s56, s56, 7
    s_add_u32 s56, s56, 5050368
    s_waitcnt vmcnt(0)
    s_barrier
    buffer_atomic_add v7, v246, s[16:19], s57 offen sc1
    s_add_u32 m0, s30, 0
    s_add_u32 s5, s28, 0
    buffer_load_dwordx4 v233, s[12:15], s5 offen lds
    buffer_load_dwordx4 v234, s[12:15], s5 offen offset:1024 lds
    buffer_load_dwordx4 v235, s[12:15], s5 offen offset:2048 lds
    s_add_u32 m0, s30, 3072
    s_add_u32 s5, s28, 221184
    buffer_load_dwordx4 v233, s[12:15], s5 offen lds
    buffer_load_dwordx4 v234, s[12:15], s5 offen offset:1024 lds
    buffer_load_dwordx4 v235, s[12:15], s5 offen offset:2048 lds
    s_add_u32 m0, s30, 24576
    s_add_u32 s5, s28, 884736
    buffer_load_dwordx4 v233, s[12:15], s5 offen lds
    buffer_load_dwordx4 v234, s[12:15], s5 offen offset:1024 lds
    buffer_load_dwordx4 v235, s[12:15], s5 offen offset:2048 lds
    s_add_u32 m0, s30, 27648
    s_add_u32 s5, s28, 1105920
    buffer_load_dwordx4 v233, s[12:15], s5 offen lds
    buffer_load_dwordx4 v234, s[12:15], s5 offen offset:1024 lds
    buffer_load_dwordx4 v235, s[12:15], s5 offen offset:2048 lds
    s_add_u32 m0, s30, 49152
    s_add_u32 s5, s28, 1769472
    buffer_load_dwordx4 v233, s[12:15], s5 offen lds
    buffer_load_dwordx4 v234, s[12:15], s5 offen offset:1024 lds
    buffer_load_dwordx4 v235, s[12:15], s5 offen offset:2048 lds
    s_add_u32 m0, s30, 52224
    s_add_u32 s5, s28, 1990656
    buffer_load_dwordx4 v233, s[12:15], s5 offen lds
    buffer_load_dwordx4 v234, s[12:15], s5 offen offset:1024 lds
    buffer_load_dwordx4 v235, s[12:15], s5 offen offset:2048 lds
    s_add_u32 m0, s30, 73728
    s_add_u32 s5, s28, 2654208
    buffer_load_dwordx4 v233, s[12:15], s5 offen lds
    buffer_load_dwordx4 v234, s[12:15], s5 offen offset:1024 lds
    buffer_load_dwordx4 v235, s[12:15], s5 offen offset:2048 lds
    s_add_u32 m0, s30, 76800
    s_add_u32 s5, s28, 2875392
    buffer_load_dwordx4 v233, s[12:15], s5 offen lds
    buffer_load_dwordx4 v234, s[12:15], s5 offen offset:1024 lds
    buffer_load_dwordx4 v235, s[12:15], s5 offen offset:2048 lds
    buffer_load_dword v249, off, s[16:19], s56 offset:0 sc1
    s_waitcnt vmcnt(0)
L_ffn_kernel_pch:
    v_readfirstlane_b32 s50, v249
    s_sub_u32 s51, s51, 1
    s_cselect_b32 s50, 4, s50
    s_cmp_ge_u32 s50, 4
    s_cbranch_scc1 L_ffn_kernel_pdh
    buffer_load_dword v249, off, s[16:19], s56 offset:0 sc1
    s_waitcnt vmcnt(0)
    s_branch L_ffn_kernel_pch
L_ffn_kernel_pdh:
    buffer_load_dwordx4 a[0:3], v242, s[16:19], s32 offen sc1
    buffer_load_dwordx4 a[4:7], v242, s[16:19], s32 offen offset:1024 sc1
    buffer_load_dwordx4 a[8:11], v242, s[16:19], s32 offen offset:2048 sc1
    buffer_load_dwordx4 a[12:15], v242, s[16:19], s32 offen offset:3072 sc1
    s_add_u32 s32, s32, 4096
    buffer_load_dwordx4 a[16:19], v242, s[16:19], s32 offen sc1
    buffer_load_dwordx4 a[20:23], v242, s[16:19], s32 offen offset:1024 sc1
    buffer_load_dwordx4 a[24:27], v242, s[16:19], s32 offen offset:2048 sc1
    buffer_load_dwordx4 a[28:31], v242, s[16:19], s32 offen offset:3072 sc1
    s_barrier
    ds_read_b64_tr_b16 a[144:145], v224 offset:0
    ds_read_b64_tr_b16 a[146:147], v224 offset:1024
    ds_read_b64_tr_b16 a[148:149], v224 offset:12288
    ds_read_b64_tr_b16 a[150:151], v224 offset:13312
    ds_read_b64_tr_b16 a[152:153], v227 offset:0
    ds_read_b64_tr_b16 a[154:155], v227 offset:1024
    ds_read_b64_tr_b16 a[156:157], v227 offset:12288
    ds_read_b64_tr_b16 a[158:159], v227 offset:13312
    ds_read_b64_tr_b16 a[160:161], v224 offset:2048
    ds_read_b64_tr_b16 a[162:163], v224 offset:3072
    ds_read_b64_tr_b16 a[164:165], v224 offset:14336
    ds_read_b64_tr_b16 a[166:167], v224 offset:15360
    s_waitcnt vmcnt(7)
    s_waitcnt lgkmcnt(8)
    v_mfma_f32_32x32x16_bf16 v[8:23], a[144:147], a[0:3], 0
    ds_read_b64_tr_b16 a[168:169], v227 offset:2048
    ds_read_b64_tr_b16 a[170:171], v227 offset:3072
    s_add_u32 s32, s32, 4096
    v_mfma_f32_32x32x16_bf16 v[24:39], a[148:151], a[0:3], 0
    ds_read_b64_tr_b16 a[172:173], v227 offset:14336
    ds_read_b64_tr_b16 a[174:175], v227 offset:15360
    buffer_load_dwordx4 a[32:35], v242, s[16:19], s32 offen sc1
    s_waitcnt lgkmcnt(8)
    v_mfma_f32_32x32x16_bf16 v[40:55], a[152:155], a[0:3], 0
    ds_read_b64_tr_b16 a[144:145], v224 offset:4096
    ds_read_b64_tr_b16 a[146:147], v224 offset:5120
    buffer_load_dwordx4 a[36:39], v242, s[16:19], s32 offen offset:1024 sc1
    v_mfma_f32_32x32x16_bf16 v[56:71], a[156:159], a[0:3], 0
    ds_read_b64_tr_b16 a[148:149], v224 offset:16384
    ds_read_b64_tr_b16 a[150:151], v224 offset:17408
    buffer_load_dwordx4 a[40:43], v242, s[16:19], s32 offen offset:2048 sc1
    s_waitcnt vmcnt(9)
    s_waitcnt lgkmcnt(8)
    v_mfma_f32_32x32x16_bf16 v[8:23], a[160:163], a[4:7], v[8:23]
    ds_read_b64_tr_b16 a[152:153], v227 offset:4096
    ds_read_b64_tr_b16 a[154:155], v227 offset:5120
    buffer_load_dwordx4 a[44:47], v242, s[16:19], s32 offen offset:3072 sc1
    v_mfma_f32_32x32x16_bf16 v[24:39], a[164:167], a[4:7], v[24:39]
    ds_read_b64_tr_b16 a[156:157], v227 offset:16384
    ds_read_b64_tr_b16 a[158:159], v227 offset:17408
    s_add_u32 s32, s32, 4096
    s_waitcnt lgkmcnt(8)
    v_mfma_f32_32x32x16_bf16 v[40:55], a[168:171], a[4:7], v[40:55]
    ds_read_b64_tr_b16 a[160:161], v224 offset:6144
    ds_read_b64_tr_b16 a[162:163], v224 offset:7168
    buffer_load_dwordx4 a[48:51], v242, s[16:19], s32 offen sc1
    v_mfma_f32_32x32x16_bf16 v[56:71], a[172:175], a[4:7], v[56:71]
    ds_read_b64_tr_b16 a[164:165], v224 offset:18432
    ds_read_b64_tr_b16 a[166:167], v224 offset:19456
    buffer_load_dwordx4 a[52:55], v242, s[16:19], s32 offen offset:1024 sc1
    s_waitcnt vmcnt(11)
    s_waitcnt lgkmcnt(8)
    v_mfma_f32_32x32x16_bf16 v[8:23], a[144:147], a[8:11], v[8:23]
    ds_read_b64_tr_b16 a[168:169], v227 offset:6144
    ds_read_b64_tr_b16 a[170:171], v227 offset:7168
    buffer_load_dwordx4 a[56:59], v242, s[16:19], s32 offen offset:2048 sc1
    v_mfma_f32_32x32x16_bf16 v[24:39], a[148:151], a[8:11], v[24:39]
    ds_read_b64_tr_b16 a[172:173], v227 offset:18432
    ds_read_b64_tr_b16 a[174:175], v227 offset:19456
    buffer_load_dwordx4 a[60:63], v242, s[16:19], s32 offen offset:3072 sc1
    s_waitcnt lgkmcnt(8)
    v_mfma_f32_32x32x16_bf16 v[40:55], a[152:155], a[8:11], v[40:55]
    ds_read_b64_tr_b16 a[144:145], v224 offset:8192
    ds_read_b64_tr_b16 a[146:147], v224 offset:9216
    v_mfma_f32_32x32x16_bf16 v[56:71], a[156:159], a[8:11], v[56:71]
    ds_read_b64_tr_b16 a[148:149], v224 offset:20480
    ds_read_b64_tr_b16 a[150:151], v224 offset:21504
    s_add_u32 s32, s32, 4096
    s_waitcnt vmcnt(12)
    s_waitcnt lgkmcnt(8)
    v_mfma_f32_32x32x16_bf16 v[8:23], a[160:163], a[12:15], v[8:23]
    ds_read_b64_tr_b16 a[152:153], v227 offset:8192
    ds_read_b64_tr_b16 a[154:155], v227 offset:9216
    buffer_load_dwordx4 a[64:67], v242, s[16:19], s32 offen sc1
    v_mfma_f32_32x32x16_bf16 v[24:39], a[164:167], a[12:15], v[24:39]
    ds_read_b64_tr_b16 a[156:157], v227 offset:20480
    ds_read_b64_tr_b16 a[158:159], v227 offset:21504
    buffer_load_dwordx4 a[68:71], v242, s[16:19], s32 offen offset:1024 sc1
    s_waitcnt lgkmcnt(8)
    v_mfma_f32_32x32x16_bf16 v[40:55], a[168:171], a[12:15], v[40:55]
    ds_read_b64_tr_b16 a[160:161], v224 offset:10240
    ds_read_b64_tr_b16 a[162:163], v224 offset:11264
    buffer_load_dwordx4 a[72:75], v242, s[16:19], s32 offen offset:2048 sc1
    v_mfma_f32_32x32x16_bf16 v[56:71], a[172:175], a[12:15], v[56:71]
    ds_read_b64_tr_b16 a[164:165], v224 offset:22528
    ds_read_b64_tr_b16 a[166:167], v224 offset:23552
    buffer_load_dwordx4 a[76:79], v242, s[16:19], s32 offen offset:3072 sc1
    s_waitcnt vmcnt(15)
    s_waitcnt lgkmcnt(8)
    v_mfma_f32_32x32x16_bf16 v[8:23], a[144:147], a[16:19], v[8:23]
    ds_read_b64_tr_b16 a[168:169], v227 offset:10240
    ds_read_b64_tr_b16 a[170:171], v227 offset:11264
    s_add_u32 s32, s32, 4096
    v_mfma_f32_32x32x16_bf16 v[24:39], a[148:151], a[16:19], v[24:39]
    ds_read_b64_tr_b16 a[172:173], v227 offset:22528
    ds_read_b64_tr_b16 a[174:175], v227 offset:23552
    buffer_load_dwordx4 a[80:83], v242, s[16:19], s32 offen sc1
    s_waitcnt lgkmcnt(8)
    v_mfma_f32_32x32x16_bf16 v[40:55], a[152:155], a[16:19], v[40:55]
    ds_read_b64_tr_b16 a[144:145], v224 offset:24576
    ds_read_b64_tr_b16 a[146:147], v224 offset:25600
    buffer_load_dwordx4 a[84:87], v242, s[16:19], s32 offen offset:1024 sc1
    v_mfma_f32_32x32x16_bf16 v[56:71], a[156:159], a[16:19], v[56:71]
    ds_read_b64_tr_b16 a[148:149], v224 offset:36864
    ds_read_b64_tr_b16 a[150:151], v224 offset:37888
    buffer_load_dwordx4 a[88:91], v242, s[16:19], s32 offen offset:2048 sc1
    s_waitcnt vmcnt(17)
    s_waitcnt lgkmcnt(8)
    v_mfma_f32_32x32x16_bf16 v[8:23], a[160:163], a[20:23], v[8:23]
    ds_read_b64_tr_b16 a[152:153], v227 offset:24576
    ds_read_b64_tr_b16 a[154:155], v227 offset:25600
    buffer_load_dwordx4 a[92:95], v242, s[16:19], s32 offen offset:3072 sc1
    v_mfma_f32_32x32x16_bf16 v[24:39], a[164:167], a[20:23], v[24:39]
    ds_read_b64_tr_b16 a[156:157], v227 offset:36864
    ds_read_b64_tr_b16 a[158:159], v227 offset:37888
    s_waitcnt lgkmcnt(8)
    v_mfma_f32_32x32x16_bf16 v[40:55], a[168:171], a[20:23], v[40:55]
    ds_read_b64_tr_b16 a[160:161], v224 offset:26624
    ds_read_b64_tr_b16 a[162:163], v224 offset:27648
    v_mfma_f32_32x32x16_bf16 v[56:71], a[172:175], a[20:23], v[56:71]
    ds_read_b64_tr_b16 a[164:165], v224 offset:38912
    ds_read_b64_tr_b16 a[166:167], v224 offset:39936
    s_waitcnt vmcnt(31)
    s_barrier
    s_waitcnt vmcnt(17)
    s_waitcnt lgkmcnt(8)
    v_mfma_f32_32x32x16_bf16 v[8:23], a[144:147], a[24:27], v[8:23]
    ds_read_b64_tr_b16 a[168:169], v227 offset:26624
    ds_read_b64_tr_b16 a[170:171], v227 offset:27648
    s_add_u32 m0, s30, 98304
    s_add_u32 s5, s28, 3538944
    buffer_load_dwordx4 v233, s[12:15], s5 offen lds
    buffer_load_dwordx4 v234, s[12:15], s5 offen offset:1024 lds
    buffer_load_dwordx4 v235, s[12:15], s5 offen offset:2048 lds
    v_mfma_f32_32x32x16_bf16 v[24:39], a[148:151], a[24:27], v[24:39]
    ds_read_b64_tr_b16 a[172:173], v227 offset:38912
    ds_read_b64_tr_b16 a[174:175], v227 offset:39936
    s_waitcnt lgkmcnt(8)
    v_mfma_f32_32x32x16_bf16 v[40:55], a[152:155], a[24:27], v[40:55]
    ds_read_b64_tr_b16 a[144:145], v224 offset:28672
    ds_read_b64_tr_b16 a[146:147], v224 offset:29696
    s_add_u32 m0, s30, 101376
    s_add_u32 s5, s28, 3760128
    buffer_load_dwordx4 v233, s[12:15], s5 offen lds
    buffer_load_dwordx4 v234, s[12:15], s5 offen offset:1024 lds
    buffer_load_dwordx4 v235, s[12:15], s5 offen offset:2048 lds
    v_mfma_f32_32x32x16_bf16 v[56:71], a[156:159], a[24:27], v[56:71]
    ds_read_b64_tr_b16 a[148:149], v224 offset:40960
    ds_read_b64_tr_b16 a[150:151], v224 offset:41984
    s_waitcnt vmcnt(22)
    s_waitcnt lgkmcnt(8)
    v_mfma_f32_32x32x16_bf16 v[8:23], a[160:163], a[28:31], v[8:23]
    ds_read_b64_tr_b16 a[152:153], v227 offset:28672
    ds_read_b64_tr_b16 a[154:155], v227 offset:29696
    s_add_u32 s32, s32, 4096
    v_mfma_f32_32x32x16_bf16 v[24:39], a[164:167], a[28:31], v[24:39]
    ds_read_b64_tr_b16 a[156:157], v227 offset:40960
    ds_read_b64_tr_b16 a[158:159], v227 offset:41984
    s_waitcnt lgkmcnt(8)
    v_mfma_f32_32x32x16_bf16 v[40:55], a[168:171], a[28:31], v[40:55]
    ds_read_b64_tr_b16 a[160:161], v224 offset:30720
    ds_read_b64_tr_b16 a[162:163], v224 offset:31744
    buffer_load_dwordx4 a[96:99], v242, s[16:19], s32 offen sc1
    v_mfma_f32_32x32x16_bf16 v[56:71], a[172:175], a[28:31], v[56:71]
    ds_read_b64_tr_b16 a[164:165], v224 offset:43008
    ds_read_b64_tr_b16 a[166:167], v224 offset:44032
    s_waitcnt vmcnt(22)
    s_waitcnt lgkmcnt(8)
    v_mfma_f32_32x32x16_bf16 v[8:23], a[144:147], a[32:35], v[8:23]
    ds_read_b64_tr_b16 a[168:169], v227 offset:30720
    ds_read_b64_tr_b16 a[170:171], v227 offset:31744
    buffer_load_dwordx4 a[100:103], v242, s[16:19], s32 offen offset:1024 sc1
    v_mfma_f32_32x32x16_bf16 v[24:39], a[148:151], a[32:35], v[24:39]
    ds_read_b64_tr_b16 a[172:173], v227 offset:43008
    ds_read_b64_tr_b16 a[174:175], v227 offset:44032
    s_waitcnt lgkmcnt(8)
    v_mfma_f32_32x32x16_bf16 v[40:55], a[152:155], a[32:35], v[40:55]
    ds_read_b64_tr_b16 a[144:145], v224 offset:32768
    ds_read_b64_tr_b16 a[146:147], v224 offset:33792
    buffer_load_dwordx4 a[104:107], v242, s[16:19], s32 offen offset:2048 sc1
    v_mfma_f32_32x32x16_bf16 v[56:71], a[156:159], a[32:35], v[56:71]
    ds_read_b64_tr_b16 a[148:149], v224 offset:45056
    ds_read_b64_tr_b16 a[150:151], v224 offset:46080
    s_waitcnt vmcnt(23)
    s_waitcnt lgkmcnt(8)
    v_mfma_f32_32x32x16_bf16 v[8:23], a[160:163], a[36:39], v[8:23]
    ds_read_b64_tr_b16 a[152:153], v227 offset:32768
    ds_read_b64_tr_b16 a[154:155], v227 offset:33792
    buffer_load_dwordx4 a[108:111], v242, s[16:19], s32 offen offset:3072 sc1
    v_mfma_f32_32x32x16_bf16 v[24:39], a[164:167], a[36:39], v[24:39]
    ds_read_b64_tr_b16 a[156:157], v227 offset:45056
    ds_read_b64_tr_b16 a[158:159], v227 offset:46080
    s_waitcnt lgkmcnt(8)
    v_mfma_f32_32x32x16_bf16 v[40:55], a[168:171], a[36:39], v[40:55]
    ds_read_b64_tr_b16 a[160:161], v224 offset:34816
    ds_read_b64_tr_b16 a[162:163], v224 offset:35840
    s_add_u32 s32, s32, 4096
    v_mfma_f32_32x32x16_bf16 v[56:71], a[172:175], a[36:39], v[56:71]
    ds_read_b64_tr_b16 a[164:165], v224 offset:47104
    ds_read_b64_tr_b16 a[166:167], v224 offset:48128
    s_waitcnt vmcnt(23)
    s_waitcnt lgkmcnt(8)
    v_mfma_f32_32x32x16_bf16 v[8:23], a[144:147], a[40:43], v[8:23]
    ds_read_b64_tr_b16 a[168:169], v227 offset:34816
    ds_read_b64_tr_b16 a[170:171], v227 offset:35840
    buffer_load_dwordx4 a[112:115], v242, s[16:19], s32 offen sc1
    v_mfma_f32_32x32x16_bf16 v[24:39], a[148:151], a[40:43], v[24:39]
    ds_read_b64_tr_b16 a[172:173], v227 offset:47104
    ds_read_b64_tr_b16 a[174:175], v227 offset:48128
    s_waitcnt lgkmcnt(8)
    v_mfma_f32_32x32x16_bf16 v[40:55], a[152:155], a[40:43], v[40:55]
    ds_read_b64_tr_b16 a[144:145], v225 offset:0
    ds_read_b64_tr_b16 a[146:147], v225 offset:1024
    buffer_load_dwordx4 a[116:119], v242, s[16:19], s32 offen offset:1024 sc1
    v_mfma_f32_32x32x16_bf16 v[56:71], a[156:159], a[40:43], v[56:71]
    ds_read_b64_tr_b16 a[148:149], v225 offset:12288
    ds_read_b64_tr_b16 a[150:151], v225 offset:13312
    s_waitcnt vmcnt(24)
    s_waitcnt lgkmcnt(8)
    v_mfma_f32_32x32x16_bf16 v[8:23], a[160:163], a[44:47], v[8:23]
    ds_read_b64_tr_b16 a[152:153], v228 offset:0
    ds_read_b64_tr_b16 a[154:155], v228 offset:1024
    v_mfma_f32_32x32x16_bf16 v[24:39], a[164:167], a[44:47], v[24:39]
    ds_read_b64_tr_b16 a[156:157], v228 offset:12288
    ds_read_b64_tr_b16 a[158:159], v228 offset:13312
    s_waitcnt lgkmcnt(8)
    v_mfma_f32_32x32x16_bf16 v[40:55], a[168:171], a[44:47], v[40:55]
    ds_read_b64_tr_b16 a[160:161], v225 offset:2048
    ds_read_b64_tr_b16 a[162:163], v225 offset:3072
    v_mfma_f32_32x32x16_bf16 v[56:71], a[172:175], a[44:47], v[56:71]
    ds_read_b64_tr_b16 a[164:165], v225 offset:14336
    ds_read_b64_tr_b16 a[166:167], v225 offset:15360
    s_waitcnt vmcnt(37)
    s_barrier
    s_waitcnt vmcnt(23)
    s_waitcnt lgkmcnt(8)
    v_mfma_f32_32x32x16_bf16 v[8:23], a[144:147], a[48:51], v[8:23]
    ds_read_b64_tr_b16 a[168:169], v228 offset:2048
    ds_read_b64_tr_b16 a[170:171], v228 offset:3072
    s_add_u32 m0, s30, 122880
    s_add_u32 s5, s28, 4423680
    buffer_load_dwordx4 v233, s[12:15], s5 offen lds
    buffer_load_dwordx4 v234, s[12:15], s5 offen offset:1024 lds
    buffer_load_dwordx4 v235, s[12:15], s5 offen offset:2048 lds
    v_mfma_f32_32x32x16_bf16 v[24:39], a[148:151], a[48:51], v[24:39]
    ds_read_b64_tr_b16 a[172:173], v228 offset:14336
    ds_read_b64_tr_b16 a[174:175], v228 offset:15360
    s_waitcnt lgkmcnt(8)
    v_mfma_f32_32x32x16_bf16 v[40:55], a[152:155], a[48:51], v[40:55]
    ds_read_b64_tr_b16 a[144:145], v225 offset:4096
    ds_read_b64_tr_b16 a[146:147], v225 offset:5120
    s_add_u32 m0, s30, 125952
    s_add_u32 s5, s28, 4644864
    buffer_load_dwordx4 v233, s[12:15], s5 offen lds
    buffer_load_dwordx4 v234, s[12:15], s5 offen offset:1024 lds
    buffer_load_dwordx4 v235, s[12:15], s5 offen offset:2048 lds
    v_mfma_f32_32x32x16_bf16 v[56:71], a[156:159], a[48:51], v[56:71]
    ds_read_b64_tr_b16 a[148:149], v225 offset:16384
    ds_read_b64_tr_b16 a[150:151], v225 offset:17408
    s_waitcnt vmcnt(28)
    s_waitcnt lgkmcnt(8)
    v_mfma_f32_32x32x16_bf16 v[8:23], a[160:163], a[52:55], v[8:23]
    ds_read_b64_tr_b16 a[152:153], v228 offset:4096
    ds_read_b64_tr_b16 a[154:155], v228 offset:5120
    buffer_load_dwordx4 a[120:123], v242, s[16:19], s32 offen offset:2048 sc1
    v_mfma_f32_32x32x16_bf16 v[24:39], a[164:167], a[52:55], v[24:39]
    ds_read_b64_tr_b16 a[156:157], v228 offset:16384
    ds_read_b64_tr_b16 a[158:159], v228 offset:17408
    s_waitcnt lgkmcnt(8)
    v_mfma_f32_32x32x16_bf16 v[40:55], a[168:171], a[52:55], v[40:55]
    ds_read_b64_tr_b16 a[160:161], v225 offset:6144
    ds_read_b64_tr_b16 a[162:163], v225 offset:7168
    buffer_load_dwordx4 a[124:127], v242, s[16:19], s32 offen offset:3072 sc1
    v_mfma_f32_32x32x16_bf16 v[56:71], a[172:175], a[52:55], v[56:71]
    ds_read_b64_tr_b16 a[164:165], v225 offset:18432
    ds_read_b64_tr_b16 a[166:167], v225 offset:19456
    s_waitcnt vmcnt(29)
    s_waitcnt lgkmcnt(8)
    v_mfma_f32_32x32x16_bf16 v[8:23], a[144:147], a[56:59], v[8:23]
    ds_read_b64_tr_b16 a[168:169], v228 offset:6144
    ds_read_b64_tr_b16 a[170:171], v228 offset:7168
    s_add_u32 s32, s32, 4096
    v_mfma_f32_32x32x16_bf16 v[24:39], a[148:151], a[56:59], v[24:39]
    ds_read_b64_tr_b16 a[172:173], v228 offset:18432
    ds_read_b64_tr_b16 a[174:175], v228 offset:19456
    s_waitcnt lgkmcnt(8)
    v_mfma_f32_32x32x16_bf16 v[40:55], a[152:155], a[56:59], v[40:55]
    ds_read_b64_tr_b16 a[144:145], v225 offset:8192
    ds_read_b64_tr_b16 a[146:147], v225 offset:9216
    buffer_load_dwordx4 a[128:131], v242, s[16:19], s32 offen sc1
    v_mfma_f32_32x32x16_bf16 v[56:71], a[156:159], a[56:59], v[56:71]
    ds_read_b64_tr_b16 a[148:149], v225 offset:20480
    ds_read_b64_tr_b16 a[150:151], v225 offset:21504
    s_waitcnt vmcnt(29)
    s_waitcnt lgkmcnt(8)
    v_mfma_f32_32x32x16_bf16 v[8:23], a[160:163], a[60:63], v[8:23]
    ds_read_b64_tr_b16 a[152:153], v228 offset:8192
    ds_read_b64_tr_b16 a[154:155], v228 offset:9216
    buffer_load_dwordx4 a[132:135], v242, s[16:19], s32 offen offset:1024 sc1
    v_mfma_f32_32x32x16_bf16 v[24:39], a[164:167], a[60:63], v[24:39]
    ds_read_b64_tr_b16 a[156:157], v228 offset:20480
    ds_read_b64_tr_b16 a[158:159], v228 offset:21504
    s_waitcnt lgkmcnt(8)
    v_mfma_f32_32x32x16_bf16 v[40:55], a[168:171], a[60:63], v[40:55]
    ds_read_b64_tr_b16 a[160:161], v225 offset:10240
    ds_read_b64_tr_b16 a[162:163], v225 offset:11264
    buffer_load_dwordx4 a[136:139], v242, s[16:19], s32 offen offset:2048 sc1
    v_mfma_f32_32x32x16_bf16 v[56:71], a[172:175], a[60:63], v[56:71]
    ds_read_b64_tr_b16 a[164:165], v225 offset:22528
    ds_read_b64_tr_b16 a[166:167], v225 offset:23552
    s_waitcnt vmcnt(30)
    s_waitcnt lgkmcnt(8)
    v_mfma_f32_32x32x16_bf16 v[8:23], a[144:147], a[64:67], v[8:23]
    ds_read_b64_tr_b16 a[168:169], v228 offset:10240
    ds_read_b64_tr_b16 a[170:171], v228 offset:11264
    buffer_load_dwordx4 a[140:143], v242, s[16:19], s32 offen offset:3072 sc1
    v_mfma_f32_32x32x16_bf16 v[24:39], a[148:151], a[64:67], v[24:39]
    ds_read_b64_tr_b16 a[172:173], v228 offset:22528
    ds_read_b64_tr_b16 a[174:175], v228 offset:23552
    s_waitcnt lgkmcnt(8)
    v_mfma_f32_32x32x16_bf16 v[40:55], a[152:155], a[64:67], v[40:55]
    ds_read_b64_tr_b16 a[144:145], v225 offset:24576
    ds_read_b64_tr_b16 a[146:147], v225 offset:25600
    buffer_load_dword v208, v6, s[16:19], s33 offen offset:0 sc1
    buffer_load_dword v209, v6, s[16:19], s33 offen offset:128 sc1
    buffer_load_dword v210, v6, s[16:19], s33 offen offset:256 sc1
    buffer_load_dword v211, v6, s[16:19], s33 offen offset:384 sc1
    buffer_load_dword v212, v6, s[16:19], s33 offen offset:512 sc1
    buffer_load_dword v213, v6, s[16:19], s33 offen offset:640 sc1
    buffer_load_dword v214, v6, s[16:19], s33 offen offset:768 sc1
    buffer_load_dword v215, v6, s[16:19], s33 offen offset:896 sc1
    v_mfma_f32_32x32x16_bf16 v[56:71], a[156:159], a[64:67], v[56:71]
    ds_read_b64_tr_b16 a[148:149], v225 offset:36864
    ds_read_b64_tr_b16 a[150:151], v225 offset:37888
    s_waitcnt vmcnt(38)
    s_waitcnt lgkmcnt(8)
    v_mfma_f32_32x32x16_bf16 v[8:23], a[160:163], a[68:71], v[8:23]
    ds_read_b64_tr_b16 a[152:153], v228 offset:24576
    ds_read_b64_tr_b16 a[154:155], v228 offset:25600
    v_mfma_f32_32x32x16_bf16 v[24:39], a[164:167], a[68:71], v[24:39]
    ds_read_b64_tr_b16 a[156:157], v228 offset:36864
    ds_read_b64_tr_b16 a[158:159], v228 offset:37888
    s_waitcnt lgkmcnt(8)
    v_mfma_f32_32x32x16_bf16 v[40:55], a[168:171], a[68:71], v[40:55]
    ds_read_b64_tr_b16 a[160:161], v225 offset:26624
    ds_read_b64_tr_b16 a[162:163], v225 offset:27648
    v_mfma_f32_32x32x16_bf16 v[56:71], a[172:175], a[68:71], v[56:71]
    ds_read_b64_tr_b16 a[164:165], v225 offset:38912
    ds_read_b64_tr_b16 a[166:167], v225 offset:39936
    s_waitcnt vmcnt(26)
    s_barrier
    s_waitcnt vmcnt(37)
    s_waitcnt lgkmcnt(8)
    v_mfma_f32_32x32x16_bf16 v[8:23], a[144:147], a[72:75], v[8:23]
    ds_read_b64_tr_b16 a[168:169], v228 offset:26624
    ds_read_b64_tr_b16 a[170:171], v228 offset:27648
    s_add_u32 m0, s30, 0
    s_add_u32 s5, s28, 128
    buffer_load_dwordx4 v233, s[12:15], s5 offen lds
    buffer_load_dwordx4 v234, s[12:15], s5 offen offset:1024 lds
    buffer_load_dwordx4 v235, s[12:15], s5 offen offset:2048 lds
    v_mfma_f32_32x32x16_bf16 v[24:39], a[148:151], a[72:75], v[24:39]
    ds_read_b64_tr_b16 a[172:173], v228 offset:38912
    ds_read_b64_tr_b16 a[174:175], v228 offset:39936
    s_waitcnt lgkmcnt(8)
    v_mfma_f32_32x32x16_bf16 v[40:55], a[152:155], a[72:75], v[40:55]
    ds_read_b64_tr_b16 a[144:145], v225 offset:28672
    ds_read_b64_tr_b16 a[146:147], v225 offset:29696
    v_mfma_f32_32x32x16_bf16 v[56:71], a[156:159], a[72:75], v[56:71]
    ds_read_b64_tr_b16 a[148:149], v225 offset:40960
    ds_read_b64_tr_b16 a[150:151], v225 offset:41984
    s_waitcnt vmcnt(39)
    s_waitcnt lgkmcnt(8)
    v_mfma_f32_32x32x16_bf16 v[8:23], a[160:163], a[76:79], v[8:23]
    ds_read_b64_tr_b16 a[152:153], v228 offset:28672
    ds_read_b64_tr_b16 a[154:155], v228 offset:29696
    s_add_u32 m0, s30, 3072
    s_add_u32 s5, s28, 221312
    buffer_load_dwordx4 v233, s[12:15], s5 offen lds
    buffer_load_dwordx4 v234, s[12:15], s5 offen offset:1024 lds
    buffer_load_dwordx4 v235, s[12:15], s5 offen offset:2048 lds
    v_mfma_f32_32x32x16_bf16 v[24:39], a[164:167], a[76:79], v[24:39]
    ds_read_b64_tr_b16 a[156:157], v228 offset:40960
    ds_read_b64_tr_b16 a[158:159], v228 offset:41984
    s_waitcnt lgkmcnt(8)
    v_mfma_f32_32x32x16_bf16 v[40:55], a[168:171], a[76:79], v[40:55]
    ds_read_b64_tr_b16 a[160:161], v225 offset:30720
    ds_read_b64_tr_b16 a[162:163], v225 offset:31744
    v_mfma_f32_32x32x16_bf16 v[56:71], a[172:175], a[76:79], v[56:71]
    ds_read_b64_tr_b16 a[164:165], v225 offset:43008
    ds_read_b64_tr_b16 a[166:167], v225 offset:44032
    s_waitcnt vmcnt(41)
    s_waitcnt lgkmcnt(8)
    v_mfma_f32_32x32x16_bf16 v[8:23], a[144:147], a[80:83], v[8:23]
    ds_read_b64_tr_b16 a[168:169], v228 offset:30720
    ds_read_b64_tr_b16 a[170:171], v228 offset:31744
    s_add_u32 m0, s30, 24576
    s_add_u32 s5, s28, 884864
    buffer_load_dwordx4 v233, s[12:15], s5 offen lds
    buffer_load_dwordx4 v234, s[12:15], s5 offen offset:1024 lds
    buffer_load_dwordx4 v235, s[12:15], s5 offen offset:2048 lds
    v_mfma_f32_32x32x16_bf16 v[24:39], a[148:151], a[80:83], v[24:39]
    ds_read_b64_tr_b16 a[172:173], v228 offset:43008
    ds_read_b64_tr_b16 a[174:175], v228 offset:44032
    s_waitcnt lgkmcnt(8)
    v_mfma_f32_32x32x16_bf16 v[40:55], a[152:155], a[80:83], v[40:55]
    ds_read_b64_tr_b16 a[144:145], v225 offset:32768
    ds_read_b64_tr_b16 a[146:147], v225 offset:33792
    v_mfma_f32_32x32x16_bf16 v[56:71], a[156:159], a[80:83], v[56:71]
    ds_read_b64_tr_b16 a[148:149], v225 offset:45056
    ds_read_b64_tr_b16 a[150:151], v225 offset:46080
    s_waitcnt vmcnt(43)
    s_waitcnt lgkmcnt(8)
    v_mfma_f32_32x32x16_bf16 v[8:23], a[160:163], a[84:87], v[8:23]
    ds_read_b64_tr_b16 a[152:153], v228 offset:32768
    ds_read_b64_tr_b16 a[154:155], v228 offset:33792
    s_add_u32 m0, s30, 27648
    s_add_u32 s5, s28, 1106048
    buffer_load_dwordx4 v233, s[12:15], s5 offen lds
    buffer_load_dwordx4 v234, s[12:15], s5 offen offset:1024 lds
    buffer_load_dwordx4 v235, s[12:15], s5 offen offset:2048 lds
    v_mfma_f32_32x32x16_bf16 v[24:39], a[164:167], a[84:87], v[24:39]
    ds_read_b64_tr_b16 a[156:157], v228 offset:45056
    ds_read_b64_tr_b16 a[158:159], v228 offset:46080
    s_waitcnt lgkmcnt(8)
    v_mfma_f32_32x32x16_bf16 v[40:55], a[168:171], a[84:87], v[40:55]
    ds_read_b64_tr_b16 a[160:161], v225 offset:34816
    ds_read_b64_tr_b16 a[162:163], v225 offset:35840
    v_mfma_f32_32x32x16_bf16 v[56:71], a[172:175], a[84:87], v[56:71]
    ds_read_b64_tr_b16 a[164:165], v225 offset:47104
    ds_read_b64_tr_b16 a[166:167], v225 offset:48128
    s_waitcnt vmcnt(45)
    s_waitcnt lgkmcnt(8)
    v_mfma_f32_32x32x16_bf16 v[8:23], a[144:147], a[88:91], v[8:23]
    ds_read_b64_tr_b16 a[168:169], v228 offset:34816
    ds_read_b64_tr_b16 a[170:171], v228 offset:35840
    v_mfma_f32_32x32x16_bf16 v[24:39], a[148:151], a[88:91], v[24:39]
    ds_read_b64_tr_b16 a[172:173], v228 offset:47104
    ds_read_b64_tr_b16 a[174:175], v228 offset:48128
    s_waitcnt lgkmcnt(8)
    v_mfma_f32_32x32x16_bf16 v[40:55], a[152:155], a[88:91], v[40:55]
    ds_read_b64_tr_b16 a[144:145], v226 offset:0
    ds_read_b64_tr_b16 a[146:147], v226 offset:1024
    v_mfma_f32_32x32x16_bf16 v[56:71], a[156:159], a[88:91], v[56:71]
    ds_read_b64_tr_b16 a[148:149], v226 offset:12288
    ds_read_b64_tr_b16 a[150:151], v226 offset:13312
    s_waitcnt vmcnt(44)
    s_waitcnt lgkmcnt(8)
    v_mfma_f32_32x32x16_bf16 v[8:23], a[160:163], a[92:95], v[8:23]
    ds_read_b64_tr_b16 a[152:153], v229 offset:0
    ds_read_b64_tr_b16 a[154:155], v229 offset:1024
    v_mfma_f32_32x32x16_bf16 v[24:39], a[164:167], a[92:95], v[24:39]
    ds_read_b64_tr_b16 a[156:157], v229 offset:12288
    ds_read_b64_tr_b16 a[158:159], v229 offset:13312
    s_waitcnt lgkmcnt(8)
    v_mfma_f32_32x32x16_bf16 v[40:55], a[168:171], a[92:95], v[40:55]
    ds_read_b64_tr_b16 a[160:161], v226 offset:2048
    ds_read_b64_tr_b16 a[162:163], v226 offset:3072
    v_mfma_f32_32x32x16_bf16 v[56:71], a[172:175], a[92:95], v[56:71]
    ds_read_b64_tr_b16 a[164:165], v226 offset:14336
    ds_read_b64_tr_b16 a[166:167], v226 offset:15360
    s_waitcnt vmcnt(26)
    s_barrier
    s_waitcnt vmcnt(37)
    s_waitcnt lgkmcnt(8)
    v_mfma_f32_32x32x16_bf16 v[8:23], a[144:147], a[96:99], v[8:23]
    ds_read_b64_tr_b16 a[168:169], v229 offset:2048
    ds_read_b64_tr_b16 a[170:171], v229 offset:3072
    s_add_u32 m0, s30, 49152
    s_add_u32 s5, s28, 1769600
    buffer_load_dwordx4 v233, s[12:15], s5 offen lds
    buffer_load_dwordx4 v234, s[12:15], s5 offen offset:1024 lds
    buffer_load_dwordx4 v235, s[12:15], s5 offen offset:2048 lds
    v_mfma_f32_32x32x16_bf16 v[24:39], a[148:151], a[96:99], v[24:39]
    ds_read_b64_tr_b16 a[172:173], v229 offset:14336
    ds_read_b64_tr_b16 a[174:175], v229 offset:15360
    s_waitcnt lgkmcnt(8)
    v_mfma_f32_32x32x16_bf16 v[40:55], a[152:155], a[96:99], v[40:55]
    ds_read_b64_tr_b16 a[144:145], v226 offset:4096
    ds_read_b64_tr_b16 a[146:147], v226 offset:5120
    v_mfma_f32_32x32x16_bf16 v[56:71], a[156:159], a[96:99], v[56:71]
    ds_read_b64_tr_b16 a[148:149], v226 offset:16384
    ds_read_b64_tr_b16 a[150:151], v226 offset:17408
    s_waitcnt vmcnt(39)
    s_waitcnt lgkmcnt(8)
    v_mfma_f32_32x32x16_bf16 v[8:23], a[160:163], a[100:103], v[8:23]
    ds_read_b64_tr_b16 a[152:153], v229 offset:4096
    ds_read_b64_tr_b16 a[154:155], v229 offset:5120
    s_and_b32 s34, s25, 7
    s_lshl_b32 s34, s34, 1
    s_add_u32 s34, s34, s41
    s_mul_i32 s34, s34, 36
    v_min_u32 v1, 35, v0
    v_add_u32 v1, s34, v1
    v_mul_u32_u24 v1, 9216, v1
    s_add_u32 m0, s30, 52224
    s_add_u32 s5, s28, 1990784
    buffer_load_dwordx4 v233, s[12:15], s5 offen lds
    buffer_load_dwordx4 v234, s[12:15], s5 offen offset:1024 lds
    buffer_load_dwordx4 v235, s[12:15], s5 offen offset:2048 lds
    v_mfma_f32_32x32x16_bf16 v[24:39], a[164:167], a[100:103], v[24:39]
    ds_read_b64_tr_b16 a[156:157], v229 offset:16384
    ds_read_b64_tr_b16 a[158:159], v229 offset:17408
    s_waitcnt lgkmcnt(8)
    v_mfma_f32_32x32x16_bf16 v[40:55], a[168:171], a[100:103], v[40:55]
    ds_read_b64_tr_b16 a[160:161], v226 offset:6144
    ds_read_b64_tr_b16 a[162:163], v226 offset:7168
    s_add_u32 s31, s28, 256
    buffer_load_dword v2, v1, s[12:15], s31 offen
    v_mfma_f32_32x32x16_bf16 v[56:71], a[172:175], a[100:103], v[56:71]
    ds_read_b64_tr_b16 a[164:165], v226 offset:18432
    ds_read_b64_tr_b16 a[166:167], v226 offset:19456
    s_waitcnt vmcnt(42)
    s_waitcnt lgkmcnt(8)
    v_mfma_f32_32x32x16_bf16 v[8:23], a[144:147], a[104:107], v[8:23]
    ds_read_b64_tr_b16 a[168:169], v229 offset:6144
    ds_read_b64_tr_b16 a[170:171], v229 offset:7168
    s_add_u32 m0, s30, 73728
    s_add_u32 s5, s28, 2654336
    buffer_load_dwordx4 v233, s[12:15], s5 offen lds
    buffer_load_dwordx4 v234, s[12:15], s5 offen offset:1024 lds
    buffer_load_dwordx4 v235, s[12:15], s5 offen offset:2048 lds
    v_mfma_f32_32x32x16_bf16 v[24:39], a[148:151], a[104:107], v[24:39]
    ds_read_b64_tr_b16 a[172:173], v229 offset:18432
    ds_read_b64_tr_b16 a[174:175], v229 offset:19456
    s_waitcnt lgkmcnt(8)
    v_mfma_f32_32x32x16_bf16 v[40:55], a[152:155], a[104:107], v[40:55]
    ds_read_b64_tr_b16 a[144:145], v226 offset:8192
    ds_read_b64_tr_b16 a[146:147], v226 offset:9216
    v_mfma_f32_32x32x16_bf16 v[56:71], a[156:159], a[104:107], v[56:71]
    ds_read_b64_tr_b16 a[148:149], v226 offset:20480
    ds_read_b64_tr_b16 a[150:151], v226 offset:21504
    s_waitcnt vmcnt(44)
    s_waitcnt lgkmcnt(8)
    v_mfma_f32_32x32x16_bf16 v[8:23], a[160:163], a[108:111], v[8:23]
    ds_read_b64_tr_b16 a[152:153], v229 offset:8192
    ds_read_b64_tr_b16 a[154:155], v229 offset:9216
    s_add_u32 m0, s30, 76800
    s_add_u32 s5, s28, 2875520
    buffer_load_dwordx4 v233, s[12:15], s5 offen lds
    buffer_load_dwordx4 v234, s[12:15], s5 offen offset:1024 lds
    buffer_load_dwordx4 v235, s[12:15], s5 offen offset:2048 lds
    v_mfma_f32_32x32x16_bf16 v[24:39], a[164:167], a[108:111], v[24:39]
    ds_read_b64_tr_b16 a[156:157], v229 offset:20480
    ds_read_b64_tr_b16 a[158:159], v229 offset:21504
    s_waitcnt lgkmcnt(8)
    v_mfma_f32_32x32x16_bf16 v[40:55], a[168:171], a[108:111], v[40:55]
    ds_read_b64_tr_b16 a[160:161], v226 offset:10240
    ds_read_b64_tr_b16 a[162:163], v226 offset:11264
    v_mfma_f32_32x32x16_bf16 v[56:71], a[172:175], a[108:111], v[56:71]
    ds_read_b64_tr_b16 a[164:165], v226 offset:22528
    ds_read_b64_tr_b16 a[166:167], v226 offset:23552
    s_waitcnt vmcnt(46)
    s_waitcnt lgkmcnt(8)
    v_mfma_f32_32x32x16_bf16 v[8:23], a[144:147], a[112:115], v[8:23]
    ds_read_b64_tr_b16 a[168:169], v229 offset:10240
    ds_read_b64_tr_b16 a[170:171], v229 offset:11264
    v_mfma_f32_32x32x16_bf16 v[24:39], a[148:151], a[112:115], v[24:39]
    ds_read_b64_tr_b16 a[172:173], v229 offset:22528
    ds_read_b64_tr_b16 a[174:175], v229 offset:23552
    s_waitcnt lgkmcnt(8)
    v_mfma_f32_32x32x16_bf16 v[40:55], a[152:155], a[112:115], v[40:55]
    ds_read_b64_tr_b16 a[144:145], v226 offset:24576
    ds_read_b64_tr_b16 a[146:147], v226 offset:25600
    v_mfma_f32_32x32x16_bf16 v[56:71], a[156:159], a[112:115], v[56:71]
    ds_read_b64_tr_b16 a[148:149], v226 offset:36864
    ds_read_b64_tr_b16 a[150:151], v226 offset:37888
    s_waitcnt vmcnt(45)
    s_waitcnt lgkmcnt(8)
    v_mfma_f32_32x32x16_bf16 v[8:23], a[160:163], a[116:119], v[8:23]
    ds_read_b64_tr_b16 a[152:153], v229 offset:24576
    ds_read_b64_tr_b16 a[154:155], v229 offset:25600
    v_mfma_f32_32x32x16_bf16 v[24:39], a[164:167], a[116:119], v[24:39]
    ds_read_b64_tr_b16 a[156:157], v229 offset:36864
    ds_read_b64_tr_b16 a[158:159], v229 offset:37888
    s_waitcnt lgkmcnt(8)
    v_mfma_f32_32x32x16_bf16 v[40:55], a[168:171], a[116:119], v[40:55]
    ds_read_b64_tr_b16 a[160:161], v226 offset:26624
    ds_read_b64_tr_b16 a[162:163], v226 offset:27648
    v_mfma_f32_32x32x16_bf16 v[56:71], a[172:175], a[116:119], v[56:71]
    ds_read_b64_tr_b16 a[164:165], v226 offset:38912
    ds_read_b64_tr_b16 a[166:167], v226 offset:39936
    s_waitcnt vmcnt(19)
    s_barrier
    s_waitcnt vmcnt(38)
    s_waitcnt lgkmcnt(8)
    v_mfma_f32_32x32x16_bf16 v[8:23], a[144:147], a[120:123], v[8:23]
    ds_read_b64_tr_b16 a[168:169], v229 offset:26624
    ds_read_b64_tr_b16 a[170:171], v229 offset:27648
    s_add_u32 m0, s30, 98304
    s_add_u32 s5, s28, 3539072
    buffer_load_dwordx4 v233, s[12:15], s5 offen lds
    buffer_load_dwordx4 v234, s[12:15], s5 offen offset:1024 lds
    buffer_load_dwordx4 v235, s[12:15], s5 offen offset:2048 lds
    v_mfma_f32_32x32x16_bf16 v[24:39], a[148:151], a[120:123], v[24:39]
    ds_read_b64_tr_b16 a[172:173], v229 offset:38912
    ds_read_b64_tr_b16 a[174:175], v229 offset:39936
    s_waitcnt lgkmcnt(8)
    v_mfma_f32_32x32x16_bf16 v[40:55], a[152:155], a[120:123], v[40:55]
    ds_read_b64_tr_b16 a[144:145], v226 offset:28672
    ds_read_b64_tr_b16 a[146:147], v226 offset:29696
    v_mfma_f32_32x32x16_bf16 v[56:71], a[156:159], a[120:123], v[56:71]
    ds_read_b64_tr_b16 a[148:149], v226 offset:40960
    ds_read_b64_tr_b16 a[150:151], v226 offset:41984
    s_waitcnt vmcnt(40)
    s_waitcnt lgkmcnt(8)
    v_mfma_f32_32x32x16_bf16 v[8:23], a[160:163], a[124:127], v[8:23]
    ds_read_b64_tr_b16 a[152:153], v229 offset:28672
    ds_read_b64_tr_b16 a[154:155], v229 offset:29696
    s_add_u32 m0, s30, 101376
    s_add_u32 s5, s28, 3760256
    buffer_load_dwordx4 v233, s[12:15], s5 offen lds
    buffer_load_dwordx4 v234, s[12:15], s5 offen offset:1024 lds
    buffer_load_dwordx4 v235, s[12:15], s5 offen offset:2048 lds
    v_mfma_f32_32x32x16_bf16 v[24:39], a[164:167], a[124:127], v[24:39]
    ds_read_b64_tr_b16 a[156:157], v229 offset:40960
    ds_read_b64_tr_b16 a[158:159], v229 offset:41984
    s_waitcnt lgkmcnt(8)
    v_mfma_f32_32x32x16_bf16 v[40:55], a[168:171], a[124:127], v[40:55]
    ds_read_b64_tr_b16 a[160:161], v226 offset:30720
    ds_read_b64_tr_b16 a[162:163], v226 offset:31744
    v_mfma_f32_32x32x16_bf16 v[56:71], a[172:175], a[124:127], v[56:71]
    ds_read_b64_tr_b16 a[164:165], v226 offset:43008
    ds_read_b64_tr_b16 a[166:167], v226 offset:44032
    s_waitcnt vmcnt(42)
    s_waitcnt lgkmcnt(8)
    v_mfma_f32_32x32x16_bf16 v[8:23], a[144:147], a[128:131], v[8:23]
    ds_read_b64_tr_b16 a[168:169], v229 offset:30720
    ds_read_b64_tr_b16 a[170:171], v229 offset:31744
    v_mfma_f32_32x32x16_bf16 v[24:39], a[148:151], a[128:131], v[24:39]
    ds_read_b64_tr_b16 a[172:173], v229 offset:43008
    ds_read_b64_tr_b16 a[174:175], v229 offset:44032
    s_waitcnt lgkmcnt(8)
    v_mfma_f32_32x32x16_bf16 v[40:55], a[152:155], a[128:131], v[40:55]
    ds_read_b64_tr_b16 a[144:145], v226 offset:32768
    ds_read_b64_tr_b16 a[146:147], v226 offset:33792
    s_waitcnt vmcnt(31)
    v_add_f32 v208, v208, v209
    v_add_f32 v208, v208, v210
    v_add_f32 v208, v208, v211
    v_mfma_f32_32x32x16_bf16 v[56:71], a[156:159], a[128:131], v[56:71]
    ds_read_b64_tr_b16 a[148:149], v226 offset:45056
    ds_read_b64_tr_b16 a[150:151], v226 offset:46080
    v_add_f32 v208, v208, v212
    v_add_f32 v208, v208, v213
    v_add_f32 v208, v208, v214
    v_add_f32 v208, v208, v215
    s_waitcnt vmcnt(41)
    s_waitcnt lgkmcnt(8)
    v_mfma_f32_32x32x16_bf16 v[8:23], a[160:163], a[132:135], v[8:23]
    ds_read_b64_tr_b16 a[152:153], v229 offset:32768
    ds_read_b64_tr_b16 a[154:155], v229 offset:33792
    v_mfma_f32_32x32x16_bf16 v[24:39], a[164:167], a[132:135], v[24:39]
    ds_read_b64_tr_b16 a[156:157], v229 offset:45056
    ds_read_b64_tr_b16 a[158:159], v229 offset:46080
    s_waitcnt lgkmcnt(8)
    v_mfma_f32_32x32x16_bf16 v[40:55], a[168:171], a[132:135], v[40:55]
    ds_read_b64_tr_b16 a[160:161], v226 offset:34816
    ds_read_b64_tr_b16 a[162:163], v226 offset:35840
    v_mov_b32 v209, v208
    s_nop 1
    v_permlane32_swap_b32 v208, v209
    s_nop 1
    v_add_f32 v208, v208, v209
    v_mfma_f32_32x32x16_bf16 v[56:71], a[172:175], a[132:135], v[56:71]
    ds_read_b64_tr_b16 a[164:165], v226 offset:47104
    ds_read_b64_tr_b16 a[166:167], v226 offset:48128
    s_waitcnt vmcnt(40)
    s_waitcnt lgkmcnt(8)
    v_mfma_f32_32x32x16_bf16 v[8:23], a[144:147], a[136:139], v[8:23]
    ds_read_b64_tr_b16 a[168:169], v229 offset:34816
    ds_read_b64_tr_b16 a[170:171], v229 offset:35840
    v_mfma_f32_32x32x16_bf16 v[24:39], a[148:151], a[136:139], v[24:39]
    ds_read_b64_tr_b16 a[172:173], v229 offset:47104
    ds_read_b64_tr_b16 a[174:175], v229 offset:48128
    s_waitcnt lgkmcnt(8)
    v_mfma_f32_32x32x16_bf16 v[40:55], a[152:155], a[136:139], v[40:55]
    ds_read_b64_tr_b16 a[144:145], v224 offset:0
    ds_read_b64_tr_b16 a[146:147], v224 offset:1024
    v_mov_b32 v245, 1e-5
    v_fmac_f32 v245, 0.001736111111111111, v208
    v_rsq_f32 v244, v245
    s_nop 0
    v_mul_f32 v244, -1.4426950408889634, v244
    v_mfma_f32_32x32x16_bf16 v[56:71], a[156:159], a[136:139], v[56:71]
    ds_read_b64_tr_b16 a[148:149], v224 offset:12288
    ds_read_b64_tr_b16 a[150:151], v224 offset:13312
    s_waitcnt vmcnt(39)
    s_waitcnt lgkmcnt(8)
    v_mfma_f32_32x32x16_bf16 v[8:23], a[160:163], a[140:143], v[8:23]
    ds_read_b64_tr_b16 a[152:153], v227 offset:0
    ds_read_b64_tr_b16 a[154:155], v227 offset:1024
    v_mfma_f32_32x32x16_bf16 v[24:39], a[164:167], a[140:143], v[24:39]
    ds_read_b64_tr_b16 a[156:157], v227 offset:12288
    ds_read_b64_tr_b16 a[158:159], v227 offset:13312
    s_waitcnt lgkmcnt(8)
    v_mfma_f32_32x32x16_bf16 v[40:55], a[168:171], a[140:143], v[40:55]
    ds_read_b64_tr_b16 a[160:161], v224 offset:2048
    ds_read_b64_tr_b16 a[162:163], v224 offset:3072
    v_mfma_f32_32x32x16_bf16 v[56:71], a[172:175], a[140:143], v[56:71]
    ds_read_b64_tr_b16 a[164:165], v224 offset:14336
    ds_read_b64_tr_b16 a[166:167], v224 offset:15360
    s_waitcnt vmcnt(19)
    s_barrier
    s_waitcnt lgkmcnt(8)
    v_mfma_f32_32x32x16_bf16 v[72:87], a[144:147], a[0:3], 0
    ds_read_b64_tr_b16 a[168:169], v227 offset:2048
    ds_read_b64_tr_b16 a[170:171], v227 offset:3072
    s_add_u32 m0, s30, 122880
    s_add_u32 s5, s28, 4423808
    buffer_load_dwordx4 v233, s[12:15], s5 offen lds
    buffer_load_dwordx4 v234, s[12:15], s5 offen offset:1024 lds
    buffer_load_dwordx4 v235, s[12:15], s5 offen offset:2048 lds
    v_mfma_f32_32x32x16_bf16 v[88:103], a[148:151], a[0:3], 0
    ds_read_b64_tr_b16 a[172:173], v227 offset:14336
    ds_read_b64_tr_b16 a[174:175], v227 offset:15360
    s_waitcnt lgkmcnt(8)
    v_mfma_f32_32x32x16_bf16 v[104:119], a[152:155], a[0:3], 0
    ds_read_b64_tr_b16 a[144:145], v224 offset:4096
    ds_read_b64_tr_b16 a[146:147], v224 offset:5120
    v_mfma_f32_32x32x16_bf16 v[120:135], a[156:159], a[0:3], 0
    ds_read_b64_tr_b16 a[148:149], v224 offset:16384
    ds_read_b64_tr_b16 a[150:151], v224 offset:17408
    s_waitcnt lgkmcnt(8)
    v_mfma_f32_32x32x16_bf16 v[72:87], a[160:163], a[4:7], v[72:87]
    ds_read_b64_tr_b16 a[152:153], v227 offset:4096
    ds_read_b64_tr_b16 a[154:155], v227 offset:5120
    s_add_u32 m0, s30, 125952
    s_add_u32 s5, s28, 4644992
    buffer_load_dwordx4 v233, s[12:15], s5 offen lds
    buffer_load_dwordx4 v234, s[12:15], s5 offen offset:1024 lds
    buffer_load_dwordx4 v235, s[12:15], s5 offen offset:2048 lds
    v_mfma_f32_32x32x16_bf16 v[88:103], a[164:167], a[4:7], v[88:103]
    ds_read_b64_tr_b16 a[156:157], v227 offset:16384
    ds_read_b64_tr_b16 a[158:159], v227 offset:17408
    v_mul_f32 v24, v8, v24
    v_mul_f32 v25, v9, v25
    s_waitcnt lgkmcnt(8)
    v_mfma_f32_32x32x16_bf16 v[104:119], a[168:171], a[4:7], v[104:119]
    ds_read_b64_tr_b16 a[160:161], v224 offset:6144
    ds_read_b64_tr_b16 a[162:163], v224 offset:7168
    s_add_u32 s31, s28, 384
    buffer_load_dword v2, v1, s[12:15], s31 offen
    v_mul_f32 v26, v10, v26
    v_mul_f32 v27, v11, v27
    v_mfma_f32_32x32x16_bf16 v[120:135], a[172:175], a[4:7], v[120:135]
    ds_read_b64_tr_b16 a[164:165], v224 offset:18432
    ds_read_b64_tr_b16 a[166:167], v224 offset:19456
    v_mul_f32 v8, v244, v8
    v_mul_f32 v9, v244, v9
    s_waitcnt lgkmcnt(8)
    v_mfma_f32_32x32x16_bf16 v[72:87], a[144:147], a[8:11], v[72:87]
    ds_read_b64_tr_b16 a[168:169], v227 offset:6144
    ds_read_b64_tr_b16 a[170:171], v227 offset:7168
    v_mul_f32 v10, v244, v10
    v_mfma_f32_32x32x16_bf16 v[88:103], a[148:151], a[8:11], v[88:103]
    ds_read_b64_tr_b16 a[172:173], v227 offset:18432
    ds_read_b64_tr_b16 a[174:175], v227 offset:19456
    v_mul_f32 v11, v244, v11
    v_exp_f32 v8, v8
    s_waitcnt lgkmcnt(8)
    v_mfma_f32_32x32x16_bf16 v[104:119], a[152:155], a[8:11], v[104:119]
    ds_read_b64_tr_b16 a[144:145], v224 offset:8192
    ds_read_b64_tr_b16 a[146:147], v224 offset:9216
    v_exp_f32 v9, v9
    v_exp_f32 v10, v10
    v_mfma_f32_32x32x16_bf16 v[120:135], a[156:159], a[8:11], v[120:135]
    ds_read_b64_tr_b16 a[148:149], v224 offset:20480
    ds_read_b64_tr_b16 a[150:151], v224 offset:21504
    v_exp_f32 v11, v11
    v_fma_f32 v8, v8, v245, v245
    s_waitcnt lgkmcnt(8)
    v_mfma_f32_32x32x16_bf16 v[72:87], a[160:163], a[12:15], v[72:87]
    ds_read_b64_tr_b16 a[152:153], v227 offset:8192
    ds_read_b64_tr_b16 a[154:155], v227 offset:9216
    v_fma_f32 v9, v9, v245, v245
    v_mfma_f32_32x32x16_bf16 v[88:103], a[164:167], a[12:15], v[88:103]
    ds_read_b64_tr_b16 a[156:157], v227 offset:20480
    ds_read_b64_tr_b16 a[158:159], v227 offset:21504
    v_fma_f32 v10, v10, v245, v245
    v_fma_f32 v11, v11, v245, v245
    s_waitcnt lgkmcnt(8)
    v_mfma_f32_32x32x16_bf16 v[104:119], a[168:171], a[12:15], v[104:119]
    ds_read_b64_tr_b16 a[160:161], v224 offset:10240
    ds_read_b64_tr_b16 a[162:163], v224 offset:11264
    v_rcp_f32 v8, v8
    v_rcp_f32 v9, v9
    v_mfma_f32_32x32x16_bf16 v[120:135], a[172:175], a[12:15], v[120:135]
    ds_read_b64_tr_b16 a[164:165], v224 offset:22528
    ds_read_b64_tr_b16 a[166:167], v224 offset:23552
    v_rcp_f32 v10, v10
    s_waitcnt lgkmcnt(8)
    v_mfma_f32_32x32x16_bf16 v[72:87], a[144:147], a[16:19], v[72:87]
    ds_read_b64_tr_b16 a[168:169], v227 offset:10240
    ds_read_b64_tr_b16 a[170:171], v227 offset:11264
    v_rcp_f32 v11, v11
    v_mul_f32 v24, v24, v8
    v_mfma_f32_32x32x16_bf16 v[88:103], a[148:151], a[16:19], v[88:103]
    ds_read_b64_tr_b16 a[172:173], v227 offset:22528
    ds_read_b64_tr_b16 a[174:175], v227 offset:23552
    v_mul_f32 v25, v25, v9
    v_mul_f32 v26, v26, v10
    s_waitcnt lgkmcnt(8)
    v_mfma_f32_32x32x16_bf16 v[104:119], a[152:155], a[16:19], v[104:119]
    ds_read_b64_tr_b16 a[144:145], v224 offset:24576
    ds_read_b64_tr_b16 a[146:147], v224 offset:25600
    v_mul_f32 v27, v27, v11
    v_cvt_pk_bf16_f32 v136, v24, v25
    v_mfma_f32_32x32x16_bf16 v[120:135], a[156:159], a[16:19], v[120:135]
    ds_read_b64_tr_b16 a[148:149], v224 offset:36864
    ds_read_b64_tr_b16 a[150:151], v224 offset:37888
    v_cvt_pk_bf16_f32 v137, v26, v27
    s_waitcnt lgkmcnt(8)
    v_mfma_f32_32x32x16_bf16 v[72:87], a[160:163], a[20:23], v[72:87]
    ds_read_b64_tr_b16 a[152:153], v227 offset:24576
    ds_read_b64_tr_b16 a[154:155], v227 offset:25600
    v_mul_f32 v28, v12, v28
    v_mul_f32 v29, v13, v29
    v_mfma_f32_32x32x16_bf16 v[88:103], a[164:167], a[20:23], v[88:103]
    ds_read_b64_tr_b16 a[156:157], v227 offset:36864
    ds_read_b64_tr_b16 a[158:159], v227 offset:37888
    v_mul_f32 v30, v14, v30
    v_mul_f32 v31, v15, v31
    s_waitcnt lgkmcnt(8)
    v_mfma_f32_32x32x16_bf16 v[104:119], a[168:171], a[20:23], v[104:119]
    ds_read_b64_tr_b16 a[160:161], v224 offset:26624
    ds_read_b64_tr_b16 a[162:163], v224 offset:27648
    v_mul_f32 v12, v244, v12
    v_mul_f32 v13, v244, v13
    v_mfma_f32_32x32x16_bf16 v[120:135], a[172:175], a[20:23], v[120:135]
    ds_read_b64_tr_b16 a[164:165], v224 offset:38912
    ds_read_b64_tr_b16 a[166:167], v224 offset:39936
    v_mul_f32 v14, v244, v14
    s_waitcnt vmcnt(20)
    s_barrier
    s_waitcnt lgkmcnt(8)
    v_mfma_f32_32x32x16_bf16 v[72:87], a[144:147], a[24:27], v[72:87]
    ds_read_b64_tr_b16 a[168:169], v227 offset:26624
    ds_read_b64_tr_b16 a[170:171], v227 offset:27648
    v_mul_f32 v15, v244, v15
    v_exp_f32 v12, v12
    s_add_u32 m0, s30, 0
    s_add_u32 s5, s28, 256
    buffer_load_dwordx4 v233, s[12:15], s5 offen lds
    buffer_load_dwordx4 v234, s[12:15], s5 offen offset:1024 lds
    buffer_load_dwordx4 v235, s[12:15], s5 offen offset:2048 lds
    v_mfma_f32_32x32x16_bf16 v[88:103], a[148:151], a[24:27], v[88:103]
    ds_read_b64_tr_b16 a[172:173], v227 offset:38912
    ds_read_b64_tr_b16 a[174:175], v227 offset:39936
    v_exp_f32 v13, v13
    v_exp_f32 v14, v14
    s_waitcnt lgkmcnt(8)
    v_mfma_f32_32x32x16_bf16 v[104:119], a[152:155], a[24:27], v[104:119]
    ds_read_b64_tr_b16 a[144:145], v224 offset:28672
    ds_read_b64_tr_b16 a[146:147], v224 offset:29696
    v_exp_f32 v15, v15
    v_mfma_f32_32x32x16_bf16 v[120:135], a[156:159], a[24:27], v[120:135]
    ds_read_b64_tr_b16 a[148:149], v224 offset:40960
    ds_read_b64_tr_b16 a[150:151], v224 offset:41984
    v_fma_f32 v12, v12, v245, v245
    v_fma_f32 v13, v13, v245, v245
    s_waitcnt lgkmcnt(8)
    v_mfma_f32_32x32x16_bf16 v[72:87], a[160:163], a[28:31], v[72:87]
    ds_read_b64_tr_b16 a[152:153], v227 offset:28672
    ds_read_b64_tr_b16 a[154:155], v227 offset:29696
    v_fma_f32 v14, v14, v245, v245
    v_fma_f32 v15, v15, v245, v245
    s_add_u32 m0, s30, 3072
    s_add_u32 s5, s28, 221440
    buffer_load_dwordx4 v233, s[12:15], s5 offen lds
    buffer_load_dwordx4 v234, s[12:15], s5 offen offset:1024 lds
    buffer_load_dwordx4 v235, s[12:15], s5 offen offset:2048 lds
    v_mfma_f32_32x32x16_bf16 v[88:103], a[164:167], a[28:31], v[88:103]
    ds_read_b64_tr_b16 a[156:157], v227 offset:40960
    ds_read_b64_tr_b16 a[158:159], v227 offset:41984
    v_rcp_f32 v12, v12
    v_rcp_f32 v13, v13
    s_waitcnt lgkmcnt(8)
    v_mfma_f32_32x32x16_bf16 v[104:119], a[168:171], a[28:31], v[104:119]
    ds_read_b64_tr_b16 a[160:161], v224 offset:30720
    ds_read_b64_tr_b16 a[162:163], v224 offset:31744
    v_rcp_f32 v14, v14
    v_mfma_f32_32x32x16_bf16 v[120:135], a[172:175], a[28:31], v[120:135]
    ds_read_b64_tr_b16 a[164:165], v224 offset:43008
    ds_read_b64_tr_b16 a[166:167], v224 offset:44032
    v_rcp_f32 v15, v15
    v_mul_f32 v28, v28, v12
    s_waitcnt lgkmcnt(8)
    v_mfma_f32_32x32x16_bf16 v[72:87], a[144:147], a[32:35], v[72:87]
    ds_read_b64_tr_b16 a[168:169], v227 offset:30720
    ds_read_b64_tr_b16 a[170:171], v227 offset:31744
    v_mul_f32 v29, v29, v13
    v_mul_f32 v30, v30, v14
    v_mfma_f32_32x32x16_bf16 v[88:103], a[148:151], a[32:35], v[88:103]
    ds_read_b64_tr_b16 a[172:173], v227 offset:43008
    ds_read_b64_tr_b16 a[174:175], v227 offset:44032
    v_mul_f32 v31, v31, v15
    s_waitcnt lgkmcnt(8)
    v_mfma_f32_32x32x16_bf16 v[104:119], a[152:155], a[32:35], v[104:119]
    ds_read_b64_tr_b16 a[144:145], v224 offset:32768
    ds_read_b64_tr_b16 a[146:147], v224 offset:33792
    v_cvt_pk_bf16_f32 v138, v28, v29
    v_cvt_pk_bf16_f32 v139, v30, v31
    v_mfma_f32_32x32x16_bf16 v[120:135], a[156:159], a[32:35], v[120:135]
    ds_read_b64_tr_b16 a[148:149], v224 offset:45056
    ds_read_b64_tr_b16 a[150:151], v224 offset:46080
    s_add_u32 s31, s52, 0
    buffer_store_dwordx4 v[136:139], v242, s[16:19], s31 offen sc1
    v_mul_f32 v32, v16, v32
    s_waitcnt lgkmcnt(8)
    v_mfma_f32_32x32x16_bf16 v[72:87], a[160:163], a[36:39], v[72:87]
    ds_read_b64_tr_b16 a[152:153], v227 offset:32768
    ds_read_b64_tr_b16 a[154:155], v227 offset:33792
    v_mul_f32 v33, v17, v33
    v_mul_f32 v34, v18, v34
    v_mfma_f32_32x32x16_bf16 v[88:103], a[164:167], a[36:39], v[88:103]
    ds_read_b64_tr_b16 a[156:157], v227 offset:45056
    ds_read_b64_tr_b16 a[158:159], v227 offset:46080
    v_mul_f32 v35, v19, v35
    s_waitcnt lgkmcnt(8)
    v_mfma_f32_32x32x16_bf16 v[104:119], a[168:171], a[36:39], v[104:119]
    ds_read_b64_tr_b16 a[160:161], v224 offset:34816
    ds_read_b64_tr_b16 a[162:163], v224 offset:35840
    v_mul_f32 v16, v244, v16
    v_mul_f32 v17, v244, v17
    v_mfma_f32_32x32x16_bf16 v[120:135], a[172:175], a[36:39], v[120:135]
    ds_read_b64_tr_b16 a[164:165], v224 offset:47104
    ds_read_b64_tr_b16 a[166:167], v224 offset:48128
    v_mul_f32 v18, v244, v18
    v_mul_f32 v19, v244, v19
    s_waitcnt lgkmcnt(8)
    v_mfma_f32_32x32x16_bf16 v[72:87], a[144:147], a[40:43], v[72:87]
    ds_read_b64_tr_b16 a[168:169], v227 offset:34816
    ds_read_b64_tr_b16 a[170:171], v227 offset:35840
    v_exp_f32 v16, v16
    v_exp_f32 v17, v17
    v_mfma_f32_32x32x16_bf16 v[88:103], a[148:151], a[40:43], v[88:103]
    ds_read_b64_tr_b16 a[172:173], v227 offset:47104
    ds_read_b64_tr_b16 a[174:175], v227 offset:48128
    v_exp_f32 v18, v18
    s_waitcnt lgkmcnt(8)
    v_mfma_f32_32x32x16_bf16 v[104:119], a[152:155], a[40:43], v[104:119]
    ds_read_b64_tr_b16 a[144:145], v225 offset:0
    ds_read_b64_tr_b16 a[146:147], v225 offset:1024
    v_exp_f32 v19, v19
    v_fma_f32 v16, v16, v245, v245
    v_mfma_f32_32x32x16_bf16 v[120:135], a[156:159], a[40:43], v[120:135]
    ds_read_b64_tr_b16 a[148:149], v225 offset:12288
    ds_read_b64_tr_b16 a[150:151], v225 offset:13312
    v_fma_f32 v17, v17, v245, v245
    v_fma_f32 v18, v18, v245, v245
    s_waitcnt lgkmcnt(8)
    v_mfma_f32_32x32x16_bf16 v[72:87], a[160:163], a[44:47], v[72:87]
    ds_read_b64_tr_b16 a[152:153], v228 offset:0
    ds_read_b64_tr_b16 a[154:155], v228 offset:1024
    v_fma_f32 v19, v19, v245, v245
    v_mfma_f32_32x32x16_bf16 v[88:103], a[164:167], a[44:47], v[88:103]
    ds_read_b64_tr_b16 a[156:157], v228 offset:12288
    ds_read_b64_tr_b16 a[158:159], v228 offset:13312
    v_rcp_f32 v16, v16
    v_rcp_f32 v17, v17
    s_waitcnt lgkmcnt(8)
    v_mfma_f32_32x32x16_bf16 v[104:119], a[168:171], a[44:47], v[104:119]
    ds_read_b64_tr_b16 a[160:161], v225 offset:2048
    ds_read_b64_tr_b16 a[162:163], v225 offset:3072
    v_rcp_f32 v18, v18
    v_rcp_f32 v19, v19
    v_mfma_f32_32x32x16_bf16 v[120:135], a[172:175], a[44:47], v[120:135]
    ds_read_b64_tr_b16 a[164:165], v225 offset:14336
    ds_read_b64_tr_b16 a[166:167], v225 offset:15360
    v_mul_f32 v32, v32, v16
    v_mul_f32 v33, v33, v17
    s_waitcnt vmcnt(20)
    s_barrier
    s_waitcnt lgkmcnt(8)
    v_mfma_f32_32x32x16_bf16 v[72:87], a[144:147], a[48:51], v[72:87]
    ds_read_b64_tr_b16 a[168:169], v228 offset:2048
    ds_read_b64_tr_b16 a[170:171], v228 offset:3072
    v_mul_f32 v34, v34, v18
    s_add_u32 m0, s30, 24576
    s_add_u32 s5, s28, 884992
    buffer_load_dwordx4 v233, s[12:15], s5 offen lds
    buffer_load_dwordx4 v234, s[12:15], s5 offen offset:1024 lds
    buffer_load_dwordx4 v235, s[12:15], s5 offen offset:2048 lds
    v_mfma_f32_32x32x16_bf16 v[88:103], a[148:151], a[48:51], v[88:103]
    ds_read_b64_tr_b16 a[172:173], v228 offset:14336
    ds_read_b64_tr_b16 a[174:175], v228 offset:15360
    v_mul_f32 v35, v35, v19
    v_cvt_pk_bf16_f32 v140, v32, v33
    s_waitcnt lgkmcnt(8)
    v_mfma_f32_32x32x16_bf16 v[104:119], a[152:155], a[48:51], v[104:119]
    ds_read_b64_tr_b16 a[144:145], v225 offset:4096
    ds_read_b64_tr_b16 a[146:147], v225 offset:5120
    v_cvt_pk_bf16_f32 v141, v34, v35
    v_mul_f32 v36, v20, v36
    v_mfma_f32_32x32x16_bf16 v[120:135], a[156:159], a[48:51], v[120:135]
    ds_read_b64_tr_b16 a[148:149], v225 offset:16384
    ds_read_b64_tr_b16 a[150:151], v225 offset:17408
    v_mul_f32 v37, v21, v37
    v_mul_f32 v38, v22, v38
    s_waitcnt lgkmcnt(8)
    v_mfma_f32_32x32x16_bf16 v[72:87], a[160:163], a[52:55], v[72:87]
    ds_read_b64_tr_b16 a[152:153], v228 offset:4096
    ds_read_b64_tr_b16 a[154:155], v228 offset:5120
    v_mul_f32 v39, v23, v39
    s_add_u32 m0, s30, 27648
    s_add_u32 s5, s28, 1106176
    buffer_load_dwordx4 v233, s[12:15], s5 offen lds
    buffer_load_dwordx4 v234, s[12:15], s5 offen offset:1024 lds
    buffer_load_dwordx4 v235, s[12:15], s5 offen offset:2048 lds
    v_mfma_f32_32x32x16_bf16 v[88:103], a[164:167], a[52:55], v[88:103]
    ds_read_b64_tr_b16 a[156:157], v228 offset:16384
    ds_read_b64_tr_b16 a[158:159], v228 offset:17408
    v_mul_f32 v20, v244, v20
    v_mul_f32 v21, v244, v21
    s_waitcnt lgkmcnt(8)
    v_mfma_f32_32x32x16_bf16 v[104:119], a[168:171], a[52:55], v[104:119]
    ds_read_b64_tr_b16 a[160:161], v225 offset:6144
    ds_read_b64_tr_b16 a[162:163], v225 offset:7168
    v_mul_f32 v22, v244, v22
    v_mul_f32 v23, v244, v23
    v_mfma_f32_32x32x16_bf16 v[120:135], a[172:175], a[52:55], v[120:135]
    ds_read_b64_tr_b16 a[164:165], v225 offset:18432
    ds_read_b64_tr_b16 a[166:167], v225 offset:19456
    v_exp_f32 v20, v20
    s_waitcnt lgkmcnt(8)
    v_mfma_f32_32x32x16_bf16 v[72:87], a[144:147], a[56:59], v[72:87]
    ds_read_b64_tr_b16 a[168:169], v228 offset:6144
    ds_read_b64_tr_b16 a[170:171], v228 offset:7168
    buffer_load_dword v2, v1, s[12:15], s29 offen
    v_exp_f32 v21, v21
    v_exp_f32 v22, v22
    v_mfma_f32_32x32x16_bf16 v[88:103], a[148:151], a[56:59], v[88:103]
    ds_read_b64_tr_b16 a[172:173], v228 offset:18432
    ds_read_b64_tr_b16 a[174:175], v228 offset:19456
    v_exp_f32 v23, v23
    v_fma_f32 v20, v20, v245, v245
    s_waitcnt lgkmcnt(8)
    v_mfma_f32_32x32x16_bf16 v[104:119], a[152:155], a[56:59], v[104:119]
    ds_read_b64_tr_b16 a[144:145], v225 offset:8192
    ds_read_b64_tr_b16 a[146:147], v225 offset:9216
    v_fma_f32 v21, v21, v245, v245
    v_fma_f32 v22, v22, v245, v245
    v_mfma_f32_32x32x16_bf16 v[120:135], a[156:159], a[56:59], v[120:135]
    ds_read_b64_tr_b16 a[148:149], v225 offset:20480
    ds_read_b64_tr_b16 a[150:151], v225 offset:21504
    v_fma_f32 v23, v23, v245, v245
    s_waitcnt lgkmcnt(8)
    v_mfma_f32_32x32x16_bf16 v[72:87], a[160:163], a[60:63], v[72:87]
    ds_read_b64_tr_b16 a[152:153], v228 offset:8192
    ds_read_b64_tr_b16 a[154:155], v228 offset:9216
    v_rcp_f32 v20, v20
    v_rcp_f32 v21, v21
    v_mfma_f32_32x32x16_bf16 v[88:103], a[164:167], a[60:63], v[88:103]
    ds_read_b64_tr_b16 a[156:157], v228 offset:20480
    ds_read_b64_tr_b16 a[158:159], v228 offset:21504
    v_rcp_f32 v22, v22
    v_rcp_f32 v23, v23
    s_waitcnt lgkmcnt(8)
    v_mfma_f32_32x32x16_bf16 v[104:119], a[168:171], a[60:63], v[104:119]
    ds_read_b64_tr_b16 a[160:161], v225 offset:10240
    ds_read_b64_tr_b16 a[162:163], v225 offset:11264
    v_mul_f32 v36, v36, v20
    v_mfma_f32_32x32x16_bf16 v[120:135], a[172:175], a[60:63], v[120:135]
    ds_read_b64_tr_b16 a[164:165], v225 offset:22528
    ds_read_b64_tr_b16 a[166:167], v225 offset:23552
    v_mul_f32 v37, v37, v21
    v_mul_f32 v38, v38, v22
    s_waitcnt lgkmcnt(8)
    v_mfma_f32_32x32x16_bf16 v[72:87], a[144:147], a[64:67], v[72:87]
    ds_read_b64_tr_b16 a[168:169], v228 offset:10240
    ds_read_b64_tr_b16 a[170:171], v228 offset:11264
    v_mul_f32 v39, v39, v23
    v_cvt_pk_bf16_f32 v142, v36, v37
    v_mfma_f32_32x32x16_bf16 v[88:103], a[148:151], a[64:67], v[88:103]
    ds_read_b64_tr_b16 a[172:173], v228 offset:22528
    ds_read_b64_tr_b16 a[174:175], v228 offset:23552
    v_cvt_pk_bf16_f32 v143, v38, v39
    s_add_u32 s31, s52, 1024
    buffer_store_dwordx4 v[140:143], v242, s[16:19], s31 offen sc1
    s_waitcnt lgkmcnt(8)
    v_mfma_f32_32x32x16_bf16 v[104:119], a[152:155], a[64:67], v[104:119]
    ds_read_b64_tr_b16 a[144:145], v225 offset:24576
    ds_read_b64_tr_b16 a[146:147], v225 offset:25600
    v_mul_f32 v56, v40, v56
    v_mfma_f32_32x32x16_bf16 v[120:135], a[156:159], a[64:67], v[120:135]
    ds_read_b64_tr_b16 a[148:149], v225 offset:36864
    ds_read_b64_tr_b16 a[150:151], v225 offset:37888
    v_mul_f32 v57, v41, v57
    v_mul_f32 v58, v42, v58
    s_waitcnt lgkmcnt(8)
    v_mfma_f32_32x32x16_bf16 v[72:87], a[160:163], a[68:71], v[72:87]
    ds_read_b64_tr_b16 a[152:153], v228 offset:24576
    ds_read_b64_tr_b16 a[154:155], v228 offset:25600
    v_mul_f32 v59, v43, v59
    v_mul_f32 v40, v244, v40
    v_mfma_f32_32x32x16_bf16 v[88:103], a[164:167], a[68:71], v[88:103]
    ds_read_b64_tr_b16 a[156:157], v228 offset:36864
    ds_read_b64_tr_b16 a[158:159], v228 offset:37888
    v_mul_f32 v41, v244, v41
    v_mul_f32 v42, v244, v42
    s_waitcnt lgkmcnt(8)
    v_mfma_f32_32x32x16_bf16 v[104:119], a[168:171], a[68:71], v[104:119]
    ds_read_b64_tr_b16 a[160:161], v225 offset:26624
    ds_read_b64_tr_b16 a[162:163], v225 offset:27648
    v_mul_f32 v43, v244, v43
    v_mfma_f32_32x32x16_bf16 v[120:135], a[172:175], a[68:71], v[120:135]
    ds_read_b64_tr_b16 a[164:165], v225 offset:38912
    ds_read_b64_tr_b16 a[166:167], v225 offset:39936
    v_exp_f32 v40, v40
    v_exp_f32 v41, v41
    s_waitcnt vmcnt(22)
    s_barrier
    s_waitcnt lgkmcnt(8)
    v_mfma_f32_32x32x16_bf16 v[72:87], a[144:147], a[72:75], v[72:87]
    ds_read_b64_tr_b16 a[168:169], v228 offset:26624
    ds_read_b64_tr_b16 a[170:171], v228 offset:27648
    v_exp_f32 v42, v42
    v_exp_f32 v43, v43
    s_add_u32 m0, s30, 49152
    s_add_u32 s5, s28, 1769728
    buffer_load_dwordx4 v233, s[12:15], s5 offen lds
    buffer_load_dwordx4 v234, s[12:15], s5 offen offset:1024 lds
    buffer_load_dwordx4 v235, s[12:15], s5 offen offset:2048 lds
    v_mfma_f32_32x32x16_bf16 v[88:103], a[148:151], a[72:75], v[88:103]
    ds_read_b64_tr_b16 a[172:173], v228 offset:38912
    ds_read_b64_tr_b16 a[174:175], v228 offset:39936
    v_fma_f32 v40, v40, v245, v245
    s_waitcnt lgkmcnt(8)
    v_mfma_f32_32x32x16_bf16 v[104:119], a[152:155], a[72:75], v[104:119]
    ds_read_b64_tr_b16 a[144:145], v225 offset:28672
    ds_read_b64_tr_b16 a[146:147], v225 offset:29696
    v_fma_f32 v41, v41, v245, v245
    v_fma_f32 v42, v42, v245, v245
    v_mfma_f32_32x32x16_bf16 v[120:135], a[156:159], a[72:75], v[120:135]
    ds_read_b64_tr_b16 a[148:149], v225 offset:40960
    ds_read_b64_tr_b16 a[150:151], v225 offset:41984
    v_fma_f32 v43, v43, v245, v245
    v_rcp_f32 v40, v40
    s_waitcnt lgkmcnt(8)
    v_mfma_f32_32x32x16_bf16 v[72:87], a[160:163], a[76:79], v[72:87]
    ds_read_b64_tr_b16 a[152:153], v228 offset:28672
    ds_read_b64_tr_b16 a[154:155], v228 offset:29696
    v_rcp_f32 v41, v41
    v_rcp_f32 v42, v42
    s_add_u32 m0, s30, 52224
    s_add_u32 s5, s28, 1990912
    buffer_load_dwordx4 v233, s[12:15], s5 offen lds
    buffer_load_dwordx4 v234, s[12:15], s5 offen offset:1024 lds
    buffer_load_dwordx4 v235, s[12:15], s5 offen offset:2048 lds
    v_mfma_f32_32x32x16_bf16 v[88:103], a[164:167], a[76:79], v[88:103]
    ds_read_b64_tr_b16 a[156:157], v228 offset:40960
    ds_read_b64_tr_b16 a[158:159], v228 offset:41984
    v_rcp_f32 v43, v43
    s_waitcnt lgkmcnt(8)
    v_mfma_f32_32x32x16_bf16 v[104:119], a[168:171], a[76:79], v[104:119]
    ds_read_b64_tr_b16 a[160:161], v225 offset:30720
    ds_read_b64_tr_b16 a[162:163], v225 offset:31744
    v_mul_f32 v56, v56, v40
    v_mul_f32 v57, v57, v41
    v_mfma_f32_32x32x16_bf16 v[120:135], a[172:175], a[76:79], v[120:135]
    ds_read_b64_tr_b16 a[164:165], v225 offset:43008
    ds_read_b64_tr_b16 a[166:167], v225 offset:44032
    v_mul_f32 v58, v58, v42
    v_mul_f32 v59, v59, v43
    s_waitcnt lgkmcnt(8)
    v_mfma_f32_32x32x16_bf16 v[72:87], a[144:147], a[80:83], v[72:87]
    ds_read_b64_tr_b16 a[168:169], v228 offset:30720
    ds_read_b64_tr_b16 a[170:171], v228 offset:31744
    v_cvt_pk_bf16_f32 v144, v56, v57
    v_mfma_f32_32x32x16_bf16 v[88:103], a[148:151], a[80:83], v[88:103]
    ds_read_b64_tr_b16 a[172:173], v228 offset:43008
    ds_read_b64_tr_b16 a[174:175], v228 offset:44032
    v_cvt_pk_bf16_f32 v145, v58, v59
    v_mul_f32 v60, v44, v60
    s_waitcnt lgkmcnt(8)
    v_mfma_f32_32x32x16_bf16 v[104:119], a[152:155], a[80:83], v[104:119]
    ds_read_b64_tr_b16 a[144:145], v225 offset:32768
    ds_read_b64_tr_b16 a[146:147], v225 offset:33792
    v_mul_f32 v61, v45, v61
    v_mul_f32 v62, v46, v62
    v_mfma_f32_32x32x16_bf16 v[120:135], a[156:159], a[80:83], v[120:135]
    ds_read_b64_tr_b16 a[148:149], v225 offset:45056
    ds_read_b64_tr_b16 a[150:151], v225 offset:46080
    v_mul_f32 v63, v47, v63
    v_mul_f32 v44, v244, v44
    s_waitcnt lgkmcnt(8)
    v_mfma_f32_32x32x16_bf16 v[72:87], a[160:163], a[84:87], v[72:87]
    ds_read_b64_tr_b16 a[152:153], v228 offset:32768
    ds_read_b64_tr_b16 a[154:155], v228 offset:33792
    v_mul_f32 v45, v244, v45
    v_mfma_f32_32x32x16_bf16 v[88:103], a[164:167], a[84:87], v[88:103]
    ds_read_b64_tr_b16 a[156:157], v228 offset:45056
    ds_read_b64_tr_b16 a[158:159], v228 offset:46080
    v_mul_f32 v46, v244, v46
    v_mul_f32 v47, v244, v47
    s_waitcnt lgkmcnt(8)
    v_mfma_f32_32x32x16_bf16 v[104:119], a[168:171], a[84:87], v[104:119]
    ds_read_b64_tr_b16 a[160:161], v225 offset:34816
    ds_read_b64_tr_b16 a[162:163], v225 offset:35840
    v_exp_f32 v44, v44
    v_exp_f32 v45, v45
    v_mfma_f32_32x32x16_bf16 v[120:135], a[172:175], a[84:87], v[120:135]
    ds_read_b64_tr_b16 a[164:165], v225 offset:47104
    ds_read_b64_tr_b16 a[166:167], v225 offset:48128
    v_exp_f32 v46, v46
    v_exp_f32 v47, v47
    s_waitcnt lgkmcnt(8)
    v_mfma_f32_32x32x16_bf16 v[72:87], a[144:147], a[88:91], v[72:87]
    ds_read_b64_tr_b16 a[168:169], v228 offset:34816
    ds_read_b64_tr_b16 a[170:171], v228 offset:35840
    v_fma_f32 v44, v44, v245, v245
    v_mfma_f32_32x32x16_bf16 v[88:103], a[148:151], a[88:91], v[88:103]
    ds_read_b64_tr_b16 a[172:173], v228 offset:47104
    ds_read_b64_tr_b16 a[174:175], v228 offset:48128
    v_fma_f32 v45, v45, v245, v245
    v_fma_f32 v46, v46, v245, v245
    s_waitcnt lgkmcnt(8)
    v_mfma_f32_32x32x16_bf16 v[104:119], a[152:155], a[88:91], v[104:119]
    ds_read_b64_tr_b16 a[144:145], v226 offset:0
    ds_read_b64_tr_b16 a[146:147], v226 offset:1024
    v_fma_f32 v47, v47, v245, v245
    v_rcp_f32 v44, v44
    v_mfma_f32_32x32x16_bf16 v[120:135], a[156:159], a[88:91], v[120:135]
    ds_read_b64_tr_b16 a[148:149], v226 offset:12288
    ds_read_b64_tr_b16 a[150:151], v226 offset:13312
    v_rcp_f32 v45, v45
    s_waitcnt lgkmcnt(8)
    v_mfma_f32_32x32x16_bf16 v[72:87], a[160:163], a[92:95], v[72:87]
    ds_read_b64_tr_b16 a[152:153], v229 offset:0
    ds_read_b64_tr_b16 a[154:155], v229 offset:1024
    v_rcp_f32 v46, v46
    v_rcp_f32 v47, v47
    v_mfma_f32_32x32x16_bf16 v[88:103], a[164:167], a[92:95], v[88:103]
    ds_read_b64_tr_b16 a[156:157], v229 offset:12288
    ds_read_b64_tr_b16 a[158:159], v229 offset:13312
    v_mul_f32 v60, v60, v44
    v_mul_f32 v61, v61, v45
    s_waitcnt lgkmcnt(8)
    v_mfma_f32_32x32x16_bf16 v[104:119], a[168:171], a[92:95], v[104:119]
    ds_read_b64_tr_b16 a[160:161], v226 offset:2048
    ds_read_b64_tr_b16 a[162:163], v226 offset:3072
    v_mul_f32 v62, v62, v46
    v_mul_f32 v63, v63, v47
    v_mfma_f32_32x32x16_bf16 v[120:135], a[172:175], a[92:95], v[120:135]
    ds_read_b64_tr_b16 a[164:165], v226 offset:14336
    ds_read_b64_tr_b16 a[166:167], v226 offset:15360
    v_cvt_pk_bf16_f32 v146, v60, v61
    s_waitcnt vmcnt(22)
    s_barrier
    s_waitcnt lgkmcnt(8)
    v_mfma_f32_32x32x16_bf16 v[72:87], a[144:147], a[96:99], v[72:87]
    ds_read_b64_tr_b16 a[168:169], v229 offset:2048
    ds_read_b64_tr_b16 a[170:171], v229 offset:3072
    v_cvt_pk_bf16_f32 v147, v62, v63
    s_add_u32 s31, s52, 2048
    buffer_store_dwordx4 v[144:147], v242, s[16:19], s31 offen sc1
    s_add_u32 m0, s30, 73728
    s_add_u32 s5, s28, 2654464
    buffer_load_dwordx4 v233, s[12:15], s5 offen lds
    buffer_load_dwordx4 v234, s[12:15], s5 offen offset:1024 lds
    buffer_load_dwordx4 v235, s[12:15], s5 offen offset:2048 lds
    v_mfma_f32_32x32x16_bf16 v[88:103], a[148:151], a[96:99], v[88:103]
    ds_read_b64_tr_b16 a[172:173], v229 offset:14336
    ds_read_b64_tr_b16 a[174:175], v229 offset:15360
    v_mul_f32 v64, v48, v64
    v_mul_f32 v65, v49, v65
    s_waitcnt lgkmcnt(8)
    v_mfma_f32_32x32x16_bf16 v[104:119], a[152:155], a[96:99], v[104:119]
    ds_read_b64_tr_b16 a[144:145], v226 offset:4096
    ds_read_b64_tr_b16 a[146:147], v226 offset:5120
    v_mul_f32 v66, v50, v66
    v_mul_f32 v67, v51, v67
    v_mfma_f32_32x32x16_bf16 v[120:135], a[156:159], a[96:99], v[120:135]
    ds_read_b64_tr_b16 a[148:149], v226 offset:16384
    ds_read_b64_tr_b16 a[150:151], v226 offset:17408
    v_mul_f32 v48, v244, v48
    s_waitcnt lgkmcnt(8)
    v_mfma_f32_32x32x16_bf16 v[72:87], a[160:163], a[100:103], v[72:87]
    ds_read_b64_tr_b16 a[152:153], v229 offset:4096
    ds_read_b64_tr_b16 a[154:155], v229 offset:5120
    v_mul_f32 v49, v244, v49
    v_mul_f32 v50, v244, v50
    s_add_u32 m0, s30, 76800
    s_add_u32 s5, s28, 2875648
    buffer_load_dwordx4 v233, s[12:15], s5 offen lds
    buffer_load_dwordx4 v234, s[12:15], s5 offen offset:1024 lds
    buffer_load_dwordx4 v235, s[12:15], s5 offen offset:2048 lds
    v_mfma_f32_32x32x16_bf16 v[88:103], a[164:167], a[100:103], v[88:103]
    ds_read_b64_tr_b16 a[156:157], v229 offset:16384
    ds_read_b64_tr_b16 a[158:159], v229 offset:17408
    v_mul_f32 v51, v244, v51
    v_exp_f32 v48, v48
    s_waitcnt lgkmcnt(8)
    v_mfma_f32_32x32x16_bf16 v[104:119], a[168:171], a[100:103], v[104:119]
    ds_read_b64_tr_b16 a[160:161], v226 offset:6144
    ds_read_b64_tr_b16 a[162:163], v226 offset:7168
    v_exp_f32 v49, v49
    v_mfma_f32_32x32x16_bf16 v[120:135], a[172:175], a[100:103], v[120:135]
    ds_read_b64_tr_b16 a[164:165], v226 offset:18432
    ds_read_b64_tr_b16 a[166:167], v226 offset:19456
    v_exp_f32 v50, v50
    v_exp_f32 v51, v51
    s_waitcnt lgkmcnt(8)
    v_mfma_f32_32x32x16_bf16 v[72:87], a[144:147], a[104:107], v[72:87]
    ds_read_b64_tr_b16 a[168:169], v229 offset:6144
    ds_read_b64_tr_b16 a[170:171], v229 offset:7168
    v_fma_f32 v48, v48, v245, v245
    v_fma_f32 v49, v49, v245, v245
    v_mfma_f32_32x32x16_bf16 v[88:103], a[148:151], a[104:107], v[88:103]
    ds_read_b64_tr_b16 a[172:173], v229 offset:18432
    ds_read_b64_tr_b16 a[174:175], v229 offset:19456
    s_and_b32 s34, s25, 7
    s_lshl_b32 s34, s34, 2
    s_add_u32 s34, s34, s24
    s_mul_i32 s34, s34, 10368
    s_mul_i32 s31, s26, 331776
    s_add_u32 s34, s34, s31
    s_add_u32 s34, s34, 663552
    v_min_u32 v3, 40, v0
    v_lshlrev_b32 v3, 7, v3
    v_add_u32 v3, s34, v3
    v_fma_f32 v50, v50, v245, v245
    v_fma_f32 v51, v51, v245, v245
    s_waitcnt lgkmcnt(8)
    v_mfma_f32_32x32x16_bf16 v[104:119], a[152:155], a[104:107], v[104:119]
    ds_read_b64_tr_b16 a[144:145], v226 offset:8192
    ds_read_b64_tr_b16 a[146:147], v226 offset:9216
    buffer_load_dword v2, v3, s[20:23], 0 offen
    v_rcp_f32 v48, v48
    v_mfma_f32_32x32x16_bf16 v[120:135], a[156:159], a[104:107], v[120:135]
    ds_read_b64_tr_b16 a[148:149], v226 offset:20480
    ds_read_b64_tr_b16 a[150:151], v226 offset:21504
    v_rcp_f32 v49, v49
    v_rcp_f32 v50, v50
    s_waitcnt lgkmcnt(8)
    v_mfma_f32_32x32x16_bf16 v[72:87], a[160:163], a[108:111], v[72:87]
    ds_read_b64_tr_b16 a[152:153], v229 offset:8192
    ds_read_b64_tr_b16 a[154:155], v229 offset:9216
    v_rcp_f32 v51, v51
    v_mul_f32 v64, v64, v48
    v_mfma_f32_32x32x16_bf16 v[88:103], a[164:167], a[108:111], v[88:103]
    ds_read_b64_tr_b16 a[156:157], v229 offset:20480
    ds_read_b64_tr_b16 a[158:159], v229 offset:21504
    v_mul_f32 v65, v65, v49
    s_waitcnt lgkmcnt(8)
    v_mfma_f32_32x32x16_bf16 v[104:119], a[168:171], a[108:111], v[104:119]
    ds_read_b64_tr_b16 a[160:161], v226 offset:10240
    ds_read_b64_tr_b16 a[162:163], v226 offset:11264
    v_mul_f32 v66, v66, v50
    v_mul_f32 v67, v67, v51
    v_mfma_f32_32x32x16_bf16 v[120:135], a[172:175], a[108:111], v[120:135]
    ds_read_b64_tr_b16 a[164:165], v226 offset:22528
    ds_read_b64_tr_b16 a[166:167], v226 offset:23552
    v_cvt_pk_bf16_f32 v148, v64, v65
    v_cvt_pk_bf16_f32 v149, v66, v67
    s_waitcnt lgkmcnt(8)
    v_mfma_f32_32x32x16_bf16 v[72:87], a[144:147], a[112:115], v[72:87]
    ds_read_b64_tr_b16 a[168:169], v229 offset:10240
    ds_read_b64_tr_b16 a[170:171], v229 offset:11264
    v_mul_f32 v68, v52, v68
    v_mul_f32 v69, v53, v69
    v_mfma_f32_32x32x16_bf16 v[88:103], a[148:151], a[112:115], v[88:103]
    ds_read_b64_tr_b16 a[172:173], v229 offset:22528
    ds_read_b64_tr_b16 a[174:175], v229 offset:23552
    v_mul_f32 v70, v54, v70
    s_waitcnt lgkmcnt(8)
    v_mfma_f32_32x32x16_bf16 v[104:119], a[152:155], a[112:115], v[104:119]
    ds_read_b64_tr_b16 a[144:145], v226 offset:24576
    ds_read_b64_tr_b16 a[146:147], v226 offset:25600
    v_mul_f32 v71, v55, v71
    v_mul_f32 v52, v244, v52
    v_mfma_f32_32x32x16_bf16 v[120:135], a[156:159], a[112:115], v[120:135]
    ds_read_b64_tr_b16 a[148:149], v226 offset:36864
    ds_read_b64_tr_b16 a[150:151], v226 offset:37888
    v_mul_f32 v53, v244, v53
    v_mul_f32 v54, v244, v54
    s_waitcnt lgkmcnt(8)
    v_mfma_f32_32x32x16_bf16 v[72:87], a[160:163], a[116:119], v[72:87]
    ds_read_b64_tr_b16 a[152:153], v229 offset:24576
    ds_read_b64_tr_b16 a[154:155], v229 offset:25600
    v_mul_f32 v55, v244, v55
    v_exp_f32 v52, v52
    v_mfma_f32_32x32x16_bf16 v[88:103], a[164:167], a[116:119], v[88:103]
    ds_read_b64_tr_b16 a[156:157], v229 offset:36864
    ds_read_b64_tr_b16 a[158:159], v229 offset:37888
    v_exp_f32 v53, v53
    s_waitcnt lgkmcnt(8)
    v_mfma_f32_32x32x16_bf16 v[104:119], a[168:171], a[116:119], v[104:119]
    ds_read_b64_tr_b16 a[160:161], v226 offset:26624
    ds_read_b64_tr_b16 a[162:163], v226 offset:27648
    v_exp_f32 v54, v54
    v_exp_f32 v55, v55
    v_mfma_f32_32x32x16_bf16 v[120:135], a[172:175], a[116:119], v[120:135]
    ds_read_b64_tr_b16 a[164:165], v226 offset:38912
    ds_read_b64_tr_b16 a[166:167], v226 offset:39936
    v_fma_f32 v52, v52, v245, v245
    v_fma_f32 v53, v53, v245, v245
    s_waitcnt vmcnt(23)
    s_barrier
    s_waitcnt lgkmcnt(8)
    v_mfma_f32_32x32x16_bf16 v[72:87], a[144:147], a[120:123], v[72:87]
    ds_read_b64_tr_b16 a[168:169], v229 offset:26624
    ds_read_b64_tr_b16 a[170:171], v229 offset:27648
    v_fma_f32 v54, v54, v245, v245
    s_add_u32 m0, s30, 98304
    s_add_u32 s5, s28, 3539200
    buffer_load_dwordx4 v233, s[12:15], s5 offen lds
    buffer_load_dwordx4 v234, s[12:15], s5 offen offset:1024 lds
    buffer_load_dwordx4 v235, s[12:15], s5 offen offset:2048 lds
    v_mfma_f32_32x32x16_bf16 v[88:103], a[148:151], a[120:123], v[88:103]
    ds_read_b64_tr_b16 a[172:173], v229 offset:38912
    ds_read_b64_tr_b16 a[174:175], v229 offset:39936
    v_fma_f32 v55, v55, v245, v245
    v_rcp_f32 v52, v52
    s_waitcnt lgkmcnt(8)
    v_mfma_f32_32x32x16_bf16 v[104:119], a[152:155], a[120:123], v[104:119]
    ds_read_b64_tr_b16 a[144:145], v226 offset:28672
    ds_read_b64_tr_b16 a[146:147], v226 offset:29696
    v_rcp_f32 v53, v53
    v_rcp_f32 v54, v54
    v_mfma_f32_32x32x16_bf16 v[120:135], a[156:159], a[120:123], v[120:135]
    ds_read_b64_tr_b16 a[148:149], v226 offset:40960
    ds_read_b64_tr_b16 a[150:151], v226 offset:41984
    v_rcp_f32 v55, v55
    v_mul_f32 v68, v68, v52
    s_waitcnt lgkmcnt(8)
    v_mfma_f32_32x32x16_bf16 v[72:87], a[160:163], a[124:127], v[72:87]
    ds_read_b64_tr_b16 a[152:153], v229 offset:28672
    ds_read_b64_tr_b16 a[154:155], v229 offset:29696
    v_mul_f32 v69, v69, v53
    s_add_u32 m0, s30, 101376
    s_add_u32 s5, s28, 3760384
    buffer_load_dwordx4 v233, s[12:15], s5 offen lds
    buffer_load_dwordx4 v234, s[12:15], s5 offen offset:1024 lds
    buffer_load_dwordx4 v235, s[12:15], s5 offen offset:2048 lds
    v_mfma_f32_32x32x16_bf16 v[88:103], a[164:167], a[124:127], v[88:103]
    ds_read_b64_tr_b16 a[156:157], v229 offset:40960
    ds_read_b64_tr_b16 a[158:159], v229 offset:41984
    v_mul_f32 v70, v70, v54
    v_mul_f32 v71, v71, v55
    s_waitcnt lgkmcnt(8)
    v_mfma_f32_32x32x16_bf16 v[104:119], a[168:171], a[124:127], v[104:119]
    ds_read_b64_tr_b16 a[160:161], v226 offset:30720
    ds_read_b64_tr_b16 a[162:163], v226 offset:31744
    v_cvt_pk_bf16_f32 v150, v68, v69
    v_cvt_pk_bf16_f32 v151, v70, v71
    v_mfma_f32_32x32x16_bf16 v[120:135], a[172:175], a[124:127], v[120:135]
    ds_read_b64_tr_b16 a[164:165], v226 offset:43008
    ds_read_b64_tr_b16 a[166:167], v226 offset:44032
    s_add_u32 s31, s52, 3072
    buffer_store_dwordx4 v[148:151], v242, s[16:19], s31 offen sc1
    s_waitcnt lgkmcnt(8)
    v_mfma_f32_32x32x16_bf16 v[72:87], a[144:147], a[128:131], v[72:87]
    ds_read_b64_tr_b16 a[168:169], v229 offset:30720
    ds_read_b64_tr_b16 a[170:171], v229 offset:31744
    v_mfma_f32_32x32x16_bf16 v[88:103], a[148:151], a[128:131], v[88:103]
    ds_read_b64_tr_b16 a[172:173], v229 offset:43008
    ds_read_b64_tr_b16 a[174:175], v229 offset:44032
    s_waitcnt lgkmcnt(8)
    v_mfma_f32_32x32x16_bf16 v[104:119], a[152:155], a[128:131], v[104:119]
    ds_read_b64_tr_b16 a[144:145], v226 offset:32768
    ds_read_b64_tr_b16 a[146:147], v226 offset:33792
    v_mfma_f32_32x32x16_bf16 v[120:135], a[156:159], a[128:131], v[120:135]
    ds_read_b64_tr_b16 a[148:149], v226 offset:45056
    ds_read_b64_tr_b16 a[150:151], v226 offset:46080
    s_waitcnt lgkmcnt(8)
    v_mfma_f32_32x32x16_bf16 v[72:87], a[160:163], a[132:135], v[72:87]
    ds_read_b64_tr_b16 a[152:153], v229 offset:32768
    ds_read_b64_tr_b16 a[154:155], v229 offset:33792
    v_mfma_f32_32x32x16_bf16 v[88:103], a[164:167], a[132:135], v[88:103]
    ds_read_b64_tr_b16 a[156:157], v229 offset:45056
    ds_read_b64_tr_b16 a[158:159], v229 offset:46080
    s_waitcnt lgkmcnt(8)
    v_mfma_f32_32x32x16_bf16 v[104:119], a[168:171], a[132:135], v[104:119]
    ds_read_b64_tr_b16 a[160:161], v226 offset:34816
    ds_read_b64_tr_b16 a[162:163], v226 offset:35840
    v_mfma_f32_32x32x16_bf16 v[120:135], a[172:175], a[132:135], v[120:135]
    ds_read_b64_tr_b16 a[164:165], v226 offset:47104
    ds_read_b64_tr_b16 a[166:167], v226 offset:48128
    s_waitcnt lgkmcnt(8)
    v_mfma_f32_32x32x16_bf16 v[72:87], a[144:147], a[136:139], v[72:87]
    ds_read_b64_tr_b16 a[168:169], v229 offset:34816
    ds_read_b64_tr_b16 a[170:171], v229 offset:35840
    v_mfma_f32_32x32x16_bf16 v[88:103], a[148:151], a[136:139], v[88:103]
    ds_read_b64_tr_b16 a[172:173], v229 offset:47104
    ds_read_b64_tr_b16 a[174:175], v229 offset:48128
    s_waitcnt lgkmcnt(8)
    v_mfma_f32_32x32x16_bf16 v[104:119], a[152:155], a[136:139], v[104:119]
    ds_read_b64_tr_b16 a[144:145], v224 offset:0
    ds_read_b64_tr_b16 a[146:147], v224 offset:1024
    v_mfma_f32_32x32x16_bf16 v[120:135], a[156:159], a[136:139], v[120:135]
    ds_read_b64_tr_b16 a[148:149], v224 offset:12288
    ds_read_b64_tr_b16 a[150:151], v224 offset:13312
    s_waitcnt lgkmcnt(8)
    v_mfma_f32_32x32x16_bf16 v[72:87], a[160:163], a[140:143], v[72:87]
    ds_read_b64_tr_b16 a[152:153], v227 offset:0
    ds_read_b64_tr_b16 a[154:155], v227 offset:1024
    v_mfma_f32_32x32x16_bf16 v[88:103], a[164:167], a[140:143], v[88:103]
    ds_read_b64_tr_b16 a[156:157], v227 offset:12288
    ds_read_b64_tr_b16 a[158:159], v227 offset:13312
    s_waitcnt lgkmcnt(8)
    v_mfma_f32_32x32x16_bf16 v[104:119], a[168:171], a[140:143], v[104:119]
    ds_read_b64_tr_b16 a[160:161], v224 offset:2048
    ds_read_b64_tr_b16 a[162:163], v224 offset:3072
    v_mfma_f32_32x32x16_bf16 v[120:135], a[172:175], a[140:143], v[120:135]
    ds_read_b64_tr_b16 a[164:165], v224 offset:14336
    ds_read_b64_tr_b16 a[166:167], v224 offset:15360
    s_waitcnt vmcnt(23)
    s_barrier
    s_waitcnt lgkmcnt(8)
    v_mfma_f32_32x32x16_bf16 v[8:23], a[144:147], a[0:3], 0
    ds_read_b64_tr_b16 a[168:169], v227 offset:2048
    ds_read_b64_tr_b16 a[170:171], v227 offset:3072
    s_add_u32 m0, s30, 122880
    s_add_u32 s5, s28, 4423936
    buffer_load_dwordx4 v233, s[12:15], s5 offen lds
    buffer_load_dwordx4 v234, s[12:15], s5 offen offset:1024 lds
    buffer_load_dwordx4 v235, s[12:15], s5 offen offset:2048 lds
    v_mfma_f32_32x32x16_bf16 v[24:39], a[148:151], a[0:3], 0
    ds_read_b64_tr_b16 a[172:173], v227 offset:14336
    ds_read_b64_tr_b16 a[174:175], v227 offset:15360
    s_waitcnt lgkmcnt(8)
    v_mfma_f32_32x32x16_bf16 v[40:55], a[152:155], a[0:3], 0
    ds_read_b64_tr_b16 a[144:145], v224 offset:4096
    ds_read_b64_tr_b16 a[146:147], v224 offset:5120
    v_mfma_f32_32x32x16_bf16 v[56:71], a[156:159], a[0:3], 0
    ds_read_b64_tr_b16 a[148:149], v224 offset:16384
    ds_read_b64_tr_b16 a[150:151], v224 offset:17408
    s_waitcnt lgkmcnt(8)
    v_mfma_f32_32x32x16_bf16 v[8:23], a[160:163], a[4:7], v[8:23]
    ds_read_b64_tr_b16 a[152:153], v227 offset:4096
    ds_read_b64_tr_b16 a[154:155], v227 offset:5120
    s_add_u32 m0, s30, 125952
    s_add_u32 s5, s28, 4645120
    buffer_load_dwordx4 v233, s[12:15], s5 offen lds
    buffer_load_dwordx4 v234, s[12:15], s5 offen offset:1024 lds
    buffer_load_dwordx4 v235, s[12:15], s5 offen offset:2048 lds
    v_mfma_f32_32x32x16_bf16 v[24:39], a[164:167], a[4:7], v[24:39]
    ds_read_b64_tr_b16 a[156:157], v227 offset:16384
    ds_read_b64_tr_b16 a[158:159], v227 offset:17408
    v_mul_f32 v88, v72, v88
    v_mul_f32 v89, v73, v89
    s_waitcnt lgkmcnt(8)
    v_mfma_f32_32x32x16_bf16 v[40:55], a[168:171], a[4:7], v[40:55]
    ds_read_b64_tr_b16 a[160:161], v224 offset:6144
    ds_read_b64_tr_b16 a[162:163], v224 offset:7168
    v_mul_f32 v90, v74, v90
    v_mul_f32 v91, v75, v91
    v_mfma_f32_32x32x16_bf16 v[56:71], a[172:175], a[4:7], v[56:71]
    ds_read_b64_tr_b16 a[164:165], v224 offset:18432
    ds_read_b64_tr_b16 a[166:167], v224 offset:19456
    v_mul_f32 v72, v244, v72
    v_mul_f32 v73, v244, v73
    s_waitcnt lgkmcnt(8)
    v_mfma_f32_32x32x16_bf16 v[8:23], a[144:147], a[8:11], v[8:23]
    ds_read_b64_tr_b16 a[168:169], v227 offset:6144
    ds_read_b64_tr_b16 a[170:171], v227 offset:7168
    v_mul_f32 v74, v244, v74
    v_mfma_f32_32x32x16_bf16 v[24:39], a[148:151], a[8:11], v[24:39]
    ds_read_b64_tr_b16 a[172:173], v227 offset:18432
    ds_read_b64_tr_b16 a[174:175], v227 offset:19456
    v_mul_f32 v75, v244, v75
    v_exp_f32 v72, v72
    s_waitcnt lgkmcnt(8)
    v_mfma_f32_32x32x16_bf16 v[40:55], a[152:155], a[8:11], v[40:55]
    ds_read_b64_tr_b16 a[144:145], v224 offset:8192
    ds_read_b64_tr_b16 a[146:147], v224 offset:9216
    v_exp_f32 v73, v73
    v_exp_f32 v74, v74
    v_mfma_f32_32x32x16_bf16 v[56:71], a[156:159], a[8:11], v[56:71]
    ds_read_b64_tr_b16 a[148:149], v224 offset:20480
    ds_read_b64_tr_b16 a[150:151], v224 offset:21504
    v_exp_f32 v75, v75
    v_fma_f32 v72, v72, v245, v245
    s_waitcnt lgkmcnt(8)
    v_mfma_f32_32x32x16_bf16 v[8:23], a[160:163], a[12:15], v[8:23]
    ds_read_b64_tr_b16 a[152:153], v227 offset:8192
    ds_read_b64_tr_b16 a[154:155], v227 offset:9216
    s_movk_i32 s31, 5120
    buffer_load_dword v2, v3, s[20:23], s31 offen
    v_fma_f32 v73, v73, v245, v245
    v_mfma_f32_32x32x16_bf16 v[24:39], a[164:167], a[12:15], v[24:39]
    ds_read_b64_tr_b16 a[156:157], v227 offset:20480
    ds_read_b64_tr_b16 a[158:159], v227 offset:21504
    v_fma_f32 v74, v74, v245, v245
    v_fma_f32 v75, v75, v245, v245
    s_waitcnt lgkmcnt(8)
    v_mfma_f32_32x32x16_bf16 v[40:55], a[168:171], a[12:15], v[40:55]
    ds_read_b64_tr_b16 a[160:161], v224 offset:10240
    ds_read_b64_tr_b16 a[162:163], v224 offset:11264
    v_rcp_f32 v72, v72
    v_rcp_f32 v73, v73
    v_mfma_f32_32x32x16_bf16 v[56:71], a[172:175], a[12:15], v[56:71]
    ds_read_b64_tr_b16 a[164:165], v224 offset:22528
    ds_read_b64_tr_b16 a[166:167], v224 offset:23552
    v_rcp_f32 v74, v74
    s_waitcnt lgkmcnt(8)
    v_mfma_f32_32x32x16_bf16 v[8:23], a[144:147], a[16:19], v[8:23]
    ds_read_b64_tr_b16 a[168:169], v227 offset:10240
    ds_read_b64_tr_b16 a[170:171], v227 offset:11264
    v_rcp_f32 v75, v75
    v_mul_f32 v88, v88, v72
    v_mfma_f32_32x32x16_bf16 v[24:39], a[148:151], a[16:19], v[24:39]
    ds_read_b64_tr_b16 a[172:173], v227 offset:22528
    ds_read_b64_tr_b16 a[174:175], v227 offset:23552
    v_mul_f32 v89, v89, v73
    v_mul_f32 v90, v90, v74
    s_waitcnt lgkmcnt(8)
    v_mfma_f32_32x32x16_bf16 v[40:55], a[152:155], a[16:19], v[40:55]
    ds_read_b64_tr_b16 a[144:145], v224 offset:24576
    ds_read_b64_tr_b16 a[146:147], v224 offset:25600
    v_mul_f32 v91, v91, v75
    v_cvt_pk_bf16_f32 v152, v88, v89
    s_waitcnt vmcnt(7)
    v_mov_b32 v250, 1
    buffer_store_dword v250, v246, s[16:19], s54 offen sc1
    v_mfma_f32_32x32x16_bf16 v[56:71], a[156:159], a[16:19], v[56:71]
    ds_read_b64_tr_b16 a[148:149], v224 offset:36864
    ds_read_b64_tr_b16 a[150:151], v224 offset:37888
    v_cvt_pk_bf16_f32 v153, v90, v91
    s_waitcnt lgkmcnt(8)
    v_mfma_f32_32x32x16_bf16 v[8:23], a[160:163], a[20:23], v[8:23]
    ds_read_b64_tr_b16 a[152:153], v227 offset:24576
    ds_read_b64_tr_b16 a[154:155], v227 offset:25600
    v_mul_f32 v92, v76, v92
    v_mul_f32 v93, v77, v93
    v_mfma_f32_32x32x16_bf16 v[24:39], a[164:167], a[20:23], v[24:39]
    ds_read_b64_tr_b16 a[156:157], v227 offset:36864
    ds_read_b64_tr_b16 a[158:159], v227 offset:37888
    v_mul_f32 v94, v78, v94
    v_mul_f32 v95, v79, v95
    s_waitcnt lgkmcnt(8)
    v_mfma_f32_32x32x16_bf16 v[40:55], a[168:171], a[20:23], v[40:55]
    ds_read_b64_tr_b16 a[160:161], v224 offset:26624
    ds_read_b64_tr_b16 a[162:163], v224 offset:27648
    v_mul_f32 v76, v244, v76
    v_mul_f32 v77, v244, v77
    v_mfma_f32_32x32x16_bf16 v[56:71], a[172:175], a[20:23], v[56:71]
    ds_read_b64_tr_b16 a[164:165], v224 offset:38912
    ds_read_b64_tr_b16 a[166:167], v224 offset:39936
    v_mul_f32 v78, v244, v78
    s_waitcnt vmcnt(23)
    s_barrier
    s_waitcnt lgkmcnt(8)
    v_mfma_f32_32x32x16_bf16 v[8:23], a[144:147], a[24:27], v[8:23]
    ds_read_b64_tr_b16 a[168:169], v227 offset:26624
    ds_read_b64_tr_b16 a[170:171], v227 offset:27648
    v_mul_f32 v79, v244, v79
    v_exp_f32 v76, v76
    s_add_u32 m0, s30, 0
    s_add_u32 s5, s28, 384
    buffer_load_dwordx4 v233, s[12:15], s5 offen lds
    buffer_load_dwordx4 v234, s[12:15], s5 offen offset:1024 lds
    buffer_load_dwordx4 v235, s[12:15], s5 offen offset:2048 lds
    v_mfma_f32_32x32x16_bf16 v[24:39], a[148:151], a[24:27], v[24:39]
    ds_read_b64_tr_b16 a[172:173], v227 offset:38912
    ds_read_b64_tr_b16 a[174:175], v227 offset:39936
    v_exp_f32 v77, v77
    v_exp_f32 v78, v78
    s_waitcnt lgkmcnt(8)
    v_mfma_f32_32x32x16_bf16 v[40:55], a[152:155], a[24:27], v[40:55]
    ds_read_b64_tr_b16 a[144:145], v224 offset:28672
    ds_read_b64_tr_b16 a[146:147], v224 offset:29696
    v_exp_f32 v79, v79
    v_mfma_f32_32x32x16_bf16 v[56:71], a[156:159], a[24:27], v[56:71]
    ds_read_b64_tr_b16 a[148:149], v224 offset:40960
    ds_read_b64_tr_b16 a[150:151], v224 offset:41984
    v_fma_f32 v76, v76, v245, v245
    v_fma_f32 v77, v77, v245, v245
    s_waitcnt lgkmcnt(8)
    v_mfma_f32_32x32x16_bf16 v[8:23], a[160:163], a[28:31], v[8:23]
    ds_read_b64_tr_b16 a[152:153], v227 offset:28672
    ds_read_b64_tr_b16 a[154:155], v227 offset:29696
    v_fma_f32 v78, v78, v245, v245
    v_fma_f32 v79, v79, v245, v245
    s_add_u32 m0, s30, 3072
    s_add_u32 s5, s28, 221568
    buffer_load_dwordx4 v233, s[12:15], s5 offen lds
    buffer_load_dwordx4 v234, s[12:15], s5 offen offset:1024 lds
    buffer_load_dwordx4 v235, s[12:15], s5 offen offset:2048 lds
    v_mfma_f32_32x32x16_bf16 v[24:39], a[164:167], a[28:31], v[24:39]
    ds_read_b64_tr_b16 a[156:157], v227 offset:40960
    ds_read_b64_tr_b16 a[158:159], v227 offset:41984
    v_rcp_f32 v76, v76
    v_rcp_f32 v77, v77
    s_waitcnt lgkmcnt(8)
    v_mfma_f32_32x32x16_bf16 v[40:55], a[168:171], a[28:31], v[40:55]
    ds_read_b64_tr_b16 a[160:161], v224 offset:30720
    ds_read_b64_tr_b16 a[162:163], v224 offset:31744
    v_rcp_f32 v78, v78
    v_mfma_f32_32x32x16_bf16 v[56:71], a[172:175], a[28:31], v[56:71]
    ds_read_b64_tr_b16 a[164:165], v224 offset:43008
    ds_read_b64_tr_b16 a[166:167], v224 offset:44032
    v_rcp_f32 v79, v79
    v_mul_f32 v92, v92, v76
    s_waitcnt lgkmcnt(8)
    v_mfma_f32_32x32x16_bf16 v[8:23], a[144:147], a[32:35], v[8:23]
    ds_read_b64_tr_b16 a[168:169], v227 offset:30720
    ds_read_b64_tr_b16 a[170:171], v227 offset:31744
    v_mul_f32 v93, v93, v77
    v_mul_f32 v94, v94, v78
    v_mfma_f32_32x32x16_bf16 v[24:39], a[148:151], a[32:35], v[24:39]
    ds_read_b64_tr_b16 a[172:173], v227 offset:43008
    ds_read_b64_tr_b16 a[174:175], v227 offset:44032
    v_mul_f32 v95, v95, v79
    s_waitcnt lgkmcnt(8)
    v_mfma_f32_32x32x16_bf16 v[40:55], a[152:155], a[32:35], v[40:55]
    ds_read_b64_tr_b16 a[144:145], v224 offset:32768
    ds_read_b64_tr_b16 a[146:147], v224 offset:33792
    v_cvt_pk_bf16_f32 v154, v92, v93
    v_cvt_pk_bf16_f32 v155, v94, v95
    v_mfma_f32_32x32x16_bf16 v[56:71], a[156:159], a[32:35], v[56:71]
    ds_read_b64_tr_b16 a[148:149], v224 offset:45056
    ds_read_b64_tr_b16 a[150:151], v224 offset:46080
    s_add_u32 s31, s52, 4096
    buffer_store_dwordx4 v[152:155], v242, s[16:19], s31 offen sc1
    v_mul_f32 v96, v80, v96
    s_waitcnt lgkmcnt(8)
    v_mfma_f32_32x32x16_bf16 v[8:23], a[160:163], a[36:39], v[8:23]
    ds_read_b64_tr_b16 a[152:153], v227 offset:32768
    ds_read_b64_tr_b16 a[154:155], v227 offset:33792
    v_mul_f32 v97, v81, v97
    v_mul_f32 v98, v82, v98
    v_mfma_f32_32x32x16_bf16 v[24:39], a[164:167], a[36:39], v[24:39]
    ds_read_b64_tr_b16 a[156:157], v227 offset:45056
    ds_read_b64_tr_b16 a[158:159], v227 offset:46080
    v_mul_f32 v99, v83, v99
    s_waitcnt lgkmcnt(8)
    v_mfma_f32_32x32x16_bf16 v[40:55], a[168:171], a[36:39], v[40:55]
    ds_read_b64_tr_b16 a[160:161], v224 offset:34816
    ds_read_b64_tr_b16 a[162:163], v224 offset:35840
    v_mul_f32 v80, v244, v80
    v_mul_f32 v81, v244, v81
    v_mfma_f32_32x32x16_bf16 v[56:71], a[172:175], a[36:39], v[56:71]
    ds_read_b64_tr_b16 a[164:165], v224 offset:47104
    ds_read_b64_tr_b16 a[166:167], v224 offset:48128
    v_mul_f32 v82, v244, v82
    v_mul_f32 v83, v244, v83
    s_waitcnt lgkmcnt(8)
    v_mfma_f32_32x32x16_bf16 v[8:23], a[144:147], a[40:43], v[8:23]
    ds_read_b64_tr_b16 a[168:169], v227 offset:34816
    ds_read_b64_tr_b16 a[170:171], v227 offset:35840
    v_exp_f32 v80, v80
    v_exp_f32 v81, v81
    v_mfma_f32_32x32x16_bf16 v[24:39], a[148:151], a[40:43], v[24:39]
    ds_read_b64_tr_b16 a[172:173], v227 offset:47104
    ds_read_b64_tr_b16 a[174:175], v227 offset:48128
    v_exp_f32 v82, v82
    s_waitcnt lgkmcnt(8)
    v_mfma_f32_32x32x16_bf16 v[40:55], a[152:155], a[40:43], v[40:55]
    ds_read_b64_tr_b16 a[144:145], v225 offset:0
    ds_read_b64_tr_b16 a[146:147], v225 offset:1024
    v_exp_f32 v83, v83
    v_fma_f32 v80, v80, v245, v245
    v_mfma_f32_32x32x16_bf16 v[56:71], a[156:159], a[40:43], v[56:71]
    ds_read_b64_tr_b16 a[148:149], v225 offset:12288
    ds_read_b64_tr_b16 a[150:151], v225 offset:13312
    v_fma_f32 v81, v81, v245, v245
    v_fma_f32 v82, v82, v245, v245
    s_waitcnt lgkmcnt(8)
    v_mfma_f32_32x32x16_bf16 v[8:23], a[160:163], a[44:47], v[8:23]
    ds_read_b64_tr_b16 a[152:153], v228 offset:0
    ds_read_b64_tr_b16 a[154:155], v228 offset:1024
    v_fma_f32 v83, v83, v245, v245
    v_mfma_f32_32x32x16_bf16 v[24:39], a[164:167], a[44:47], v[24:39]
    ds_read_b64_tr_b16 a[156:157], v228 offset:12288
    ds_read_b64_tr_b16 a[158:159], v228 offset:13312
    v_rcp_f32 v80, v80
    v_rcp_f32 v81, v81
    s_waitcnt lgkmcnt(8)
    v_mfma_f32_32x32x16_bf16 v[40:55], a[168:171], a[44:47], v[40:55]
    ds_read_b64_tr_b16 a[160:161], v225 offset:2048
    ds_read_b64_tr_b16 a[162:163], v225 offset:3072
    v_rcp_f32 v82, v82
    v_rcp_f32 v83, v83
    buffer_load_dword v249, off, s[16:19], s55 offset:0 sc1
    v_mfma_f32_32x32x16_bf16 v[56:71], a[172:175], a[44:47], v[56:71]
    ds_read_b64_tr_b16 a[164:165], v225 offset:14336
    ds_read_b64_tr_b16 a[166:167], v225 offset:15360
    v_mul_f32 v96, v96, v80
    v_mul_f32 v97, v97, v81
    s_waitcnt vmcnt(24)
    s_barrier
    s_waitcnt lgkmcnt(8)
    v_mfma_f32_32x32x16_bf16 v[8:23], a[144:147], a[48:51], v[8:23]
    ds_read_b64_tr_b16 a[168:169], v228 offset:2048
    ds_read_b64_tr_b16 a[170:171], v228 offset:3072
    v_mul_f32 v98, v98, v82
    s_add_u32 m0, s30, 24576
    s_add_u32 s5, s28, 885120
    buffer_load_dwordx4 v233, s[12:15], s5 offen lds
    buffer_load_dwordx4 v234, s[12:15], s5 offen offset:1024 lds
    buffer_load_dwordx4 v235, s[12:15], s5 offen offset:2048 lds
    v_mfma_f32_32x32x16_bf16 v[24:39], a[148:151], a[48:51], v[24:39]
    ds_read_b64_tr_b16 a[172:173], v228 offset:14336
    ds_read_b64_tr_b16 a[174:175], v228 offset:15360
    v_mul_f32 v99, v99, v83
    v_cvt_pk_bf16_f32 v156, v96, v97
    s_waitcnt lgkmcnt(8)
    v_mfma_f32_32x32x16_bf16 v[40:55], a[152:155], a[48:51], v[40:55]
    ds_read_b64_tr_b16 a[144:145], v225 offset:4096
    ds_read_b64_tr_b16 a[146:147], v225 offset:5120
    v_cvt_pk_bf16_f32 v157, v98, v99
    v_mul_f32 v100, v84, v100
    v_mfma_f32_32x32x16_bf16 v[56:71], a[156:159], a[48:51], v[56:71]
    ds_read_b64_tr_b16 a[148:149], v225 offset:16384
    ds_read_b64_tr_b16 a[150:151], v225 offset:17408
    v_mul_f32 v101, v85, v101
    v_mul_f32 v102, v86, v102
    s_waitcnt lgkmcnt(8)
    v_mfma_f32_32x32x16_bf16 v[8:23], a[160:163], a[52:55], v[8:23]
    ds_read_b64_tr_b16 a[152:153], v228 offset:4096
    ds_read_b64_tr_b16 a[154:155], v228 offset:5120
    v_mul_f32 v103, v87, v103
    s_add_u32 m0, s30, 27648
    s_add_u32 s5, s28, 1106304
    buffer_load_dwordx4 v233, s[12:15], s5 offen lds
    buffer_load_dwordx4 v234, s[12:15], s5 offen offset:1024 lds
    buffer_load_dwordx4 v235, s[12:15], s5 offen offset:2048 lds
    v_mfma_f32_32x32x16_bf16 v[24:39], a[164:167], a[52:55], v[24:39]
    ds_read_b64_tr_b16 a[156:157], v228 offset:16384
    ds_read_b64_tr_b16 a[158:159], v228 offset:17408
    v_mul_f32 v84, v244, v84
    v_mul_f32 v85, v244, v85
    s_waitcnt lgkmcnt(8)
    v_mfma_f32_32x32x16_bf16 v[40:55], a[168:171], a[52:55], v[40:55]
    ds_read_b64_tr_b16 a[160:161], v225 offset:6144
    ds_read_b64_tr_b16 a[162:163], v225 offset:7168
    v_mul_f32 v86, v244, v86
    v_mul_f32 v87, v244, v87
    v_mfma_f32_32x32x16_bf16 v[56:71], a[172:175], a[52:55], v[56:71]
    ds_read_b64_tr_b16 a[164:165], v225 offset:18432
    ds_read_b64_tr_b16 a[166:167], v225 offset:19456
    v_exp_f32 v84, v84
    s_waitcnt lgkmcnt(8)
    v_mfma_f32_32x32x16_bf16 v[8:23], a[144:147], a[56:59], v[8:23]
    ds_read_b64_tr_b16 a[168:169], v228 offset:6144
    ds_read_b64_tr_b16 a[170:171], v228 offset:7168
    v_exp_f32 v85, v85
    v_exp_f32 v86, v86
    v_mfma_f32_32x32x16_bf16 v[24:39], a[148:151], a[56:59], v[24:39]
    ds_read_b64_tr_b16 a[172:173], v228 offset:18432
    ds_read_b64_tr_b16 a[174:175], v228 offset:19456
    v_exp_f32 v87, v87
    v_fma_f32 v84, v84, v245, v245
    s_waitcnt lgkmcnt(8)
    v_mfma_f32_32x32x16_bf16 v[40:55], a[152:155], a[56:59], v[40:55]
    ds_read_b64_tr_b16 a[144:145], v225 offset:8192
    ds_read_b64_tr_b16 a[146:147], v225 offset:9216
    v_fma_f32 v85, v85, v245, v245
    v_fma_f32 v86, v86, v245, v245
    v_mfma_f32_32x32x16_bf16 v[56:71], a[156:159], a[56:59], v[56:71]
    ds_read_b64_tr_b16 a[148:149], v225 offset:20480
    ds_read_b64_tr_b16 a[150:151], v225 offset:21504
    v_fma_f32 v87, v87, v245, v245
    s_waitcnt lgkmcnt(8)
    v_mfma_f32_32x32x16_bf16 v[8:23], a[160:163], a[60:63], v[8:23]
    ds_read_b64_tr_b16 a[152:153], v228 offset:8192
    ds_read_b64_tr_b16 a[154:155], v228 offset:9216
    v_rcp_f32 v84, v84
    v_rcp_f32 v85, v85
    v_mfma_f32_32x32x16_bf16 v[24:39], a[164:167], a[60:63], v[24:39]
    ds_read_b64_tr_b16 a[156:157], v228 offset:20480
    ds_read_b64_tr_b16 a[158:159], v228 offset:21504
    v_rcp_f32 v86, v86
    v_rcp_f32 v87, v87
    s_waitcnt lgkmcnt(8)
    v_mfma_f32_32x32x16_bf16 v[40:55], a[168:171], a[60:63], v[40:55]
    ds_read_b64_tr_b16 a[160:161], v225 offset:10240
    ds_read_b64_tr_b16 a[162:163], v225 offset:11264
    v_mul_f32 v100, v100, v84
    s_waitcnt vmcnt(6)
L_ffn_kernel_pca0:
    v_readfirstlane_b32 s50, v249
    s_sub_u32 s51, s51, 1
    s_cselect_b32 s50, 1, s50
    s_cmp_ge_u32 s50, 1
    s_cbranch_scc1 L_ffn_kernel_pda0
    buffer_load_dword v249, off, s[16:19], s55 offset:0 sc1
    s_waitcnt vmcnt(0)
    s_branch L_ffn_kernel_pca0
L_ffn_kernel_pda0:
    v_mfma_f32_32x32x16_bf16 v[56:71], a[172:175], a[60:63], v[56:71]
    ds_read_b64_tr_b16 a[164:165], v225 offset:22528
    ds_read_b64_tr_b16 a[166:167], v225 offset:23552
    v_mul_f32 v101, v101, v85
    v_mul_f32 v102, v102, v86
    s_add_u32 s31, s53, 0
    buffer_load_dwordx4 a[176:179], v242, s[16:19], s31 offen sc1
    s_waitcnt lgkmcnt(8)
    v_mfma_f32_32x32x16_bf16 v[8:23], a[144:147], a[64:67], v[8:23]
    ds_read_b64_tr_b16 a[168:169], v228 offset:10240
    ds_read_b64_tr_b16 a[170:171], v228 offset:11264
    v_mul_f32 v103, v103, v87
    v_cvt_pk_bf16_f32 v158, v100, v101
    v_mfma_f32_32x32x16_bf16 v[24:39], a[148:151], a[64:67], v[24:39]
    ds_read_b64_tr_b16 a[172:173], v228 offset:22528
    ds_read_b64_tr_b16 a[174:175], v228 offset:23552
    v_cvt_pk_bf16_f32 v159, v102, v103
    s_add_u32 s31, s52, 5120
    buffer_store_dwordx4 v[156:159], v242, s[16:19], s31 offen sc1
    s_waitcnt lgkmcnt(8)
    v_mfma_f32_32x32x16_bf16 v[40:55], a[152:155], a[64:67], v[40:55]
    ds_read_b64_tr_b16 a[144:145], v225 offset:24576
    ds_read_b64_tr_b16 a[146:147], v225 offset:25600
    v_mul_f32 v120, v104, v120
    v_mfma_f32_32x32x16_bf16 v[56:71], a[156:159], a[64:67], v[56:71]
    ds_read_b64_tr_b16 a[148:149], v225 offset:36864
    ds_read_b64_tr_b16 a[150:151], v225 offset:37888
    v_mul_f32 v121, v105, v121
    v_mul_f32 v122, v106, v122
    s_waitcnt lgkmcnt(8)
    v_mfma_f32_32x32x16_bf16 v[8:23], a[160:163], a[68:71], v[8:23]
    ds_read_b64_tr_b16 a[152:153], v228 offset:24576
    ds_read_b64_tr_b16 a[154:155], v228 offset:25600
    v_mul_f32 v123, v107, v123
    v_mul_f32 v104, v244, v104
    v_mfma_f32_32x32x16_bf16 v[24:39], a[164:167], a[68:71], v[24:39]
    ds_read_b64_tr_b16 a[156:157], v228 offset:36864
    ds_read_b64_tr_b16 a[158:159], v228 offset:37888
    v_mul_f32 v105, v244, v105
    v_mul_f32 v106, v244, v106
    s_waitcnt lgkmcnt(8)
    v_mfma_f32_32x32x16_bf16 v[40:55], a[168:171], a[68:71], v[40:55]
    ds_read_b64_tr_b16 a[160:161], v225 offset:26624
    ds_read_b64_tr_b16 a[162:163], v225 offset:27648
    v_mul_f32 v107, v244, v107
    v_mfma_f32_32x32x16_bf16 v[56:71], a[172:175], a[68:71], v[56:71]
    ds_read_b64_tr_b16 a[164:165], v225 offset:38912
    ds_read_b64_tr_b16 a[166:167], v225 offset:39936
    v_exp_f32 v104, v104
    v_exp_f32 v105, v105
    s_waitcnt vmcnt(25)
    s_barrier
    s_waitcnt lgkmcnt(8)
    v_mfma_f32_32x32x16_bf16 v[8:23], a[144:147], a[72:75], v[8:23]
    ds_read_b64_tr_b16 a[168:169], v228 offset:26624
    ds_read_b64_tr_b16 a[170:171], v228 offset:27648
    v_exp_f32 v106, v106
    v_exp_f32 v107, v107
    s_add_u32 m0, s30, 49152
    s_add_u32 s5, s28, 1769856
    buffer_load_dwordx4 v233, s[12:15], s5 offen lds
    buffer_load_dwordx4 v234, s[12:15], s5 offen offset:1024 lds
    buffer_load_dwordx4 v235, s[12:15], s5 offen offset:2048 lds
    v_mfma_f32_32x32x16_bf16 v[24:39], a[148:151], a[72:75], v[24:39]
    ds_read_b64_tr_b16 a[172:173], v228 offset:38912
    ds_read_b64_tr_b16 a[174:175], v228 offset:39936
    v_fma_f32 v104, v104, v245, v245
    s_waitcnt lgkmcnt(8)
    v_mfma_f32_32x32x16_bf16 v[40:55], a[152:155], a[72:75], v[40:55]
    ds_read_b64_tr_b16 a[144:145], v225 offset:28672
    ds_read_b64_tr_b16 a[146:147], v225 offset:29696
    v_fma_f32 v105, v105, v245, v245
    v_fma_f32 v106, v106, v245, v245
    v_mfma_f32_32x32x16_bf16 v[56:71], a[156:159], a[72:75], v[56:71]
    ds_read_b64_tr_b16 a[148:149], v225 offset:40960
    ds_read_b64_tr_b16 a[150:151], v225 offset:41984
    v_fma_f32 v107, v107, v245, v245
    v_rcp_f32 v104, v104
    s_waitcnt lgkmcnt(8)
    v_mfma_f32_32x32x16_bf16 v[8:23], a[160:163], a[76:79], v[8:23]
    ds_read_b64_tr_b16 a[152:153], v228 offset:28672
    ds_read_b64_tr_b16 a[154:155], v228 offset:29696
    v_rcp_f32 v105, v105
    v_rcp_f32 v106, v106
    s_add_u32 m0, s30, 52224
    s_add_u32 s5, s28, 1991040
    buffer_load_dwordx4 v233, s[12:15], s5 offen lds
    buffer_load_dwordx4 v234, s[12:15], s5 offen offset:1024 lds
    buffer_load_dwordx4 v235, s[12:15], s5 offen offset:2048 lds
    v_mfma_f32_32x32x16_bf16 v[24:39], a[164:167], a[76:79], v[24:39]
    ds_read_b64_tr_b16 a[156:157], v228 offset:40960
    ds_read_b64_tr_b16 a[158:159], v228 offset:41984
    v_rcp_f32 v107, v107
    s_waitcnt lgkmcnt(8)
    v_mfma_f32_32x32x16_bf16 v[40:55], a[168:171], a[76:79], v[40:55]
    ds_read_b64_tr_b16 a[160:161], v225 offset:30720
    ds_read_b64_tr_b16 a[162:163], v225 offset:31744
    v_mul_f32 v120, v120, v104
    v_mul_f32 v121, v121, v105
    v_mfma_f32_32x32x16_bf16 v[56:71], a[172:175], a[76:79], v[56:71]
    ds_read_b64_tr_b16 a[164:165], v225 offset:43008
    ds_read_b64_tr_b16 a[166:167], v225 offset:44032
    v_mul_f32 v122, v122, v106
    v_mul_f32 v123, v123, v107
    s_waitcnt lgkmcnt(8)
    v_mfma_f32_32x32x16_bf16 v[8:23], a[144:147], a[80:83], v[8:23]
    ds_read_b64_tr_b16 a[168:169], v228 offset:30720
    ds_read_b64_tr_b16 a[170:171], v228 offset:31744
    v_cvt_pk_bf16_f32 v160, v120, v121
    v_mfma_f32_32x32x16_bf16 v[24:39], a[148:151], a[80:83], v[24:39]
    ds_read_b64_tr_b16 a[172:173], v228 offset:43008
    ds_read_b64_tr_b16 a[174:175], v228 offset:44032
    v_cvt_pk_bf16_f32 v161, v122, v123
    v_mul_f32 v124, v108, v124
    s_add_u32 s31, s53, 1024
    buffer_load_dwordx4 a[180:183], v242, s[16:19], s31 offen sc1
    s_waitcnt lgkmcnt(8)
    v_mfma_f32_32x32x16_bf16 v[40:55], a[152:155], a[80:83], v[40:55]
    ds_read_b64_tr_b16 a[144:145], v225 offset:32768
    ds_read_b64_tr_b16 a[146:147], v225 offset:33792
    v_mul_f32 v125, v109, v125
    v_mul_f32 v126, v110, v126
    v_mfma_f32_32x32x16_bf16 v[56:71], a[156:159], a[80:83], v[56:71]
    ds_read_b64_tr_b16 a[148:149], v225 offset:45056
    ds_read_b64_tr_b16 a[150:151], v225 offset:46080
    v_mul_f32 v127, v111, v127
    v_mul_f32 v108, v244, v108
    s_waitcnt lgkmcnt(8)
    v_mfma_f32_32x32x16_bf16 v[8:23], a[160:163], a[84:87], v[8:23]
    ds_read_b64_tr_b16 a[152:153], v228 offset:32768
    ds_read_b64_tr_b16 a[154:155], v228 offset:33792
    v_mul_f32 v109, v244, v109
    v_mfma_f32_32x32x16_bf16 v[24:39], a[164:167], a[84:87], v[24:39]
    ds_read_b64_tr_b16 a[156:157], v228 offset:45056
    ds_read_b64_tr_b16 a[158:159], v228 offset:46080
    v_mul_f32 v110, v244, v110
    v_mul_f32 v111, v244, v111
    s_waitcnt lgkmcnt(8)
    v_mfma_f32_32x32x16_bf16 v[40:55], a[168:171], a[84:87], v[40:55]
    ds_read_b64_tr_b16 a[160:161], v225 offset:34816
    ds_read_b64_tr_b16 a[162:163], v225 offset:35840
    v_exp_f32 v108, v108
    v_exp_f32 v109, v109
    v_mfma_f32_32x32x16_bf16 v[56:71], a[172:175], a[84:87], v[56:71]
    ds_read_b64_tr_b16 a[164:165], v225 offset:47104
    ds_read_b64_tr_b16 a[166:167], v225 offset:48128
    v_exp_f32 v110, v110
    v_exp_f32 v111, v111
    s_waitcnt lgkmcnt(8)
    v_mfma_f32_32x32x16_bf16 v[8:23], a[144:147], a[88:91], v[8:23]
    ds_read_b64_tr_b16 a[168:169], v228 offset:34816
    ds_read_b64_tr_b16 a[170:171], v228 offset:35840
    v_fma_f32 v108, v108, v245, v245
    v_mfma_f32_32x32x16_bf16 v[24:39], a[148:151], a[88:91], v[24:39]
    ds_read_b64_tr_b16 a[172:173], v228 offset:47104
    ds_read_b64_tr_b16 a[174:175], v228 offset:48128
    v_fma_f32 v109, v109, v245, v245
    v_fma_f32 v110, v110, v245, v245
    s_waitcnt lgkmcnt(8)
    v_mfma_f32_32x32x16_bf16 v[40:55], a[152:155], a[88:91], v[40:55]
    ds_read_b64_tr_b16 a[144:145], v226 offset:0
    ds_read_b64_tr_b16 a[146:147], v226 offset:1024
    v_fma_f32 v111, v111, v245, v245
    v_rcp_f32 v108, v108
    v_mfma_f32_32x32x16_bf16 v[56:71], a[156:159], a[88:91], v[56:71]
    ds_read_b64_tr_b16 a[148:149], v226 offset:12288
    ds_read_b64_tr_b16 a[150:151], v226 offset:13312
    v_rcp_f32 v109, v109
    s_waitcnt lgkmcnt(8)
    v_mfma_f32_32x32x16_bf16 v[8:23], a[160:163], a[92:95], v[8:23]
    ds_read_b64_tr_b16 a[152:153], v229 offset:0
    ds_read_b64_tr_b16 a[154:155], v229 offset:1024
    v_rcp_f32 v110, v110
    v_rcp_f32 v111, v111
    v_mfma_f32_32x32x16_bf16 v[24:39], a[164:167], a[92:95], v[24:39]
    ds_read_b64_tr_b16 a[156:157], v229 offset:12288
    ds_read_b64_tr_b16 a[158:159], v229 offset:13312
    v_mul_f32 v124, v124, v108
    v_mul_f32 v125, v125, v109
    s_waitcnt lgkmcnt(8)
    v_mfma_f32_32x32x16_bf16 v[40:55], a[168:171], a[92:95], v[40:55]
    ds_read_b64_tr_b16 a[160:161], v226 offset:2048
    ds_read_b64_tr_b16 a[162:163], v226 offset:3072
    v_mul_f32 v126, v126, v110
    v_mul_f32 v127, v127, v111
    v_mfma_f32_32x32x16_bf16 v[56:71], a[172:175], a[92:95], v[56:71]
    ds_read_b64_tr_b16 a[164:165], v226 offset:14336
    ds_read_b64_tr_b16 a[166:167], v226 offset:15360
    v_cvt_pk_bf16_f32 v162, v124, v125
    s_waitcnt vmcnt(25)
    s_barrier
    s_waitcnt lgkmcnt(8)
    v_mfma_f32_32x32x16_bf16 v[8:23], a[144:147], a[96:99], v[8:23]
    ds_read_b64_tr_b16 a[168:169], v229 offset:2048
    ds_read_b64_tr_b16 a[170:171], v229 offset:3072
    v_cvt_pk_bf16_f32 v163, v126, v127
    s_add_u32 s31, s52, 6144
    buffer_store_dwordx4 v[160:163], v242, s[16:19], s31 offen sc1
    s_add_u32 m0, s30, 73728
    s_add_u32 s5, s28, 2654592
    buffer_load_dwordx4 v233, s[12:15], s5 offen lds
    buffer_load_dwordx4 v234, s[12:15], s5 offen offset:1024 lds
    buffer_load_dwordx4 v235, s[12:15], s5 offen offset:2048 lds
    v_mfma_f32_32x32x16_bf16 v[24:39], a[148:151], a[96:99], v[24:39]
    ds_read_b64_tr_b16 a[172:173], v229 offset:14336
    ds_read_b64_tr_b16 a[174:175], v229 offset:15360
    v_mul_f32 v128, v112, v128
    v_mul_f32 v129, v113, v129
    s_waitcnt lgkmcnt(8)
    v_mfma_f32_32x32x16_bf16 v[40:55], a[152:155], a[96:99], v[40:55]
    ds_read_b64_tr_b16 a[144:145], v226 offset:4096
    ds_read_b64_tr_b16 a[146:147], v226 offset:5120
    v_mul_f32 v130, v114, v130
    v_mul_f32 v131, v115, v131
    v_mfma_f32_32x32x16_bf16 v[56:71], a[156:159], a[96:99], v[56:71]
    ds_read_b64_tr_b16 a[148:149], v226 offset:16384
    ds_read_b64_tr_b16 a[150:151], v226 offset:17408
    v_mul_f32 v112, v244, v112
    s_add_u32 s31, s53, 2048
    buffer_load_dwordx4 a[184:187], v242, s[16:19], s31 offen sc1
    s_waitcnt lgkmcnt(8)
    v_mfma_f32_32x32x16_bf16 v[8:23], a[160:163], a[100:103], v[8:23]
    ds_read_b64_tr_b16 a[152:153], v229 offset:4096
    ds_read_b64_tr_b16 a[154:155], v229 offset:5120
    v_mul_f32 v113, v244, v113
    v_mul_f32 v114, v244, v114
    s_add_u32 m0, s30, 76800
    s_add_u32 s5, s28, 2875776
    buffer_load_dwordx4 v233, s[12:15], s5 offen lds
    buffer_load_dwordx4 v234, s[12:15], s5 offen offset:1024 lds
    buffer_load_dwordx4 v235, s[12:15], s5 offen offset:2048 lds
    v_mfma_f32_32x32x16_bf16 v[24:39], a[164:167], a[100:103], v[24:39]
    ds_read_b64_tr_b16 a[156:157], v229 offset:16384
    ds_read_b64_tr_b16 a[158:159], v229 offset:17408
    v_mul_f32 v115, v244, v115
    v_exp_f32 v112, v112
    s_waitcnt lgkmcnt(8)
    v_mfma_f32_32x32x16_bf16 v[40:55], a[168:171], a[100:103], v[40:55]
    ds_read_b64_tr_b16 a[160:161], v226 offset:6144
    ds_read_b64_tr_b16 a[162:163], v226 offset:7168
    v_exp_f32 v113, v113
    v_mfma_f32_32x32x16_bf16 v[56:71], a[172:175], a[100:103], v[56:71]
    ds_read_b64_tr_b16 a[164:165], v226 offset:18432
    ds_read_b64_tr_b16 a[166:167], v226 offset:19456
    v_exp_f32 v114, v114
    v_exp_f32 v115, v115
    s_waitcnt lgkmcnt(8)
    v_mfma_f32_32x32x16_bf16 v[8:23], a[144:147], a[104:107], v[8:23]
    ds_read_b64_tr_b16 a[168:169], v229 offset:6144
    ds_read_b64_tr_b16 a[170:171], v229 offset:7168
    v_fma_f32 v112, v112, v245, v245
    v_fma_f32 v113, v113, v245, v245
    v_mfma_f32_32x32x16_bf16 v[24:39], a[148:151], a[104:107], v[24:39]
    ds_read_b64_tr_b16 a[172:173], v229 offset:18432
    ds_read_b64_tr_b16 a[174:175], v229 offset:19456
    v_fma_f32 v114, v114, v245, v245
    v_fma_f32 v115, v115, v245, v245
    s_waitcnt lgkmcnt(8)
    v_mfma_f32_32x32x16_bf16 v[40:55], a[152:155], a[104:107], v[40:55]
    ds_read_b64_tr_b16 a[144:145], v226 offset:8192
    ds_read_b64_tr_b16 a[146:147], v226 offset:9216
    v_rcp_f32 v112, v112
    v_mfma_f32_32x32x16_bf16 v[56:71], a[156:159], a[104:107], v[56:71]
    ds_read_b64_tr_b16 a[148:149], v226 offset:20480
    ds_read_b64_tr_b16 a[150:151], v226 offset:21504
    v_rcp_f32 v113, v113
    v_rcp_f32 v114, v114
    s_waitcnt lgkmcnt(8)
    v_mfma_f32_32x32x16_bf16 v[8:23], a[160:163], a[108:111], v[8:23]
    ds_read_b64_tr_b16 a[152:153], v229 offset:8192
    ds_read_b64_tr_b16 a[154:155], v229 offset:9216
    v_rcp_f32 v115, v115
    v_mul_f32 v128, v128, v112
    v_mfma_f32_32x32x16_bf16 v[24:39], a[164:167], a[108:111], v[24:39]
    ds_read_b64_tr_b16 a[156:157], v229 offset:20480
    ds_read_b64_tr_b16 a[158:159], v229 offset:21504
    v_mul_f32 v129, v129, v113
    s_waitcnt lgkmcnt(8)
    v_mfma_f32_32x32x16_bf16 v[40:55], a[168:171], a[108:111], v[40:55]
    ds_read_b64_tr_b16 a[160:161], v226 offset:10240
    ds_read_b64_tr_b16 a[162:163], v226 offset:11264
    v_mul_f32 v130, v130, v114
    v_mul_f32 v131, v131, v115
    v_mfma_f32_32x32x16_bf16 v[56:71], a[172:175], a[108:111], v[56:71]
    ds_read_b64_tr_b16 a[164:165], v226 offset:22528
    ds_read_b64_tr_b16 a[166:167], v226 offset:23552
    v_cvt_pk_bf16_f32 v164, v128, v129
    v_cvt_pk_bf16_f32 v165, v130, v131
    s_waitcnt lgkmcnt(8)
    v_mfma_f32_32x32x16_bf16 v[8:23], a[144:147], a[112:115], v[8:23]
    ds_read_b64_tr_b16 a[168:169], v229 offset:10240
    ds_read_b64_tr_b16 a[170:171], v229 offset:11264
    v_mul_f32 v132, v116, v132
    v_mul_f32 v133, v117, v133
    v_mfma_f32_32x32x16_bf16 v[24:39], a[148:151], a[112:115], v[24:39]
    ds_read_b64_tr_b16 a[172:173], v229 offset:22528
    ds_read_b64_tr_b16 a[174:175], v229 offset:23552
    v_mul_f32 v134, v118, v134
    s_waitcnt lgkmcnt(8)
    v_mfma_f32_32x32x16_bf16 v[40:55], a[152:155], a[112:115], v[40:55]
    ds_read_b64_tr_b16 a[144:145], v226 offset:24576
    ds_read_b64_tr_b16 a[146:147], v226 offset:25600
    v_mul_f32 v135, v119, v135
    v_mul_f32 v116, v244, v116
    v_mfma_f32_32x32x16_bf16 v[56:71], a[156:159], a[112:115], v[56:71]
    ds_read_b64_tr_b16 a[148:149], v226 offset:36864
    ds_read_b64_tr_b16 a[150:151], v226 offset:37888
    v_mul_f32 v117, v244, v117
    v_mul_f32 v118, v244, v118
    s_waitcnt lgkmcnt(8)
    v_mfma_f32_32x32x16_bf16 v[8:23], a[160:163], a[116:119], v[8:23]
    ds_read_b64_tr_b16 a[152:153], v229 offset:24576
    ds_read_b64_tr_b16 a[154:155], v229 offset:25600
    v_mul_f32 v119, v244, v119
    v_exp_f32 v116, v116
    v_mfma_f32_32x32x16_bf16 v[24:39], a[164:167], a[116:119], v[24:39]
    ds_read_b64_tr_b16 a[156:157], v229 offset:36864
    ds_read_b64_tr_b16 a[158:159], v229 offset:37888
    v_exp_f32 v117, v117
    s_add_u32 s31, s53, 3072
    buffer_load_dwordx4 a[188:191], v242, s[16:19], s31 offen sc1
    s_waitcnt lgkmcnt(8)
    v_mfma_f32_32x32x16_bf16 v[40:55], a[168:171], a[116:119], v[40:55]
    ds_read_b64_tr_b16 a[160:161], v226 offset:26624
    ds_read_b64_tr_b16 a[162:163], v226 offset:27648
    v_exp_f32 v118, v118
    v_exp_f32 v119, v119
    v_mfma_f32_32x32x16_bf16 v[56:71], a[172:175], a[116:119], v[56:71]
    ds_read_b64_tr_b16 a[164:165], v226 offset:38912
    ds_read_b64_tr_b16 a[166:167], v226 offset:39936
    v_fma_f32 v116, v116, v245, v245
    v_fma_f32 v117, v117, v245, v245
    s_waitcnt vmcnt(26)
    s_barrier
    s_waitcnt lgkmcnt(8)
    v_mfma_f32_32x32x16_bf16 v[8:23], a[144:147], a[120:123], v[8:23]
    ds_read_b64_tr_b16 a[168:169], v229 offset:26624
    ds_read_b64_tr_b16 a[170:171], v229 offset:27648
    v_fma_f32 v118, v118, v245, v245
    s_add_u32 m0, s30, 98304
    s_add_u32 s5, s28, 3539328
    buffer_load_dwordx4 v233, s[12:15], s5 offen lds
    buffer_load_dwordx4 v234, s[12:15], s5 offen offset:1024 lds
    buffer_load_dwordx4 v235, s[12:15], s5 offen offset:2048 lds
    v_mfma_f32_32x32x16_bf16 v[24:39], a[148:151], a[120:123], v[24:39]
    ds_read_b64_tr_b16 a[172:173], v229 offset:38912
    ds_read_b64_tr_b16 a[174:175], v229 offset:39936
    v_fma_f32 v119, v119, v245, v245
    v_rcp_f32 v116, v116
    s_waitcnt lgkmcnt(8)
    v_mfma_f32_32x32x16_bf16 v[40:55], a[152:155], a[120:123], v[40:55]
    ds_read_b64_tr_b16 a[144:145], v226 offset:28672
    ds_read_b64_tr_b16 a[146:147], v226 offset:29696
    v_rcp_f32 v117, v117
    v_rcp_f32 v118, v118
    v_mfma_f32_32x32x16_bf16 v[56:71], a[156:159], a[120:123], v[56:71]
    ds_read_b64_tr_b16 a[148:149], v226 offset:40960
    ds_read_b64_tr_b16 a[150:151], v226 offset:41984
    v_rcp_f32 v119, v119
    v_mul_f32 v132, v132, v116
    s_waitcnt lgkmcnt(8)
    v_mfma_f32_32x32x16_bf16 v[8:23], a[160:163], a[124:127], v[8:23]
    ds_read_b64_tr_b16 a[152:153], v229 offset:28672
    ds_read_b64_tr_b16 a[154:155], v229 offset:29696
    v_mul_f32 v133, v133, v117
    s_add_u32 m0, s30, 101376
    s_add_u32 s5, s28, 3760512
    buffer_load_dwordx4 v233, s[12:15], s5 offen lds
    buffer_load_dwordx4 v234, s[12:15], s5 offen offset:1024 lds
    buffer_load_dwordx4 v235, s[12:15], s5 offen offset:2048 lds
    v_mfma_f32_32x32x16_bf16 v[24:39], a[164:167], a[124:127], v[24:39]
    ds_read_b64_tr_b16 a[156:157], v229 offset:40960
    ds_read_b64_tr_b16 a[158:159], v229 offset:41984
    v_mul_f32 v134, v134, v118
    v_mul_f32 v135, v135, v119
    s_waitcnt lgkmcnt(8)
    v_mfma_f32_32x32x16_bf16 v[40:55], a[168:171], a[124:127], v[40:55]
    ds_read_b64_tr_b16 a[160:161], v226 offset:30720
    ds_read_b64_tr_b16 a[162:163], v226 offset:31744
    v_cvt_pk_bf16_f32 v166, v132, v133
    v_cvt_pk_bf16_f32 v167, v134, v135
    v_mfma_f32_32x32x16_bf16 v[56:71], a[172:175], a[124:127], v[56:71]
    ds_read_b64_tr_b16 a[164:165], v226 offset:43008
    ds_read_b64_tr_b16 a[166:167], v226 offset:44032
    s_add_u32 s31, s52, 7168
    buffer_store_dwordx4 v[164:167], v242, s[16:19], s31 offen sc1
    s_waitcnt lgkmcnt(8)
    v_mfma_f32_32x32x16_bf16 v[8:23], a[144:147], a[128:131], v[8:23]
    ds_read_b64_tr_b16 a[168:169], v229 offset:30720
    ds_read_b64_tr_b16 a[170:171], v229 offset:31744
    v_mfma_f32_32x32x16_bf16 v[24:39], a[148:151], a[128:131], v[24:39]
    ds_read_b64_tr_b16 a[172:173], v229 offset:43008
    ds_read_b64_tr_b16 a[174:175], v229 offset:44032
    s_waitcnt lgkmcnt(8)
    v_mfma_f32_32x32x16_bf16 v[40:55], a[152:155], a[128:131], v[40:55]
    ds_read_b64_tr_b16 a[144:145], v226 offset:32768
    ds_read_b64_tr_b16 a[146:147], v226 offset:33792
    v_mfma_f32_32x32x16_bf16 v[56:71], a[156:159], a[128:131], v[56:71]
    ds_read_b64_tr_b16 a[148:149], v226 offset:45056
    ds_read_b64_tr_b16 a[150:151], v226 offset:46080
    s_waitcnt lgkmcnt(8)
    v_mfma_f32_32x32x16_bf16 v[8:23], a[160:163], a[132:135], v[8:23]
    ds_read_b64_tr_b16 a[152:153], v229 offset:32768
    ds_read_b64_tr_b16 a[154:155], v229 offset:33792
    v_mfma_f32_32x32x16_bf16 v[24:39], a[164:167], a[132:135], v[24:39]
    ds_read_b64_tr_b16 a[156:157], v229 offset:45056
    ds_read_b64_tr_b16 a[158:159], v229 offset:46080
    s_waitcnt lgkmcnt(8)
    v_mfma_f32_32x32x16_bf16 v[40:55], a[168:171], a[132:135], v[40:55]
    ds_read_b64_tr_b16 a[160:161], v226 offset:34816
    ds_read_b64_tr_b16 a[162:163], v226 offset:35840
    v_mfma_f32_32x32x16_bf16 v[56:71], a[172:175], a[132:135], v[56:71]
    ds_read_b64_tr_b16 a[164:165], v226 offset:47104
    ds_read_b64_tr_b16 a[166:167], v226 offset:48128
    s_waitcnt lgkmcnt(8)
    v_mfma_f32_32x32x16_bf16 v[8:23], a[144:147], a[136:139], v[8:23]
    ds_read_b64_tr_b16 a[168:169], v229 offset:34816
    ds_read_b64_tr_b16 a[170:171], v229 offset:35840
    v_mfma_f32_32x32x16_bf16 v[24:39], a[148:151], a[136:139], v[24:39]
    ds_read_b64_tr_b16 a[172:173], v229 offset:47104
    ds_read_b64_tr_b16 a[174:175], v229 offset:48128
    s_waitcnt lgkmcnt(8)
    v_mfma_f32_32x32x16_bf16 v[40:55], a[152:155], a[136:139], v[40:55]
    ds_read_b64_tr_b16 a[144:145], v224 offset:0
    ds_read_b64_tr_b16 a[146:147], v224 offset:1024
    v_mfma_f32_32x32x16_bf16 v[56:71], a[156:159], a[136:139], v[56:71]
    ds_read_b64_tr_b16 a[148:149], v224 offset:12288
    ds_read_b64_tr_b16 a[150:151], v224 offset:13312
    s_waitcnt lgkmcnt(8)
    v_mfma_f32_32x32x16_bf16 v[8:23], a[160:163], a[140:143], v[8:23]
    ds_read_b64_tr_b16 a[152:153], v227 offset:0
    ds_read_b64_tr_b16 a[154:155], v227 offset:1024
    v_mfma_f32_32x32x16_bf16 v[24:39], a[164:167], a[140:143], v[24:39]
    ds_read_b64_tr_b16 a[156:157], v227 offset:12288
    ds_read_b64_tr_b16 a[158:159], v227 offset:13312
    s_waitcnt lgkmcnt(8)
    v_mfma_f32_32x32x16_bf16 v[40:55], a[168:171], a[140:143], v[40:55]
    ds_read_b64_tr_b16 a[160:161], v224 offset:2048
    ds_read_b64_tr_b16 a[162:163], v224 offset:3072
    v_mfma_f32_32x32x16_bf16 v[56:71], a[172:175], a[140:143], v[56:71]
    ds_read_b64_tr_b16 a[164:165], v224 offset:14336
    ds_read_b64_tr_b16 a[166:167], v224 offset:15360
    s_waitcnt vmcnt(25)
    s_barrier
    s_waitcnt lgkmcnt(8)
    v_mfma_f32_32x32x16_bf16 v[72:87], a[144:147], a[0:3], 0
    ds_read_b64_tr_b16 a[168:169], v227 offset:2048
    ds_read_b64_tr_b16 a[170:171], v227 offset:3072
    s_add_u32 m0, s30, 122880
    s_add_u32 s5, s28, 4424064
    buffer_load_dwordx4 v233, s[12:15], s5 offen lds
    buffer_load_dwordx4 v234, s[12:15], s5 offen offset:1024 lds
    buffer_load_dwordx4 v235, s[12:15], s5 offen offset:2048 lds
    v_mfma_f32_32x32x16_bf16 v[88:103], a[148:151], a[0:3], 0
    ds_read_b64_tr_b16 a[172:173], v227 offset:14336
    ds_read_b64_tr_b16 a[174:175], v227 offset:15360
    s_waitcnt lgkmcnt(8)
    v_mfma_f32_32x32x16_bf16 v[104:119], a[152:155], a[0:3], 0
    ds_read_b64_tr_b16 a[144:145], v224 offset:4096
    ds_read_b64_tr_b16 a[146:147], v224 offset:5120
    v_mfma_f32_32x32x16_bf16 v[120:135], a[156:159], a[0:3], 0
    ds_read_b64_tr_b16 a[148:149], v224 offset:16384
    ds_read_b64_tr_b16 a[150:151], v224 offset:17408
    s_waitcnt lgkmcnt(8)
    v_mfma_f32_32x32x16_bf16 v[72:87], a[160:163], a[4:7], v[72:87]
    ds_read_b64_tr_b16 a[152:153], v227 offset:4096
    ds_read_b64_tr_b16 a[154:155], v227 offset:5120
    s_add_u32 m0, s30, 125952
    s_add_u32 s5, s28, 4645248
    buffer_load_dwordx4 v233, s[12:15], s5 offen lds
    buffer_load_dwordx4 v234, s[12:15], s5 offen offset:1024 lds
    buffer_load_dwordx4 v235, s[12:15], s5 offen offset:2048 lds
    v_mfma_f32_32x32x16_bf16 v[88:103], a[164:167], a[4:7], v[88:103]
    ds_read_b64_tr_b16 a[156:157], v227 offset:16384
    ds_read_b64_tr_b16 a[158:159], v227 offset:17408
    v_mul_f32 v24, v8, v24
    v_mul_f32 v25, v9, v25
    s_waitcnt lgkmcnt(8)
    v_mfma_f32_32x32x16_bf16 v[104:119], a[168:171], a[4:7], v[104:119]
    ds_read_b64_tr_b16 a[160:161], v224 offset:6144
    ds_read_b64_tr_b16 a[162:163], v224 offset:7168
    v_mul_f32 v26, v10, v26
    v_mul_f32 v27, v11, v27
    v_mfma_f32_32x32x16_bf16 v[120:135], a[172:175], a[4:7], v[120:135]
    ds_read_b64_tr_b16 a[164:165], v224 offset:18432
    ds_read_b64_tr_b16 a[166:167], v224 offset:19456
    v_mul_f32 v8, v244, v8
    v_mul_f32 v9, v244, v9
    s_waitcnt lgkmcnt(8)
    v_mfma_f32_32x32x16_bf16 v[72:87], a[144:147], a[8:11], v[72:87]
    ds_read_b64_tr_b16 a[168:169], v227 offset:6144
    ds_read_b64_tr_b16 a[170:171], v227 offset:7168
    v_mul_f32 v10, v244, v10
    v_mfma_f32_32x32x16_bf16 v[88:103], a[148:151], a[8:11], v[88:103]
    ds_read_b64_tr_b16 a[172:173], v227 offset:18432
    ds_read_b64_tr_b16 a[174:175], v227 offset:19456
    v_mul_f32 v11, v244, v11
    v_exp_f32 v8, v8
    s_waitcnt lgkmcnt(8)
    v_mfma_f32_32x32x16_bf16 v[104:119], a[152:155], a[8:11], v[104:119]
    ds_read_b64_tr_b16 a[144:145], v224 offset:8192
    ds_read_b64_tr_b16 a[146:147], v224 offset:9216
    v_exp_f32 v9, v9
    v_exp_f32 v10, v10
    v_mfma_f32_32x32x16_bf16 v[120:135], a[156:159], a[8:11], v[120:135]
    ds_read_b64_tr_b16 a[148:149], v224 offset:20480
    ds_read_b64_tr_b16 a[150:151], v224 offset:21504
    v_exp_f32 v11, v11
    v_fma_f32 v8, v8, v245, v245
    s_waitcnt lgkmcnt(8)
    v_mfma_f32_32x32x16_bf16 v[72:87], a[160:163], a[12:15], v[72:87]
    ds_read_b64_tr_b16 a[152:153], v227 offset:8192
    ds_read_b64_tr_b16 a[154:155], v227 offset:9216
    v_fma_f32 v9, v9, v245, v245
    v_mfma_f32_32x32x16_bf16 v[88:103], a[164:167], a[12:15], v[88:103]
    ds_read_b64_tr_b16 a[156:157], v227 offset:20480
    ds_read_b64_tr_b16 a[158:159], v227 offset:21504
    v_fma_f32 v10, v10, v245, v245
    v_fma_f32 v11, v11, v245, v245
    s_waitcnt lgkmcnt(8)
    v_mfma_f32_32x32x16_bf16 v[104:119], a[168:171], a[12:15], v[104:119]
    ds_read_b64_tr_b16 a[160:161], v224 offset:10240
    ds_read_b64_tr_b16 a[162:163], v224 offset:11264
    v_rcp_f32 v8, v8
    v_rcp_f32 v9, v9
    v_mfma_f32_32x32x16_bf16 v[120:135], a[172:175], a[12:15], v[120:135]
    ds_read_b64_tr_b16 a[164:165], v224 offset:22528
    ds_read_b64_tr_b16 a[166:167], v224 offset:23552
    v_rcp_f32 v10, v10
    s_waitcnt lgkmcnt(8)
    v_mfma_f32_32x32x16_bf16 v[72:87], a[144:147], a[16:19], v[72:87]
    ds_read_b64_tr_b16 a[168:169], v227 offset:10240
    ds_read_b64_tr_b16 a[170:171], v227 offset:11264
    v_rcp_f32 v11, v11
    v_mul_f32 v24, v24, v8
    v_mfma_f32_32x32x16_bf16 v[88:103], a[148:151], a[16:19], v[88:103]
    ds_read_b64_tr_b16 a[172:173], v227 offset:22528
    ds_read_b64_tr_b16 a[174:175], v227 offset:23552
    v_mul_f32 v25, v25, v9
    v_mul_f32 v26, v26, v10
    s_waitcnt lgkmcnt(8)
    v_mfma_f32_32x32x16_bf16 v[104:119], a[152:155], a[16:19], v[104:119]
    ds_read_b64_tr_b16 a[144:145], v224 offset:24576
    ds_read_b64_tr_b16 a[146:147], v224 offset:25600
    v_mul_f32 v27, v27, v11
    v_cvt_pk_bf16_f32 v168, v24, v25
    s_waitcnt vmcnt(6)
    v_mov_b32 v250, 2
    buffer_store_dword v250, v246, s[16:19], s54 offen sc1
    v_mfma_f32_32x32x16_bf16 v[120:135], a[156:159], a[16:19], v[120:135]
    ds_read_b64_tr_b16 a[148:149], v224 offset:36864
    ds_read_b64_tr_b16 a[150:151], v224 offset:37888
    v_cvt_pk_bf16_f32 v169, v26, v27
    s_waitcnt lgkmcnt(8)
    v_mfma_f32_32x32x16_bf16 v[72:87], a[160:163], a[20:23], v[72:87]
    ds_read_b64_tr_b16 a[152:153], v227 offset:24576
    ds_read_b64_tr_b16 a[154:155], v227 offset:25600
    v_mul_f32 v28, v12, v28
    v_mul_f32 v29, v13, v29
    v_mfma_f32_32x32x16_bf16 v[88:103], a[164:167], a[20:23], v[88:103]
    ds_read_b64_tr_b16 a[156:157], v227 offset:36864
    ds_read_b64_tr_b16 a[158:159], v227 offset:37888
    v_mul_f32 v30, v14, v30
    v_mul_f32 v31, v15, v31
    s_waitcnt lgkmcnt(8)
    v_mfma_f32_32x32x16_bf16 v[104:119], a[168:171], a[20:23], v[104:119]
    ds_read_b64_tr_b16 a[160:161], v224 offset:26624
    ds_read_b64_tr_b16 a[162:163], v224 offset:27648
    v_mul_f32 v12, v244, v12
    v_mul_f32 v13, v244, v13
    v_mfma_f32_32x32x16_bf16 v[120:135], a[172:175], a[20:23], v[120:135]
    ds_read_b64_tr_b16 a[164:165], v224 offset:38912
    ds_read_b64_tr_b16 a[166:167], v224 offset:39936
    v_mul_f32 v14, v244, v14
    s_waitcnt vmcnt(24)
    s_barrier
    s_waitcnt lgkmcnt(8)
    v_mfma_f32_32x32x16_bf16 v[72:87], a[144:147], a[24:27], v[72:87]
    ds_read_b64_tr_b16 a[168:169], v227 offset:26624
    ds_read_b64_tr_b16 a[170:171], v227 offset:27648
    v_mul_f32 v15, v244, v15
    v_exp_f32 v12, v12
    s_add_u32 m0, s30, 0
    s_add_u32 s5, s29, 0
    buffer_load_dwordx4 v236, s[12:15], s5 offen lds
    buffer_load_dwordx4 v237, s[12:15], s5 offen offset:1024 lds
    buffer_load_dwordx4 v238, s[12:15], s5 offen offset:2048 lds
    v_mfma_f32_32x32x16_bf16 v[88:103], a[148:151], a[24:27], v[88:103]
    ds_read_b64_tr_b16 a[172:173], v227 offset:38912
    ds_read_b64_tr_b16 a[174:175], v227 offset:39936
    v_exp_f32 v13, v13
    v_exp_f32 v14, v14
    s_waitcnt lgkmcnt(8)
    v_mfma_f32_32x32x16_bf16 v[104:119], a[152:155], a[24:27], v[104:119]
    ds_read_b64_tr_b16 a[144:145], v224 offset:28672
    ds_read_b64_tr_b16 a[146:147], v224 offset:29696
    v_exp_f32 v15, v15
    v_mfma_f32_32x32x16_bf16 v[120:135], a[156:159], a[24:27], v[120:135]
    ds_read_b64_tr_b16 a[148:149], v224 offset:40960
    ds_read_b64_tr_b16 a[150:151], v224 offset:41984
    v_fma_f32 v12, v12, v245, v245
    v_fma_f32 v13, v13, v245, v245
    s_waitcnt lgkmcnt(8)
    v_mfma_f32_32x32x16_bf16 v[72:87], a[160:163], a[28:31], v[72:87]
    ds_read_b64_tr_b16 a[152:153], v227 offset:28672
    ds_read_b64_tr_b16 a[154:155], v227 offset:29696
    v_fma_f32 v14, v14, v245, v245
    v_fma_f32 v15, v15, v245, v245
    s_add_u32 m0, s30, 3072
    s_add_u32 s5, s29, 442368
    buffer_load_dwordx4 v236, s[12:15], s5 offen lds
    buffer_load_dwordx4 v237, s[12:15], s5 offen offset:1024 lds
    buffer_load_dwordx4 v238, s[12:15], s5 offen offset:2048 lds
    v_mfma_f32_32x32x16_bf16 v[88:103], a[164:167], a[28:31], v[88:103]
    ds_read_b64_tr_b16 a[156:157], v227 offset:40960
    ds_read_b64_tr_b16 a[158:159], v227 offset:41984
    v_rcp_f32 v12, v12
    v_rcp_f32 v13, v13
    s_waitcnt lgkmcnt(8)
    v_mfma_f32_32x32x16_bf16 v[104:119], a[168:171], a[28:31], v[104:119]
    ds_read_b64_tr_b16 a[160:161], v224 offset:30720
    ds_read_b64_tr_b16 a[162:163], v224 offset:31744
    v_rcp_f32 v14, v14
    v_mfma_f32_32x32x16_bf16 v[120:135], a[172:175], a[28:31], v[120:135]
    ds_read_b64_tr_b16 a[164:165], v224 offset:43008
    ds_read_b64_tr_b16 a[166:167], v224 offset:44032
    v_rcp_f32 v15, v15
    v_mul_f32 v28, v28, v12
    s_waitcnt lgkmcnt(8)
    v_mfma_f32_32x32x16_bf16 v[72:87], a[144:147], a[32:35], v[72:87]
    ds_read_b64_tr_b16 a[168:169], v227 offset:30720
    ds_read_b64_tr_b16 a[170:171], v227 offset:31744
    v_mul_f32 v29, v29, v13
    v_mul_f32 v30, v30, v14
    v_mfma_f32_32x32x16_bf16 v[88:103], a[148:151], a[32:35], v[88:103]
    ds_read_b64_tr_b16 a[172:173], v227 offset:43008
    ds_read_b64_tr_b16 a[174:175], v227 offset:44032
    v_mul_f32 v31, v31, v15
    s_waitcnt lgkmcnt(8)
    v_mfma_f32_32x32x16_bf16 v[104:119], a[152:155], a[32:35], v[104:119]
    ds_read_b64_tr_b16 a[144:145], v224 offset:32768
    ds_read_b64_tr_b16 a[146:147], v224 offset:33792
    v_cvt_pk_bf16_f32 v170, v28, v29
    v_cvt_pk_bf16_f32 v171, v30, v31
    v_mfma_f32_32x32x16_bf16 v[120:135], a[156:159], a[32:35], v[120:135]
    ds_read_b64_tr_b16 a[148:149], v224 offset:45056
    ds_read_b64_tr_b16 a[150:151], v224 offset:46080
    s_add_u32 s31, s52, 8192
    buffer_store_dwordx4 v[168:171], v242, s[16:19], s31 offen sc1
    v_mul_f32 v32, v16, v32
    s_waitcnt lgkmcnt(8)
    v_mfma_f32_32x32x16_bf16 v[72:87], a[160:163], a[36:39], v[72:87]
    ds_read_b64_tr_b16 a[152:153], v227 offset:32768
    ds_read_b64_tr_b16 a[154:155], v227 offset:33792
    v_mul_f32 v33, v17, v33
    v_mul_f32 v34, v18, v34
    v_mfma_f32_32x32x16_bf16 v[88:103], a[164:167], a[36:39], v[88:103]
    ds_read_b64_tr_b16 a[156:157], v227 offset:45056
    ds_read_b64_tr_b16 a[158:159], v227 offset:46080
    v_mul_f32 v35, v19, v35
    s_waitcnt lgkmcnt(8)
    v_mfma_f32_32x32x16_bf16 v[104:119], a[168:171], a[36:39], v[104:119]
    ds_read_b64_tr_b16 a[160:161], v224 offset:34816
    ds_read_b64_tr_b16 a[162:163], v224 offset:35840
    v_mul_f32 v16, v244, v16
    v_mul_f32 v17, v244, v17
    v_mfma_f32_32x32x16_bf16 v[120:135], a[172:175], a[36:39], v[120:135]
    ds_read_b64_tr_b16 a[164:165], v224 offset:47104
    ds_read_b64_tr_b16 a[166:167], v224 offset:48128
    v_mul_f32 v18, v244, v18
    v_mul_f32 v19, v244, v19
    s_waitcnt lgkmcnt(8)
    v_mfma_f32_32x32x16_bf16 v[72:87], a[144:147], a[40:43], v[72:87]
    ds_read_b64_tr_b16 a[168:169], v227 offset:34816
    ds_read_b64_tr_b16 a[170:171], v227 offset:35840
    v_exp_f32 v16, v16
    v_exp_f32 v17, v17
    v_mfma_f32_32x32x16_bf16 v[88:103], a[148:151], a[40:43], v[88:103]
    ds_read_b64_tr_b16 a[172:173], v227 offset:47104
    ds_read_b64_tr_b16 a[174:175], v227 offset:48128
    v_exp_f32 v18, v18
    s_waitcnt lgkmcnt(8)
    v_mfma_f32_32x32x16_bf16 v[104:119], a[152:155], a[40:43], v[104:119]
    ds_read_b64_tr_b16 a[144:145], v225 offset:0
    ds_read_b64_tr_b16 a[146:147], v225 offset:1024
    v_exp_f32 v19, v19
    v_fma_f32 v16, v16, v245, v245
    v_mfma_f32_32x32x16_bf16 v[120:135], a[156:159], a[40:43], v[120:135]
    ds_read_b64_tr_b16 a[148:149], v225 offset:12288
    ds_read_b64_tr_b16 a[150:151], v225 offset:13312
    v_fma_f32 v17, v17, v245, v245
    v_fma_f32 v18, v18, v245, v245
    s_waitcnt lgkmcnt(8)
    v_mfma_f32_32x32x16_bf16 v[72:87], a[160:163], a[44:47], v[72:87]
    ds_read_b64_tr_b16 a[152:153], v228 offset:0
    ds_read_b64_tr_b16 a[154:155], v228 offset:1024
    v_fma_f32 v19, v19, v245, v245
    v_mfma_f32_32x32x16_bf16 v[88:103], a[164:167], a[44:47], v[88:103]
    ds_read_b64_tr_b16 a[156:157], v228 offset:12288
    ds_read_b64_tr_b16 a[158:159], v228 offset:13312
    v_rcp_f32 v16, v16
    v_rcp_f32 v17, v17
    s_waitcnt lgkmcnt(8)
    v_mfma_f32_32x32x16_bf16 v[104:119], a[168:171], a[44:47], v[104:119]
    ds_read_b64_tr_b16 a[160:161], v225 offset:2048
    ds_read_b64_tr_b16 a[162:163], v225 offset:3072
    v_rcp_f32 v18, v18
    v_rcp_f32 v19, v19
    buffer_load_dword v249, off, s[16:19], s55 offset:0 sc1
    v_mfma_f32_32x32x16_bf16 v[120:135], a[172:175], a[44:47], v[120:135]
    ds_read_b64_tr_b16 a[164:165], v225 offset:14336
    ds_read_b64_tr_b16 a[166:167], v225 offset:15360
    v_mul_f32 v32, v32, v16
    v_mul_f32 v33, v33, v17
    s_waitcnt vmcnt(23)
    s_barrier
    s_waitcnt lgkmcnt(8)
    v_mfma_f32_32x32x16_bf16 v[72:87], a[144:147], a[48:51], v[72:87]
    ds_read_b64_tr_b16 a[168:169], v228 offset:2048
    ds_read_b64_tr_b16 a[170:171], v228 offset:3072
    v_mul_f32 v34, v34, v18
    s_add_u32 m0, s30, 24576
    s_add_u32 s5, s29, 1769472
    buffer_load_dwordx4 v236, s[12:15], s5 offen lds
    buffer_load_dwordx4 v237, s[12:15], s5 offen offset:1024 lds
    buffer_load_dwordx4 v238, s[12:15], s5 offen offset:2048 lds
    v_mfma_f32_32x32x16_bf16 v[88:103], a[148:151], a[48:51], v[88:103]
    ds_read_b64_tr_b16 a[172:173], v228 offset:14336
    ds_read_b64_tr_b16 a[174:175], v228 offset:15360
    v_mul_f32 v35, v35, v19
    v_cvt_pk_bf16_f32 v172, v32, v33
    s_waitcnt lgkmcnt(8)
    v_mfma_f32_32x32x16_bf16 v[104:119], a[152:155], a[48:51], v[104:119]
    ds_read_b64_tr_b16 a[144:145], v225 offset:4096
    ds_read_b64_tr_b16 a[146:147], v225 offset:5120
    v_cvt_pk_bf16_f32 v173, v34, v35
    v_mul_f32 v36, v20, v36
    v_mfma_f32_32x32x16_bf16 v[120:135], a[156:159], a[48:51], v[120:135]
    ds_read_b64_tr_b16 a[148:149], v225 offset:16384
    ds_read_b64_tr_b16 a[150:151], v225 offset:17408
    v_mul_f32 v37, v21, v37
    v_mul_f32 v38, v22, v38
    s_waitcnt lgkmcnt(8)
    v_mfma_f32_32x32x16_bf16 v[72:87], a[160:163], a[52:55], v[72:87]
    ds_read_b64_tr_b16 a[152:153], v228 offset:4096
    ds_read_b64_tr_b16 a[154:155], v228 offset:5120
    v_mul_f32 v39, v23, v39
    s_add_u32 m0, s30, 27648
    s_add_u32 s5, s29, 2211840
    buffer_load_dwordx4 v236, s[12:15], s5 offen lds
    buffer_load_dwordx4 v237, s[12:15], s5 offen offset:1024 lds
    buffer_load_dwordx4 v238, s[12:15], s5 offen offset:2048 lds
    v_mfma_f32_32x32x16_bf16 v[88:103], a[164:167], a[52:55], v[88:103]
    ds_read_b64_tr_b16 a[156:157], v228 offset:16384
    ds_read_b64_tr_b16 a[158:159], v228 offset:17408
    v_mul_f32 v20, v244, v20
    v_mul_f32 v21, v244, v21
    s_waitcnt lgkmcnt(8)
    v_mfma_f32_32x32x16_bf16 v[104:119], a[168:171], a[52:55], v[104:119]
    ds_read_b64_tr_b16 a[160:161], v225 offset:6144
    ds_read_b64_tr_b16 a[162:163], v225 offset:7168
    v_mul_f32 v22, v244, v22
    v_mul_f32 v23, v244, v23
    v_mfma_f32_32x32x16_bf16 v[120:135], a[172:175], a[52:55], v[120:135]
    ds_read_b64_tr_b16 a[164:165], v225 offset:18432
    ds_read_b64_tr_b16 a[166:167], v225 offset:19456
    v_exp_f32 v20, v20
    s_waitcnt lgkmcnt(8)
    v_mfma_f32_32x32x16_bf16 v[72:87], a[144:147], a[56:59], v[72:87]
    ds_read_b64_tr_b16 a[168:169], v228 offset:6144
    ds_read_b64_tr_b16 a[170:171], v228 offset:7168
    v_exp_f32 v21, v21
    v_exp_f32 v22, v22
    v_mfma_f32_32x32x16_bf16 v[88:103], a[148:151], a[56:59], v[88:103]
    ds_read_b64_tr_b16 a[172:173], v228 offset:18432
    ds_read_b64_tr_b16 a[174:175], v228 offset:19456
    v_exp_f32 v23, v23
    v_fma_f32 v20, v20, v245, v245
    s_waitcnt lgkmcnt(8)
    v_mfma_f32_32x32x16_bf16 v[104:119], a[152:155], a[56:59], v[104:119]
    ds_read_b64_tr_b16 a[144:145], v225 offset:8192
    ds_read_b64_tr_b16 a[146:147], v225 offset:9216
    v_fma_f32 v21, v21, v245, v245
    v_fma_f32 v22, v22, v245, v245
    v_mfma_f32_32x32x16_bf16 v[120:135], a[156:159], a[56:59], v[120:135]
    ds_read_b64_tr_b16 a[148:149], v225 offset:20480
    ds_read_b64_tr_b16 a[150:151], v225 offset:21504
    v_fma_f32 v23, v23, v245, v245
    s_waitcnt lgkmcnt(8)
    v_mfma_f32_32x32x16_bf16 v[72:87], a[160:163], a[60:63], v[72:87]
    ds_read_b64_tr_b16 a[152:153], v228 offset:8192
    ds_read_b64_tr_b16 a[154:155], v228 offset:9216
    v_rcp_f32 v20, v20
    v_rcp_f32 v21, v21
    v_mfma_f32_32x32x16_bf16 v[88:103], a[164:167], a[60:63], v[88:103]
    ds_read_b64_tr_b16 a[156:157], v228 offset:20480
    ds_read_b64_tr_b16 a[158:159], v228 offset:21504
    v_rcp_f32 v22, v22
    v_rcp_f32 v23, v23
    s_waitcnt lgkmcnt(8)
    v_mfma_f32_32x32x16_bf16 v[104:119], a[168:171], a[60:63], v[104:119]
    ds_read_b64_tr_b16 a[160:161], v225 offset:10240
    ds_read_b64_tr_b16 a[162:163], v225 offset:11264
    v_mul_f32 v36, v36, v20
    s_waitcnt vmcnt(6)
L_ffn_kernel_pca1:
    v_readfirstlane_b32 s50, v249
    s_sub_u32 s51, s51, 1
    s_cselect_b32 s50, 2, s50
    s_cmp_ge_u32 s50, 2
    s_cbranch_scc1 L_ffn_kernel_pda1
    buffer_load_dword v249, off, s[16:19], s55 offset:0 sc1
    s_waitcnt vmcnt(0)
    s_branch L_ffn_kernel_pca1
L_ffn_kernel_pda1:
    v_mfma_f32_32x32x16_bf16 v[120:135], a[172:175], a[60:63], v[120:135]
    ds_read_b64_tr_b16 a[164:165], v225 offset:22528
    ds_read_b64_tr_b16 a[166:167], v225 offset:23552
    v_mul_f32 v37, v37, v21
    v_mul_f32 v38, v38, v22
    s_add_u32 s31, s53, 4096
    buffer_load_dwordx4 a[192:195], v242, s[16:19], s31 offen sc1
    s_waitcnt lgkmcnt(8)
    v_mfma_f32_32x32x16_bf16 v[72:87], a[144:147], a[64:67], v[72:87]
    ds_read_b64_tr_b16 a[168:169], v228 offset:10240
    ds_read_b64_tr_b16 a[170:171], v228 offset:11264
    v_mul_f32 v39, v39, v23
    v_cvt_pk_bf16_f32 v174, v36, v37
    v_mfma_f32_32x32x16_bf16 v[88:103], a[148:151], a[64:67], v[88:103]
    ds_read_b64_tr_b16 a[172:173], v228 offset:22528
    ds_read_b64_tr_b16 a[174:175], v228 offset:23552
    v_cvt_pk_bf16_f32 v175, v38, v39
    s_add_u32 s31, s52, 9216
    buffer_store_dwordx4 v[172:175], v242, s[16:19], s31 offen sc1
    s_waitcnt lgkmcnt(8)
    v_mfma_f32_32x32x16_bf16 v[104:119], a[152:155], a[64:67], v[104:119]
    ds_read_b64_tr_b16 a[144:145], v225 offset:24576
    ds_read_b64_tr_b16 a[146:147], v225 offset:25600
    v_mul_f32 v56, v40, v56
    v_mfma_f32_32x32x16_bf16 v[120:135], a[156:159], a[64:67], v[120:135]
    ds_read_b64_tr_b16 a[148:149], v225 offset:36864
    ds_read_b64_tr_b16 a[150:151], v225 offset:37888
    v_mul_f32 v57, v41, v57
    v_mul_f32 v58, v42, v58
    s_waitcnt lgkmcnt(8)
    v_mfma_f32_32x32x16_bf16 v[72:87], a[160:163], a[68:71], v[72:87]
    ds_read_b64_tr_b16 a[152:153], v228 offset:24576
    ds_read_b64_tr_b16 a[154:155], v228 offset:25600
    v_mul_f32 v59, v43, v59
    v_mul_f32 v40, v244, v40
    v_mfma_f32_32x32x16_bf16 v[88:103], a[164:167], a[68:71], v[88:103]
    ds_read_b64_tr_b16 a[156:157], v228 offset:36864
    ds_read_b64_tr_b16 a[158:159], v228 offset:37888
    v_mul_f32 v41, v244, v41
    v_mul_f32 v42, v244, v42
    s_waitcnt lgkmcnt(8)
    v_mfma_f32_32x32x16_bf16 v[104:119], a[168:171], a[68:71], v[104:119]
    ds_read_b64_tr_b16 a[160:161], v225 offset:26624
    ds_read_b64_tr_b16 a[162:163], v225 offset:27648
    v_mul_f32 v43, v244, v43
    v_mfma_f32_32x32x16_bf16 v[120:135], a[172:175], a[68:71], v[120:135]
    ds_read_b64_tr_b16 a[164:165], v225 offset:38912
    ds_read_b64_tr_b16 a[166:167], v225 offset:39936
    v_exp_f32 v40, v40
    v_exp_f32 v41, v41
    s_waitcnt vmcnt(24)
    s_barrier
    s_waitcnt lgkmcnt(8)
    v_mfma_f32_32x32x16_bf16 v[72:87], a[144:147], a[72:75], v[72:87]
    ds_read_b64_tr_b16 a[168:169], v228 offset:26624
    ds_read_b64_tr_b16 a[170:171], v228 offset:27648
    v_exp_f32 v42, v42
    v_exp_f32 v43, v43
    s_add_u32 m0, s30, 49152
    s_add_u32 s5, s29, 3538944
    buffer_load_dwordx4 v236, s[12:15], s5 offen lds
    buffer_load_dwordx4 v237, s[12:15], s5 offen offset:1024 lds
    buffer_load_dwordx4 v238, s[12:15], s5 offen offset:2048 lds
    v_mfma_f32_32x32x16_bf16 v[88:103], a[148:151], a[72:75], v[88:103]
    ds_read_b64_tr_b16 a[172:173], v228 offset:38912
    ds_read_b64_tr_b16 a[174:175], v228 offset:39936
    v_fma_f32 v40, v40, v245, v245
    s_waitcnt lgkmcnt(8)
    v_mfma_f32_32x32x16_bf16 v[104:119], a[152:155], a[72:75], v[104:119]
    ds_read_b64_tr_b16 a[144:145], v225 offset:28672
    ds_read_b64_tr_b16 a[146:147], v225 offset:29696
    v_fma_f32 v41, v41, v245, v245
    v_fma_f32 v42, v42, v245, v245
    v_mfma_f32_32x32x16_bf16 v[120:135], a[156:159], a[72:75], v[120:135]
    ds_read_b64_tr_b16 a[148:149], v225 offset:40960
    ds_read_b64_tr_b16 a[150:151], v225 offset:41984
    v_fma_f32 v43, v43, v245, v245
    v_rcp_f32 v40, v40
    s_waitcnt lgkmcnt(8)
    v_mfma_f32_32x32x16_bf16 v[72:87], a[160:163], a[76:79], v[72:87]
    ds_read_b64_tr_b16 a[152:153], v228 offset:28672
    ds_read_b64_tr_b16 a[154:155], v228 offset:29696
    v_rcp_f32 v41, v41
    v_rcp_f32 v42, v42
    s_add_u32 m0, s30, 52224
    s_add_u32 s5, s29, 3981312
    buffer_load_dwordx4 v236, s[12:15], s5 offen lds
    buffer_load_dwordx4 v237, s[12:15], s5 offen offset:1024 lds
    buffer_load_dwordx4 v238, s[12:15], s5 offen offset:2048 lds
    v_mfma_f32_32x32x16_bf16 v[88:103], a[164:167], a[76:79], v[88:103]
    ds_read_b64_tr_b16 a[156:157], v228 offset:40960
    ds_read_b64_tr_b16 a[158:159], v228 offset:41984
    v_rcp_f32 v43, v43
    s_waitcnt lgkmcnt(8)
    v_mfma_f32_32x32x16_bf16 v[104:119], a[168:171], a[76:79], v[104:119]
    ds_read_b64_tr_b16 a[160:161], v225 offset:30720
    ds_read_b64_tr_b16 a[162:163], v225 offset:31744
    v_mul_f32 v56, v56, v40
    v_mul_f32 v57, v57, v41
    v_mfma_f32_32x32x16_bf16 v[120:135], a[172:175], a[76:79], v[120:135]
    ds_read_b64_tr_b16 a[164:165], v225 offset:43008
    ds_read_b64_tr_b16 a[166:167], v225 offset:44032
    v_mul_f32 v58, v58, v42
    v_mul_f32 v59, v59, v43
    s_waitcnt lgkmcnt(8)
    v_mfma_f32_32x32x16_bf16 v[72:87], a[144:147], a[80:83], v[72:87]
    ds_read_b64_tr_b16 a[168:169], v228 offset:30720
    ds_read_b64_tr_b16 a[170:171], v228 offset:31744
    v_cvt_pk_bf16_f32 v176, v56, v57
    v_mfma_f32_32x32x16_bf16 v[88:103], a[148:151], a[80:83], v[88:103]
    ds_read_b64_tr_b16 a[172:173], v228 offset:43008
    ds_read_b64_tr_b16 a[174:175], v228 offset:44032
    v_cvt_pk_bf16_f32 v177, v58, v59
    v_mul_f32 v60, v44, v60
    s_add_u32 s31, s53, 5120
    buffer_load_dwordx4 a[196:199], v242, s[16:19], s31 offen sc1
    s_waitcnt lgkmcnt(8)
    v_mfma_f32_32x32x16_bf16 v[104:119], a[152:155], a[80:83], v[104:119]
    ds_read_b64_tr_b16 a[144:145], v225 offset:32768
    ds_read_b64_tr_b16 a[146:147], v225 offset:33792
    v_mul_f32 v61, v45, v61
    v_mul_f32 v62, v46, v62
    v_mfma_f32_32x32x16_bf16 v[120:135], a[156:159], a[80:83], v[120:135]
    ds_read_b64_tr_b16 a[148:149], v225 offset:45056
    ds_read_b64_tr_b16 a[150:151], v225 offset:46080
    v_mul_f32 v63, v47, v63
    v_mul_f32 v44, v244, v44
    s_waitcnt lgkmcnt(8)
    v_mfma_f32_32x32x16_bf16 v[72:87], a[160:163], a[84:87], v[72:87]
    ds_read_b64_tr_b16 a[152:153], v228 offset:32768
    ds_read_b64_tr_b16 a[154:155], v228 offset:33792
    v_mul_f32 v45, v244, v45
    v_mfma_f32_32x32x16_bf16 v[88:103], a[164:167], a[84:87], v[88:103]
    ds_read_b64_tr_b16 a[156:157], v228 offset:45056
    ds_read_b64_tr_b16 a[158:159], v228 offset:46080
    v_mul_f32 v46, v244, v46
    v_mul_f32 v47, v244, v47
    s_waitcnt lgkmcnt(8)
    v_mfma_f32_32x32x16_bf16 v[104:119], a[168:171], a[84:87], v[104:119]
    ds_read_b64_tr_b16 a[160:161], v225 offset:34816
    ds_read_b64_tr_b16 a[162:163], v225 offset:35840
    v_exp_f32 v44, v44
    v_exp_f32 v45, v45
    v_mfma_f32_32x32x16_bf16 v[120:135], a[172:175], a[84:87], v[120:135]
    ds_read_b64_tr_b16 a[164:165], v225 offset:47104
    ds_read_b64_tr_b16 a[166:167], v225 offset:48128
    v_exp_f32 v46, v46
    v_exp_f32 v47, v47
    s_waitcnt lgkmcnt(8)
    v_mfma_f32_32x32x16_bf16 v[72:87], a[144:147], a[88:91], v[72:87]
    ds_read_b64_tr_b16 a[168:169], v228 offset:34816
    ds_read_b64_tr_b16 a[170:171], v228 offset:35840
    v_fma_f32 v44, v44, v245, v245
    v_mfma_f32_32x32x16_bf16 v[88:103], a[148:151], a[88:91], v[88:103]
    ds_read_b64_tr_b16 a[172:173], v228 offset:47104
    ds_read_b64_tr_b16 a[174:175], v228 offset:48128
    v_fma_f32 v45, v45, v245, v245
    v_fma_f32 v46, v46, v245, v245
    s_waitcnt lgkmcnt(8)
    v_mfma_f32_32x32x16_bf16 v[104:119], a[152:155], a[88:91], v[104:119]
    ds_read_b64_tr_b16 a[144:145], v226 offset:0
    ds_read_b64_tr_b16 a[146:147], v226 offset:1024
    v_fma_f32 v47, v47, v245, v245
    v_rcp_f32 v44, v44
    v_mfma_f32_32x32x16_bf16 v[120:135], a[156:159], a[88:91], v[120:135]
    ds_read_b64_tr_b16 a[148:149], v226 offset:12288
    ds_read_b64_tr_b16 a[150:151], v226 offset:13312
    v_rcp_f32 v45, v45
    s_waitcnt lgkmcnt(8)
    v_mfma_f32_32x32x16_bf16 v[72:87], a[160:163], a[92:95], v[72:87]
    ds_read_b64_tr_b16 a[152:153], v229 offset:0
    ds_read_b64_tr_b16 a[154:155], v229 offset:1024
    v_rcp_f32 v46, v46
    v_rcp_f32 v47, v47
    v_mfma_f32_32x32x16_bf16 v[88:103], a[164:167], a[92:95], v[88:103]
    ds_read_b64_tr_b16 a[156:157], v229 offset:12288
    ds_read_b64_tr_b16 a[158:159], v229 offset:13312
    v_mul_f32 v60, v60, v44
    v_mul_f32 v61, v61, v45
    s_waitcnt lgkmcnt(8)
    v_mfma_f32_32x32x16_bf16 v[104:119], a[168:171], a[92:95], v[104:119]
    ds_read_b64_tr_b16 a[160:161], v226 offset:2048
    ds_read_b64_tr_b16 a[162:163], v226 offset:3072
    v_mul_f32 v62, v62, v46
    v_mul_f32 v63, v63, v47
    v_mfma_f32_32x32x16_bf16 v[120:135], a[172:175], a[92:95], v[120:135]
    ds_read_b64_tr_b16 a[164:165], v226 offset:14336
    ds_read_b64_tr_b16 a[166:167], v226 offset:15360
    v_cvt_pk_bf16_f32 v178, v60, v61
    s_waitcnt vmcnt(24)
    s_barrier
    s_waitcnt lgkmcnt(8)
    v_mfma_f32_32x32x16_bf16 v[72:87], a[144:147], a[96:99], v[72:87]
    ds_read_b64_tr_b16 a[168:169], v229 offset:2048
    ds_read_b64_tr_b16 a[170:171], v229 offset:3072
    v_cvt_pk_bf16_f32 v179, v62, v63
    s_add_u32 s31, s52, 10240
    buffer_store_dwordx4 v[176:179], v242, s[16:19], s31 offen sc1
    s_add_u32 m0, s30, 73728
    s_add_u32 s5, s36, 0
    buffer_load_dwordx4 v239, s[20:23], s5 offen lds
    buffer_load_dwordx4 v240, s[20:23], s5 offen offset:1024 lds
    v_mfma_f32_32x32x16_bf16 v[88:103], a[148:151], a[96:99], v[88:103]
    ds_read_b64_tr_b16 a[172:173], v229 offset:14336
    ds_read_b64_tr_b16 a[174:175], v229 offset:15360
    v_mul_f32 v64, v48, v64
    v_mul_f32 v65, v49, v65
    s_waitcnt lgkmcnt(8)
    v_mfma_f32_32x32x16_bf16 v[104:119], a[152:155], a[96:99], v[104:119]
    ds_read_b64_tr_b16 a[144:145], v226 offset:4096
    ds_read_b64_tr_b16 a[146:147], v226 offset:5120
    v_mul_f32 v66, v50, v66
    v_mul_f32 v67, v51, v67
    v_mfma_f32_32x32x16_bf16 v[120:135], a[156:159], a[96:99], v[120:135]
    ds_read_b64_tr_b16 a[148:149], v226 offset:16384
    ds_read_b64_tr_b16 a[150:151], v226 offset:17408
    v_mul_f32 v48, v244, v48
    s_add_u32 s31, s53, 6144
    buffer_load_dwordx4 a[200:203], v242, s[16:19], s31 offen sc1
    s_waitcnt lgkmcnt(8)
    v_mfma_f32_32x32x16_bf16 v[72:87], a[160:163], a[100:103], v[72:87]
    ds_read_b64_tr_b16 a[152:153], v229 offset:4096
    ds_read_b64_tr_b16 a[154:155], v229 offset:5120
    v_mul_f32 v49, v244, v49
    v_mul_f32 v50, v244, v50
    s_add_u32 m0, s30, 75776
    s_add_u32 s5, s36, 18432
    buffer_load_dwordx4 v239, s[20:23], s5 offen lds
    buffer_load_dwordx4 v240, s[20:23], s5 offen offset:1024 lds
    v_mfma_f32_32x32x16_bf16 v[88:103], a[164:167], a[100:103], v[88:103]
    ds_read_b64_tr_b16 a[156:157], v229 offset:16384
    ds_read_b64_tr_b16 a[158:159], v229 offset:17408
    v_mul_f32 v51, v244, v51
    v_exp_f32 v48, v48
    s_waitcnt lgkmcnt(8)
    v_mfma_f32_32x32x16_bf16 v[104:119], a[168:171], a[100:103], v[104:119]
    ds_read_b64_tr_b16 a[160:161], v226 offset:6144
    ds_read_b64_tr_b16 a[162:163], v226 offset:7168
    v_exp_f32 v49, v49
    v_mfma_f32_32x32x16_bf16 v[120:135], a[172:175], a[100:103], v[120:135]
    ds_read_b64_tr_b16 a[164:165], v226 offset:18432
    ds_read_b64_tr_b16 a[166:167], v226 offset:19456
    v_exp_f32 v50, v50
    v_exp_f32 v51, v51
    s_waitcnt lgkmcnt(8)
    v_mfma_f32_32x32x16_bf16 v[72:87], a[144:147], a[104:107], v[72:87]
    ds_read_b64_tr_b16 a[168:169], v229 offset:6144
    ds_read_b64_tr_b16 a[170:171], v229 offset:7168
    v_fma_f32 v48, v48, v245, v245
    v_fma_f32 v49, v49, v245, v245
    s_add_u32 m0, s30, 77824
    s_add_u32 s5, s36, 36864
    buffer_load_dwordx4 v239, s[20:23], s5 offen lds
    buffer_load_dwordx4 v240, s[20:23], s5 offen offset:1024 lds
    v_mfma_f32_32x32x16_bf16 v[88:103], a[148:151], a[104:107], v[88:103]
    ds_read_b64_tr_b16 a[172:173], v229 offset:18432
    ds_read_b64_tr_b16 a[174:175], v229 offset:19456
    v_fma_f32 v50, v50, v245, v245
    v_fma_f32 v51, v51, v245, v245
    s_waitcnt lgkmcnt(8)
    v_mfma_f32_32x32x16_bf16 v[104:119], a[152:155], a[104:107], v[104:119]
    ds_read_b64_tr_b16 a[144:145], v226 offset:8192
    ds_read_b64_tr_b16 a[146:147], v226 offset:9216
    v_rcp_f32 v48, v48
    v_mfma_f32_32x32x16_bf16 v[120:135], a[156:159], a[104:107], v[120:135]
    ds_read_b64_tr_b16 a[148:149], v226 offset:20480
    ds_read_b64_tr_b16 a[150:151], v226 offset:21504
    v_rcp_f32 v49, v49
    v_rcp_f32 v50, v50
    s_waitcnt lgkmcnt(8)
    v_mfma_f32_32x32x16_bf16 v[72:87], a[160:163], a[108:111], v[72:87]
    ds_read_b64_tr_b16 a[152:153], v229 offset:8192
    ds_read_b64_tr_b16 a[154:155], v229 offset:9216
    v_rcp_f32 v51, v51
    v_mul_f32 v64, v64, v48
    v_mfma_f32_32x32x16_bf16 v[88:103], a[164:167], a[108:111], v[88:103]
    ds_read_b64_tr_b16 a[156:157], v229 offset:20480
    ds_read_b64_tr_b16 a[158:159], v229 offset:21504
    v_mul_f32 v65, v65, v49
    s_waitcnt lgkmcnt(8)
    v_mfma_f32_32x32x16_bf16 v[104:119], a[168:171], a[108:111], v[104:119]
    ds_read_b64_tr_b16 a[160:161], v226 offset:10240
    ds_read_b64_tr_b16 a[162:163], v226 offset:11264
    v_mul_f32 v66, v66, v50
    v_mul_f32 v67, v67, v51
    v_mfma_f32_32x32x16_bf16 v[120:135], a[172:175], a[108:111], v[120:135]
    ds_read_b64_tr_b16 a[164:165], v226 offset:22528
    ds_read_b64_tr_b16 a[166:167], v226 offset:23552
    v_cvt_pk_bf16_f32 v180, v64, v65
    v_cvt_pk_bf16_f32 v181, v66, v67
    s_waitcnt lgkmcnt(8)
    v_mfma_f32_32x32x16_bf16 v[72:87], a[144:147], a[112:115], v[72:87]
    ds_read_b64_tr_b16 a[168:169], v229 offset:10240
    ds_read_b64_tr_b16 a[170:171], v229 offset:11264
    v_mul_f32 v68, v52, v68
    v_mul_f32 v69, v53, v69
    v_mfma_f32_32x32x16_bf16 v[88:103], a[148:151], a[112:115], v[88:103]
    ds_read_b64_tr_b16 a[172:173], v229 offset:22528
    ds_read_b64_tr_b16 a[174:175], v229 offset:23552
    v_mul_f32 v70, v54, v70
    s_waitcnt lgkmcnt(8)
    v_mfma_f32_32x32x16_bf16 v[104:119], a[152:155], a[112:115], v[104:119]
    ds_read_b64_tr_b16 a[144:145], v226 offset:24576
    ds_read_b64_tr_b16 a[146:147], v226 offset:25600
    v_mul_f32 v71, v55, v71
    v_mul_f32 v52, v244, v52
    v_mfma_f32_32x32x16_bf16 v[120:135], a[156:159], a[112:115], v[120:135]
    ds_read_b64_tr_b16 a[148:149], v226 offset:36864
    ds_read_b64_tr_b16 a[150:151], v226 offset:37888
    v_mul_f32 v53, v244, v53
    v_mul_f32 v54, v244, v54
    s_waitcnt lgkmcnt(8)
    v_mfma_f32_32x32x16_bf16 v[72:87], a[160:163], a[116:119], v[72:87]
    ds_read_b64_tr_b16 a[152:153], v229 offset:24576
    ds_read_b64_tr_b16 a[154:155], v229 offset:25600
    v_mul_f32 v55, v244, v55
    v_exp_f32 v52, v52
    v_mfma_f32_32x32x16_bf16 v[88:103], a[164:167], a[116:119], v[88:103]
    ds_read_b64_tr_b16 a[156:157], v229 offset:36864
    ds_read_b64_tr_b16 a[158:159], v229 offset:37888
    v_exp_f32 v53, v53
    s_add_u32 s31, s53, 7168
    buffer_load_dwordx4 a[204:207], v242, s[16:19], s31 offen sc1
    s_waitcnt lgkmcnt(8)
    v_mfma_f32_32x32x16_bf16 v[104:119], a[168:171], a[116:119], v[104:119]
    ds_read_b64_tr_b16 a[160:161], v226 offset:26624
    ds_read_b64_tr_b16 a[162:163], v226 offset:27648
    v_exp_f32 v54, v54
    v_exp_f32 v55, v55
    v_mfma_f32_32x32x16_bf16 v[120:135], a[172:175], a[116:119], v[120:135]
    ds_read_b64_tr_b16 a[164:165], v226 offset:38912
    ds_read_b64_tr_b16 a[166:167], v226 offset:39936
    v_fma_f32 v52, v52, v245, v245
    v_fma_f32 v53, v53, v245, v245
    s_waitcnt vmcnt(26)
    s_barrier
    s_waitcnt lgkmcnt(8)
    v_mfma_f32_32x32x16_bf16 v[72:87], a[144:147], a[120:123], v[72:87]
    ds_read_b64_tr_b16 a[168:169], v229 offset:26624
    ds_read_b64_tr_b16 a[170:171], v229 offset:27648
    v_fma_f32 v54, v54, v245, v245
    s_add_u32 m0, s30, 98304
    s_add_u32 s5, s36, 110592
    buffer_load_dwordx4 v239, s[20:23], s5 offen lds
    buffer_load_dwordx4 v240, s[20:23], s5 offen offset:1024 lds
    v_mfma_f32_32x32x16_bf16 v[88:103], a[148:151], a[120:123], v[88:103]
    ds_read_b64_tr_b16 a[172:173], v229 offset:38912
    ds_read_b64_tr_b16 a[174:175], v229 offset:39936
    v_fma_f32 v55, v55, v245, v245
    v_rcp_f32 v52, v52
    s_waitcnt lgkmcnt(8)
    v_mfma_f32_32x32x16_bf16 v[104:119], a[152:155], a[120:123], v[104:119]
    ds_read_b64_tr_b16 a[144:145], v226 offset:28672
    ds_read_b64_tr_b16 a[146:147], v226 offset:29696
    v_rcp_f32 v53, v53
    v_rcp_f32 v54, v54
    v_mfma_f32_32x32x16_bf16 v[120:135], a[156:159], a[120:123], v[120:135]
    ds_read_b64_tr_b16 a[148:149], v226 offset:40960
    ds_read_b64_tr_b16 a[150:151], v226 offset:41984
    v_rcp_f32 v55, v55
    v_mul_f32 v68, v68, v52
    s_waitcnt lgkmcnt(8)
    v_mfma_f32_32x32x16_bf16 v[72:87], a[160:163], a[124:127], v[72:87]
    ds_read_b64_tr_b16 a[152:153], v229 offset:28672
    ds_read_b64_tr_b16 a[154:155], v229 offset:29696
    v_mul_f32 v69, v69, v53
    s_add_u32 m0, s30, 100352
    s_add_u32 s5, s36, 129024
    buffer_load_dwordx4 v239, s[20:23], s5 offen lds
    buffer_load_dwordx4 v240, s[20:23], s5 offen offset:1024 lds
    v_mfma_f32_32x32x16_bf16 v[88:103], a[164:167], a[124:127], v[88:103]
    ds_read_b64_tr_b16 a[156:157], v229 offset:40960
    ds_read_b64_tr_b16 a[158:159], v229 offset:41984
    v_mul_f32 v70, v70, v54
    v_mul_f32 v71, v71, v55
    s_waitcnt lgkmcnt(8)
    v_mfma_f32_32x32x16_bf16 v[104:119], a[168:171], a[124:127], v[104:119]
    ds_read_b64_tr_b16 a[160:161], v226 offset:30720
    ds_read_b64_tr_b16 a[162:163], v226 offset:31744
    v_cvt_pk_bf16_f32 v182, v68, v69
    v_cvt_pk_bf16_f32 v183, v70, v71
    v_mfma_f32_32x32x16_bf16 v[120:135], a[172:175], a[124:127], v[120:135]
    ds_read_b64_tr_b16 a[164:165], v226 offset:43008
    ds_read_b64_tr_b16 a[166:167], v226 offset:44032
    s_add_u32 s31, s52, 11264
    buffer_store_dwordx4 v[180:183], v242, s[16:19], s31 offen sc1
    s_waitcnt lgkmcnt(8)
    v_mfma_f32_32x32x16_bf16 v[72:87], a[144:147], a[128:131], v[72:87]
    ds_read_b64_tr_b16 a[168:169], v229 offset:30720
    ds_read_b64_tr_b16 a[170:171], v229 offset:31744
    s_add_u32 m0, s30, 102400
    s_add_u32 s5, s36, 147456
    buffer_load_dwordx4 v239, s[20:23], s5 offen lds
    buffer_load_dwordx4 v240, s[20:23], s5 offen offset:1024 lds
    v_mfma_f32_32x32x16_bf16 v[88:103], a[148:151], a[128:131], v[88:103]
    ds_read_b64_tr_b16 a[172:173], v229 offset:43008
    ds_read_b64_tr_b16 a[174:175], v229 offset:44032
    s_waitcnt lgkmcnt(8)
    v_mfma_f32_32x32x16_bf16 v[104:119], a[152:155], a[128:131], v[104:119]
    ds_read_b64_tr_b16 a[144:145], v226 offset:32768
    ds_read_b64_tr_b16 a[146:147], v226 offset:33792
    v_mfma_f32_32x32x16_bf16 v[120:135], a[156:159], a[128:131], v[120:135]
    ds_read_b64_tr_b16 a[148:149], v226 offset:45056
    ds_read_b64_tr_b16 a[150:151], v226 offset:46080
    s_waitcnt lgkmcnt(8)
    v_mfma_f32_32x32x16_bf16 v[72:87], a[160:163], a[132:135], v[72:87]
    ds_read_b64_tr_b16 a[152:153], v229 offset:32768
    ds_read_b64_tr_b16 a[154:155], v229 offset:33792
    v_mfma_f32_32x32x16_bf16 v[88:103], a[164:167], a[132:135], v[88:103]
    ds_read_b64_tr_b16 a[156:157], v229 offset:45056
    ds_read_b64_tr_b16 a[158:159], v229 offset:46080
    s_waitcnt lgkmcnt(8)
    v_mfma_f32_32x32x16_bf16 v[104:119], a[168:171], a[132:135], v[104:119]
    ds_read_b64_tr_b16 a[160:161], v226 offset:34816
    ds_read_b64_tr_b16 a[162:163], v226 offset:35840
    v_mfma_f32_32x32x16_bf16 v[120:135], a[172:175], a[132:135], v[120:135]
    ds_read_b64_tr_b16 a[164:165], v226 offset:47104
    ds_read_b64_tr_b16 a[166:167], v226 offset:48128
    s_waitcnt lgkmcnt(8)
    v_mfma_f32_32x32x16_bf16 v[72:87], a[144:147], a[136:139], v[72:87]
    ds_read_b64_tr_b16 a[168:169], v229 offset:34816
    ds_read_b64_tr_b16 a[170:171], v229 offset:35840
    v_mfma_f32_32x32x16_bf16 v[88:103], a[148:151], a[136:139], v[88:103]
    ds_read_b64_tr_b16 a[172:173], v229 offset:47104
    ds_read_b64_tr_b16 a[174:175], v229 offset:48128
    s_waitcnt lgkmcnt(8)
    v_mfma_f32_32x32x16_bf16 v[104:119], a[152:155], a[136:139], v[104:119]
    ds_read_b64_tr_b16 a[144:145], v230 offset:0
    ds_read_b64_tr_b16 a[146:147], v230 offset:512
    v_mfma_f32_32x32x16_bf16 v[120:135], a[156:159], a[136:139], v[120:135]
    ds_read_b64_tr_b16 a[148:149], v230 offset:12288
    ds_read_b64_tr_b16 a[150:151], v230 offset:12800
    s_waitcnt lgkmcnt(8)
    v_mfma_f32_32x32x16_bf16 v[72:87], a[160:163], a[140:143], v[72:87]
    ds_read_b64_tr_b16 a[152:153], v230 offset:1024
    ds_read_b64_tr_b16 a[154:155], v230 offset:1536
    v_mfma_f32_32x32x16_bf16 v[88:103], a[164:167], a[140:143], v[88:103]
    ds_read_b64_tr_b16 a[156:157], v230 offset:13312
    ds_read_b64_tr_b16 a[158:159], v230 offset:13824
    s_waitcnt lgkmcnt(8)
    v_mfma_f32_32x32x16_bf16 v[104:119], a[168:171], a[140:143], v[104:119]
    ds_read_b64_tr_b16 a[160:161], v230 offset:2048
    ds_read_b64_tr_b16 a[162:163], v230 offset:2560
    v_mfma_f32_32x32x16_bf16 v[120:135], a[172:175], a[140:143], v[120:135]
    ds_read_b64_tr_b16 a[164:165], v230 offset:14336
    ds_read_b64_tr_b16 a[166:167], v230 offset:14848
    s_waitcnt vmcnt(25)
    s_barrier
    s_waitcnt lgkmcnt(8)
    v_mfma_f32_32x32x16_bf16 v[8:23], a[144:147], a[0:3], 0
    ds_read_b64_tr_b16 a[168:169], v230 offset:3072
    ds_read_b64_tr_b16 a[170:171], v230 offset:3584
    s_add_u32 m0, s30, 122880
    s_add_u32 s5, s36, 221184
    buffer_load_dwordx4 v239, s[20:23], s5 offen lds
    buffer_load_dwordx4 v240, s[20:23], s5 offen offset:1024 lds
    v_mfma_f32_32x32x16_bf16 v[24:39], a[148:151], a[0:3], 0
    ds_read_b64_tr_b16 a[172:173], v230 offset:15360
    ds_read_b64_tr_b16 a[174:175], v230 offset:15872
    s_waitcnt lgkmcnt(8)
    v_mfma_f32_32x32x16_bf16 v[8:23], a[152:155], a[4:7], v[8:23]
    ds_read_b64_tr_b16 a[144:145], v230 offset:4096
    ds_read_b64_tr_b16 a[146:147], v230 offset:4608
    v_mfma_f32_32x32x16_bf16 v[24:39], a[156:159], a[4:7], v[24:39]
    ds_read_b64_tr_b16 a[148:149], v230 offset:16384
    ds_read_b64_tr_b16 a[150:151], v230 offset:16896
    s_waitcnt lgkmcnt(8)
    v_mfma_f32_32x32x16_bf16 v[8:23], a[160:163], a[8:11], v[8:23]
    ds_read_b64_tr_b16 a[152:153], v230 offset:5120
    ds_read_b64_tr_b16 a[154:155], v230 offset:5632
    s_add_u32 m0, s30, 124928
    s_add_u32 s5, s36, 239616
    s_add_u32 s34, s37, 239616
    s_cmp_ge_u32 s41, 1
    s_cselect_b32 s5, s34, s5
    buffer_load_dwordx4 v239, s[20:23], s5 offen lds
    buffer_load_dwordx4 v240, s[20:23], s5 offen offset:1024 lds
    v_mfma_f32_32x32x16_bf16 v[24:39], a[164:167], a[8:11], v[24:39]
    ds_read_b64_tr_b16 a[156:157], v230 offset:17408
    ds_read_b64_tr_b16 a[158:159], v230 offset:17920
    v_mul_f32 v88, v72, v88
    v_mul_f32 v89, v73, v89
    v_mul_f32 v90, v74, v90
    v_mul_f32 v91, v75, v91
    s_waitcnt lgkmcnt(8)
    v_mfma_f32_32x32x16_bf16 v[8:23], a[168:171], a[12:15], v[8:23]
    ds_read_b64_tr_b16 a[160:161], v230 offset:6144
    ds_read_b64_tr_b16 a[162:163], v230 offset:6656
    v_mul_f32 v72, v244, v72
    v_mul_f32 v73, v244, v73
    v_mul_f32 v74, v244, v74
    v_mfma_f32_32x32x16_bf16 v[24:39], a[172:175], a[12:15], v[24:39]
    ds_read_b64_tr_b16 a[164:165], v230 offset:18432
    ds_read_b64_tr_b16 a[166:167], v230 offset:18944
    v_mul_f32 v75, v244, v75
    v_exp_f32 v72, v72
    v_exp_f32 v73, v73
    s_waitcnt lgkmcnt(8)
    v_mfma_f32_32x32x16_bf16 v[8:23], a[144:147], a[16:19], v[8:23]
    ds_read_b64_tr_b16 a[168:169], v230 offset:7168
    ds_read_b64_tr_b16 a[170:171], v230 offset:7680
    v_exp_f32 v74, v74
    v_exp_f32 v75, v75
    v_fma_f32 v72, v72, v245, v245
    v_fma_f32 v73, v73, v245, v245
    s_add_u32 m0, s30, 126976
    s_add_u32 s5, s36, 258048
    s_add_u32 s34, s37, 258048
    s_cmp_ge_u32 s41, 1
    s_cselect_b32 s5, s34, s5
    buffer_load_dwordx4 v239, s[20:23], s5 offen lds
    buffer_load_dwordx4 v240, s[20:23], s5 offen offset:1024 lds
    v_mfma_f32_32x32x16_bf16 v[24:39], a[148:151], a[16:19], v[24:39]
    ds_read_b64_tr_b16 a[172:173], v230 offset:19456
    ds_read_b64_tr_b16 a[174:175], v230 offset:19968
    v_fma_f32 v74, v74, v245, v245
    v_fma_f32 v75, v75, v245, v245
    v_rcp_f32 v72, v72
    s_waitcnt lgkmcnt(8)
    v_mfma_f32_32x32x16_bf16 v[8:23], a[152:155], a[20:23], v[8:23]
    ds_read_b64_tr_b16 a[144:145], v230 offset:8192
    ds_read_b64_tr_b16 a[146:147], v230 offset:8704
    v_rcp_f32 v73, v73
    v_rcp_f32 v74, v74
    v_rcp_f32 v75, v75
    v_mfma_f32_32x32x16_bf16 v[24:39], a[156:159], a[20:23], v[24:39]
    ds_read_b64_tr_b16 a[148:149], v230 offset:20480
    ds_read_b64_tr_b16 a[150:151], v230 offset:20992
    v_mul_f32 v88, v88, v72
    v_mul_f32 v89, v89, v73
    v_mul_f32 v90, v90, v74
    s_waitcnt lgkmcnt(8)
    v_mfma_f32_32x32x16_bf16 v[8:23], a[160:163], a[24:27], v[8:23]
    ds_read_b64_tr_b16 a[152:153], v230 offset:9216
    ds_read_b64_tr_b16 a[154:155], v230 offset:9728
    v_mul_f32 v91, v91, v75
    v_cvt_pk_bf16_f32 v184, v88, v89
    v_cvt_pk_bf16_f32 v185, v90, v91
    v_mul_f32 v92, v76, v92
    v_mfma_f32_32x32x16_bf16 v[24:39], a[164:167], a[24:27], v[24:39]
    ds_read_b64_tr_b16 a[156:157], v230 offset:21504
    ds_read_b64_tr_b16 a[158:159], v230 offset:22016
    v_mul_f32 v93, v77, v93
    v_mul_f32 v94, v78, v94
    v_mul_f32 v95, v79, v95
    s_waitcnt lgkmcnt(8)
    v_mfma_f32_32x32x16_bf16 v[8:23], a[168:171], a[28:31], v[8:23]
    ds_read_b64_tr_b16 a[160:161], v230 offset:10240
    ds_read_b64_tr_b16 a[162:163], v230 offset:10752
    v_mul_f32 v76, v244, v76
    v_mul_f32 v77, v244, v77
    v_mul_f32 v78, v244, v78
    v_mfma_f32_32x32x16_bf16 v[24:39], a[172:175], a[28:31], v[24:39]
    ds_read_b64_tr_b16 a[164:165], v230 offset:22528
    ds_read_b64_tr_b16 a[166:167], v230 offset:23040
    v_mul_f32 v79, v244, v79
    v_exp_f32 v76, v76
    v_exp_f32 v77, v77
    s_waitcnt lgkmcnt(8)
    v_mfma_f32_32x32x16_bf16 v[8:23], a[144:147], a[32:35], v[8:23]
    ds_read_b64_tr_b16 a[168:169], v230 offset:11264
    ds_read_b64_tr_b16 a[170:171], v230 offset:11776
    v_exp_f32 v78, v78
    v_exp_f32 v79, v79
    v_fma_f32 v76, v76, v245, v245
    v_fma_f32 v77, v77, v245, v245
    v_mfma_f32_32x32x16_bf16 v[24:39], a[148:151], a[32:35], v[24:39]
    ds_read_b64_tr_b16 a[172:173], v230 offset:23552
    ds_read_b64_tr_b16 a[174:175], v230 offset:24064
    v_fma_f32 v78, v78, v245, v245
    v_fma_f32 v79, v79, v245, v245
    v_rcp_f32 v76, v76
    s_waitcnt lgkmcnt(8)
    v_mfma_f32_32x32x16_bf16 v[8:23], a[152:155], a[36:39], v[8:23]
    ds_read_b64_tr_b16 a[144:145], v230 offset:24576
    ds_read_b64_tr_b16 a[146:147], v230 offset:25088
    v_rcp_f32 v77, v77
    v_rcp_f32 v78, v78
    v_rcp_f32 v79, v79
    s_waitcnt vmcnt(8)
    v_mov_b32 v250, 3
    buffer_store_dword v250, v246, s[16:19], s54 offen sc1
    v_mfma_f32_32x32x16_bf16 v[24:39], a[156:159], a[36:39], v[24:39]
    ds_read_b64_tr_b16 a[148:149], v230 offset:36864
    ds_read_b64_tr_b16 a[150:151], v230 offset:37376
    v_mul_f32 v92, v92, v76
    v_mul_f32 v93, v93, v77
    v_mul_f32 v94, v94, v78
    s_waitcnt lgkmcnt(8)
    v_mfma_f32_32x32x16_bf16 v[8:23], a[160:163], a[40:43], v[8:23]
    ds_read_b64_tr_b16 a[152:153], v230 offset:25600
    ds_read_b64_tr_b16 a[154:155], v230 offset:26112
    v_mul_f32 v95, v95, v79
    v_cvt_pk_bf16_f32 v186, v92, v93
    v_cvt_pk_bf16_f32 v187, v94, v95
    s_add_u32 s31, s52, 12288
    buffer_store_dwordx4 v[184:187], v242, s[16:19], s31 offen sc1
    v_mfma_f32_32x32x16_bf16 v[24:39], a[164:167], a[40:43], v[24:39]
    ds_read_b64_tr_b16 a[156:157], v230 offset:37888
    ds_read_b64_tr_b16 a[158:159], v230 offset:38400
    v_mul_f32 v96, v80, v96
    v_mul_f32 v97, v81, v97
    v_mul_f32 v98, v82, v98
    s_waitcnt lgkmcnt(8)
    v_mfma_f32_32x32x16_bf16 v[8:23], a[168:171], a[44:47], v[8:23]
    ds_read_b64_tr_b16 a[160:161], v230 offset:26624
    ds_read_b64_tr_b16 a[162:163], v230 offset:27136
    v_mul_f32 v99, v83, v99
    v_mul_f32 v80, v244, v80
    v_mul_f32 v81, v244, v81
    v_mfma_f32_32x32x16_bf16 v[24:39], a[172:175], a[44:47], v[24:39]
    ds_read_b64_tr_b16 a[164:165], v230 offset:38912
    ds_read_b64_tr_b16 a[166:167], v230 offset:39424
    v_mul_f32 v82, v244, v82
    v_mul_f32 v83, v244, v83
    v_exp_f32 v80, v80
    s_waitcnt vmcnt(25)
    s_barrier
    s_waitcnt lgkmcnt(8)
    v_mfma_f32_32x32x16_bf16 v[8:23], a[144:147], a[48:51], v[8:23]
    ds_read_b64_tr_b16 a[168:169], v230 offset:27648
    ds_read_b64_tr_b16 a[170:171], v230 offset:28160
    v_exp_f32 v81, v81
    v_exp_f32 v82, v82
    v_exp_f32 v83, v83
    v_fma_f32 v80, v80, v245, v245
    s_add_u32 m0, s30, 0
    s_add_u32 s5, s38, 331776
    buffer_load_dwordx4 v239, s[20:23], s5 offen lds
    buffer_load_dwordx4 v240, s[20:23], s5 offen offset:1024 lds
    v_mfma_f32_32x32x16_bf16 v[24:39], a[148:151], a[48:51], v[24:39]
    ds_read_b64_tr_b16 a[172:173], v230 offset:39936
    ds_read_b64_tr_b16 a[174:175], v230 offset:40448
    v_fma_f32 v81, v81, v245, v245
    v_fma_f32 v82, v82, v245, v245
    v_fma_f32 v83, v83, v245, v245
    s_waitcnt lgkmcnt(8)
    v_mfma_f32_32x32x16_bf16 v[8:23], a[152:155], a[52:55], v[8:23]
    ds_read_b64_tr_b16 a[144:145], v230 offset:28672
    ds_read_b64_tr_b16 a[146:147], v230 offset:29184
    v_rcp_f32 v80, v80
    v_rcp_f32 v81, v81
    v_rcp_f32 v82, v82
    v_mfma_f32_32x32x16_bf16 v[24:39], a[156:159], a[52:55], v[24:39]
    ds_read_b64_tr_b16 a[148:149], v230 offset:40960
    ds_read_b64_tr_b16 a[150:151], v230 offset:41472
    v_rcp_f32 v83, v83
    v_mul_f32 v96, v96, v80
    v_mul_f32 v97, v97, v81
    v_mul_f32 v98, v98, v82
    s_waitcnt lgkmcnt(8)
    v_mfma_f32_32x32x16_bf16 v[8:23], a[160:163], a[56:59], v[8:23]
    ds_read_b64_tr_b16 a[152:153], v230 offset:29696
    ds_read_b64_tr_b16 a[154:155], v230 offset:30208
    v_mul_f32 v99, v99, v83
    v_cvt_pk_bf16_f32 v188, v96, v97
    v_cvt_pk_bf16_f32 v189, v98, v99
    s_add_u32 m0, s30, 2048
    s_add_u32 s5, s38, 350208
    buffer_load_dwordx4 v239, s[20:23], s5 offen lds
    buffer_load_dwordx4 v240, s[20:23], s5 offen offset:1024 lds
    v_mfma_f32_32x32x16_bf16 v[24:39], a[164:167], a[56:59], v[24:39]
    ds_read_b64_tr_b16 a[156:157], v230 offset:41984
    ds_read_b64_tr_b16 a[158:159], v230 offset:42496
    v_mul_f32 v100, v84, v100
    v_mul_f32 v101, v85, v101
    v_mul_f32 v102, v86, v102
    s_waitcnt lgkmcnt(8)
    v_mfma_f32_32x32x16_bf16 v[8:23], a[168:171], a[60:63], v[8:23]
    ds_read_b64_tr_b16 a[160:161], v230 offset:30720
    ds_read_b64_tr_b16 a[162:163], v230 offset:31232
    v_mul_f32 v103, v87, v103
    v_mul_f32 v84, v244, v84
    v_mul_f32 v85, v244, v85
    v_mfma_f32_32x32x16_bf16 v[24:39], a[172:175], a[60:63], v[24:39]
    ds_read_b64_tr_b16 a[164:165], v230 offset:43008
    ds_read_b64_tr_b16 a[166:167], v230 offset:43520
    v_mul_f32 v86, v244, v86
    v_mul_f32 v87, v244, v87
    v_exp_f32 v84, v84
    v_exp_f32 v85, v85
    s_waitcnt lgkmcnt(8)
    v_mfma_f32_32x32x16_bf16 v[8:23], a[144:147], a[64:67], v[8:23]
    ds_read_b64_tr_b16 a[168:169], v230 offset:31744
    ds_read_b64_tr_b16 a[170:171], v230 offset:32256
    v_exp_f32 v86, v86
    v_exp_f32 v87, v87
    v_fma_f32 v84, v84, v245, v245
    s_add_u32 m0, s30, 4096
    s_add_u32 s5, s38, 368640
    buffer_load_dwordx4 v239, s[20:23], s5 offen lds
    buffer_load_dwordx4 v240, s[20:23], s5 offen offset:1024 lds
    v_mfma_f32_32x32x16_bf16 v[24:39], a[148:151], a[64:67], v[24:39]
    ds_read_b64_tr_b16 a[172:173], v230 offset:44032
    ds_read_b64_tr_b16 a[174:175], v230 offset:44544
    v_fma_f32 v85, v85, v245, v245
    v_fma_f32 v86, v86, v245, v245
    v_fma_f32 v87, v87, v245, v245
    s_waitcnt lgkmcnt(8)
    v_mfma_f32_32x32x16_bf16 v[8:23], a[152:155], a[68:71], v[8:23]
    ds_read_b64_tr_b16 a[144:145], v230 offset:32768
    ds_read_b64_tr_b16 a[146:147], v230 offset:33280
    v_rcp_f32 v84, v84
    v_rcp_f32 v85, v85
    v_rcp_f32 v86, v86
    v_mfma_f32_32x32x16_bf16 v[24:39], a[156:159], a[68:71], v[24:39]
    ds_read_b64_tr_b16 a[148:149], v230 offset:45056
    ds_read_b64_tr_b16 a[150:151], v230 offset:45568
    v_rcp_f32 v87, v87
    v_mul_f32 v100, v100, v84
    v_mul_f32 v101, v101, v85
    v_mul_f32 v102, v102, v86
    s_waitcnt lgkmcnt(8)
    v_mfma_f32_32x32x16_bf16 v[8:23], a[160:163], a[72:75], v[8:23]
    ds_read_b64_tr_b16 a[152:153], v230 offset:33792
    ds_read_b64_tr_b16 a[154:155], v230 offset:34304
    v_mul_f32 v103, v103, v87
    v_cvt_pk_bf16_f32 v190, v100, v101
    v_cvt_pk_bf16_f32 v191, v102, v103
    v_mfma_f32_32x32x16_bf16 v[24:39], a[164:167], a[72:75], v[24:39]
    ds_read_b64_tr_b16 a[156:157], v230 offset:46080
    ds_read_b64_tr_b16 a[158:159], v230 offset:46592
    s_add_u32 s31, s52, 13312
    buffer_store_dwordx4 v[188:191], v242, s[16:19], s31 offen sc1
    v_mul_f32 v120, v104, v120
    v_mul_f32 v121, v105, v121
    s_waitcnt lgkmcnt(8)
    v_mfma_f32_32x32x16_bf16 v[8:23], a[168:171], a[76:79], v[8:23]
    ds_read_b64_tr_b16 a[160:161], v230 offset:34816
    ds_read_b64_tr_b16 a[162:163], v230 offset:35328
    v_mul_f32 v122, v106, v122
    v_mul_f32 v123, v107, v123
    v_mul_f32 v104, v244, v104
    v_mfma_f32_32x32x16_bf16 v[24:39], a[172:175], a[76:79], v[24:39]
    ds_read_b64_tr_b16 a[164:165], v230 offset:47104
    ds_read_b64_tr_b16 a[166:167], v230 offset:47616
    v_mul_f32 v105, v244, v105
    v_mul_f32 v106, v244, v106
    v_mul_f32 v107, v244, v107
    v_exp_f32 v104, v104
    s_waitcnt lgkmcnt(8)
    v_mfma_f32_32x32x16_bf16 v[8:23], a[144:147], a[80:83], v[8:23]
    ds_read_b64_tr_b16 a[168:169], v230 offset:35840
    ds_read_b64_tr_b16 a[170:171], v230 offset:36352
    v_exp_f32 v105, v105
    v_exp_f32 v106, v106
    v_exp_f32 v107, v107
    v_mfma_f32_32x32x16_bf16 v[24:39], a[148:151], a[80:83], v[24:39]
    ds_read_b64_tr_b16 a[172:173], v230 offset:48128
    ds_read_b64_tr_b16 a[174:175], v230 offset:48640
    v_fma_f32 v104, v104, v245, v245
    v_fma_f32 v105, v105, v245, v245
    v_fma_f32 v106, v106, v245, v245
    s_waitcnt lgkmcnt(8)
    v_mfma_f32_32x32x16_bf16 v[8:23], a[152:155], a[84:87], v[8:23]
    ds_read_b64_tr_b16 a[144:145], v231 offset:0
    ds_read_b64_tr_b16 a[146:147], v231 offset:512
    v_fma_f32 v107, v107, v245, v245
    v_rcp_f32 v104, v104
    v_rcp_f32 v105, v105
    v_mfma_f32_32x32x16_bf16 v[24:39], a[156:159], a[84:87], v[24:39]
    ds_read_b64_tr_b16 a[148:149], v231 offset:12288
    ds_read_b64_tr_b16 a[150:151], v231 offset:12800
    v_rcp_f32 v106, v106
    v_rcp_f32 v107, v107
    v_mul_f32 v120, v120, v104
    v_mul_f32 v121, v121, v105
    s_waitcnt lgkmcnt(8)
    v_mfma_f32_32x32x16_bf16 v[8:23], a[160:163], a[88:91], v[8:23]
    ds_read_b64_tr_b16 a[152:153], v231 offset:1024
    ds_read_b64_tr_b16 a[154:155], v231 offset:1536
    v_mul_f32 v122, v122, v106
    v_mul_f32 v123, v123, v107
    v_cvt_pk_bf16_f32 v192, v120, v121
    v_mfma_f32_32x32x16_bf16 v[24:39], a[164:167], a[88:91], v[24:39]
    ds_read_b64_tr_b16 a[156:157], v231 offset:13312
    ds_read_b64_tr_b16 a[158:159], v231 offset:13824
    v_cvt_pk_bf16_f32 v193, v122, v123
    v_mul_f32 v124, v108, v124
    v_mul_f32 v125, v109, v125
    s_waitcnt lgkmcnt(8)
    v_mfma_f32_32x32x16_bf16 v[8:23], a[168:171], a[92:95], v[8:23]
    ds_read_b64_tr_b16 a[160:161], v231 offset:2048
    ds_read_b64_tr_b16 a[162:163], v231 offset:2560
    v_mul_f32 v126, v110, v126
    v_mul_f32 v127, v111, v127
    v_mul_f32 v108, v244, v108
    buffer_load_dword v249, off, s[16:19], s55 offset:0 sc1
    v_mfma_f32_32x32x16_bf16 v[24:39], a[172:175], a[92:95], v[24:39]
    ds_read_b64_tr_b16 a[164:165], v231 offset:14336
    ds_read_b64_tr_b16 a[166:167], v231 offset:14848
    v_mul_f32 v109, v244, v109
    v_mul_f32 v110, v244, v110
    v_mul_f32 v111, v244, v111
    v_exp_f32 v108, v108
    s_waitcnt vmcnt(24)
    s_barrier
    s_waitcnt lgkmcnt(8)
    v_mfma_f32_32x32x16_bf16 v[8:23], a[144:147], a[96:99], v[8:23]
    ds_read_b64_tr_b16 a[168:169], v231 offset:3072
    ds_read_b64_tr_b16 a[170:171], v231 offset:3584
    v_exp_f32 v109, v109
    v_exp_f32 v110, v110
    v_exp_f32 v111, v111
    s_add_u32 m0, s30, 24576
    s_add_u32 s5, s38, 442368
    buffer_load_dwordx4 v239, s[20:23], s5 offen lds
    buffer_load_dwordx4 v240, s[20:23], s5 offen offset:1024 lds
    v_mfma_f32_32x32x16_bf16 v[24:39], a[148:151], a[96:99], v[24:39]
    ds_read_b64_tr_b16 a[172:173], v231 offset:15360
    ds_read_b64_tr_b16 a[174:175], v231 offset:15872
    v_fma_f32 v108, v108, v245, v245
    v_fma_f32 v109, v109, v245, v245
    v_fma_f32 v110, v110, v245, v245
    s_waitcnt lgkmcnt(8)
    v_mfma_f32_32x32x16_bf16 v[8:23], a[152:155], a[100:103], v[8:23]
    ds_read_b64_tr_b16 a[144:145], v231 offset:4096
    ds_read_b64_tr_b16 a[146:147], v231 offset:4608
    v_fma_f32 v111, v111, v245, v245
    v_rcp_f32 v108, v108
    v_rcp_f32 v109, v109
    v_rcp_f32 v110, v110
    v_mfma_f32_32x32x16_bf16 v[24:39], a[156:159], a[100:103], v[24:39]
    ds_read_b64_tr_b16 a[148:149], v231 offset:16384
    ds_read_b64_tr_b16 a[150:151], v231 offset:16896
    v_rcp_f32 v111, v111
    v_mul_f32 v124, v124, v108
    v_mul_f32 v125, v125, v109
    s_waitcnt lgkmcnt(8)
    v_mfma_f32_32x32x16_bf16 v[8:23], a[160:163], a[104:107], v[8:23]
    ds_read_b64_tr_b16 a[152:153], v231 offset:5120
    ds_read_b64_tr_b16 a[154:155], v231 offset:5632
    v_mul_f32 v126, v126, v110
    v_mul_f32 v127, v127, v111
    v_cvt_pk_bf16_f32 v194, v124, v125
    s_add_u32 m0, s30, 26624
    s_add_u32 s5, s38, 460800
    buffer_load_dwordx4 v239, s[20:23], s5 offen lds
    buffer_load_dwordx4 v240, s[20:23], s5 offen offset:1024 lds
    v_mfma_f32_32x32x16_bf16 v[24:39], a[164:167], a[104:107], v[24:39]
    ds_read_b64_tr_b16 a[156:157], v231 offset:17408
    ds_read_b64_tr_b16 a[158:159], v231 offset:17920
    v_cvt_pk_bf16_f32 v195, v126, v127
    s_add_u32 s31, s52, 14336
    buffer_store_dwordx4 v[192:195], v242, s[16:19], s31 offen sc1
    v_mul_f32 v128, v112, v128
    s_waitcnt lgkmcnt(8)
    v_mfma_f32_32x32x16_bf16 v[8:23], a[168:171], a[108:111], v[8:23]
    ds_read_b64_tr_b16 a[160:161], v231 offset:6144
    ds_read_b64_tr_b16 a[162:163], v231 offset:6656
    v_mul_f32 v129, v113, v129
    v_mul_f32 v130, v114, v130
    v_mul_f32 v131, v115, v131
    v_mul_f32 v112, v244, v112
    v_mfma_f32_32x32x16_bf16 v[24:39], a[172:175], a[108:111], v[24:39]
    ds_read_b64_tr_b16 a[164:165], v231 offset:18432
    ds_read_b64_tr_b16 a[166:167], v231 offset:18944
    v_mul_f32 v113, v244, v113
    v_mul_f32 v114, v244, v114
    v_mul_f32 v115, v244, v115
    s_waitcnt lgkmcnt(8)
    v_mfma_f32_32x32x16_bf16 v[8:23], a[144:147], a[112:115], v[8:23]
    ds_read_b64_tr_b16 a[168:169], v231 offset:7168
    ds_read_b64_tr_b16 a[170:171], v231 offset:7680
    v_exp_f32 v112, v112
    v_exp_f32 v113, v113
    v_exp_f32 v114, v114
    s_add_u32 m0, s30, 28672
    s_add_u32 s5, s38, 479232
    buffer_load_dwordx4 v239, s[20:23], s5 offen lds
    buffer_load_dwordx4 v240, s[20:23], s5 offen offset:1024 lds
    v_mfma_f32_32x32x16_bf16 v[24:39], a[148:151], a[112:115], v[24:39]
    ds_read_b64_tr_b16 a[172:173], v231 offset:19456
    ds_read_b64_tr_b16 a[174:175], v231 offset:19968
    v_exp_f32 v115, v115
    v_fma_f32 v112, v112, v245, v245
    v_fma_f32 v113, v113, v245, v245
    s_waitcnt lgkmcnt(8)
    v_mfma_f32_32x32x16_bf16 v[8:23], a[152:155], a[116:119], v[8:23]
    ds_read_b64_tr_b16 a[144:145], v231 offset:8192
    ds_read_b64_tr_b16 a[146:147], v231 offset:8704
    v_fma_f32 v114, v114, v245, v245
    v_fma_f32 v115, v115, v245, v245
    v_rcp_f32 v112, v112
    v_rcp_f32 v113, v113
    v_mfma_f32_32x32x16_bf16 v[24:39], a[156:159], a[116:119], v[24:39]
    ds_read_b64_tr_b16 a[148:149], v231 offset:20480
    ds_read_b64_tr_b16 a[150:151], v231 offset:20992
    v_rcp_f32 v114, v114
    v_rcp_f32 v115, v115
    v_mul_f32 v128, v128, v112
    s_waitcnt lgkmcnt(8)
    v_mfma_f32_32x32x16_bf16 v[8:23], a[160:163], a[120:123], v[8:23]
    ds_read_b64_tr_b16 a[152:153], v231 offset:9216
    ds_read_b64_tr_b16 a[154:155], v231 offset:9728
    v_mul_f32 v129, v129, v113
    v_mul_f32 v130, v130, v114
    v_mul_f32 v131, v131, v115
    v_mfma_f32_32x32x16_bf16 v[24:39], a[164:167], a[120:123], v[24:39]
    ds_read_b64_tr_b16 a[156:157], v231 offset:21504
    ds_read_b64_tr_b16 a[158:159], v231 offset:22016
    v_cvt_pk_bf16_f32 v196, v128, v129
    v_cvt_pk_bf16_f32 v197, v130, v131
    v_mul_f32 v132, v116, v132
    s_waitcnt lgkmcnt(8)
    v_mfma_f32_32x32x16_bf16 v[8:23], a[168:171], a[124:127], v[8:23]
    ds_read_b64_tr_b16 a[160:161], v231 offset:10240
    ds_read_b64_tr_b16 a[162:163], v231 offset:10752
    v_mul_f32 v133, v117, v133
    v_mul_f32 v134, v118, v134
    v_mul_f32 v135, v119, v135
    v_mul_f32 v116, v244, v116
    s_waitcnt vmcnt(7)
L_ffn_kernel_pca2:
    v_readfirstlane_b32 s50, v249
    s_sub_u32 s51, s51, 1
    s_cselect_b32 s50, 3, s50
    s_cmp_ge_u32 s50, 3
    s_cbranch_scc1 L_ffn_kernel_pda2
    buffer_load_dword v249, off, s[16:19], s55 offset:0 sc1
    s_waitcnt vmcnt(0)
    s_branch L_ffn_kernel_pca2
L_ffn_kernel_pda2:
    v_mfma_f32_32x32x16_bf16 v[24:39], a[172:175], a[124:127], v[24:39]
    ds_read_b64_tr_b16 a[164:165], v231 offset:22528
    ds_read_b64_tr_b16 a[166:167], v231 offset:23040
    v_mul_f32 v117, v244, v117
    v_mul_f32 v118, v244, v118
    v_mul_f32 v119, v244, v119
    s_add_u32 s31, s53, 8192
    buffer_load_dwordx4 a[208:211], v242, s[16:19], s31 offen sc1
    s_waitcnt lgkmcnt(8)
    v_mfma_f32_32x32x16_bf16 v[8:23], a[144:147], a[128:131], v[8:23]
    ds_read_b64_tr_b16 a[168:169], v231 offset:11264
    ds_read_b64_tr_b16 a[170:171], v231 offset:11776
    v_exp_f32 v116, v116
    v_exp_f32 v117, v117
    v_exp_f32 v118, v118
    v_mfma_f32_32x32x16_bf16 v[24:39], a[148:151], a[128:131], v[24:39]
    ds_read_b64_tr_b16 a[172:173], v231 offset:23552
    ds_read_b64_tr_b16 a[174:175], v231 offset:24064
    v_exp_f32 v119, v119
    v_fma_f32 v116, v116, v245, v245
    v_fma_f32 v117, v117, v245, v245
    s_waitcnt lgkmcnt(8)
    v_mfma_f32_32x32x16_bf16 v[8:23], a[152:155], a[132:135], v[8:23]
    ds_read_b64_tr_b16 a[144:145], v225 offset:24576
    ds_read_b64_tr_b16 a[146:147], v225 offset:25600
    v_fma_f32 v118, v118, v245, v245
    v_fma_f32 v119, v119, v245, v245
    v_rcp_f32 v116, v116
    v_rcp_f32 v117, v117
    v_mfma_f32_32x32x16_bf16 v[24:39], a[156:159], a[132:135], v[24:39]
    ds_read_b64_tr_b16 a[148:149], v228 offset:24576
    ds_read_b64_tr_b16 a[150:151], v228 offset:25600
    v_rcp_f32 v118, v118
    v_rcp_f32 v119, v119
    v_mul_f32 v132, v132, v116
    s_waitcnt lgkmcnt(8)
    v_mfma_f32_32x32x16_bf16 v[8:23], a[160:163], a[136:139], v[8:23]
    ds_read_b64_tr_b16 a[152:153], v225 offset:36864
    ds_read_b64_tr_b16 a[154:155], v225 offset:37888
    v_mul_f32 v133, v133, v117
    v_mul_f32 v134, v134, v118
    v_mul_f32 v135, v135, v119
    v_mfma_f32_32x32x16_bf16 v[24:39], a[164:167], a[136:139], v[24:39]
    ds_read_b64_tr_b16 a[156:157], v228 offset:36864
    ds_read_b64_tr_b16 a[158:159], v228 offset:37888
    v_cvt_pk_bf16_f32 v198, v132, v133
    v_cvt_pk_bf16_f32 v199, v134, v135
    s_add_u32 s31, s52, 15360
    buffer_store_dwordx4 v[196:199], v242, s[16:19], s31 offen sc1
    s_waitcnt lgkmcnt(8)
    v_mfma_f32_32x32x16_bf16 v[8:23], a[168:171], a[140:143], v[8:23]
    ds_read_b64_tr_b16 a[160:161], v225 offset:26624
    ds_read_b64_tr_b16 a[162:163], v225 offset:27648
    v_mfma_f32_32x32x16_bf16 v[24:39], a[172:175], a[140:143], v[24:39]
    ds_read_b64_tr_b16 a[164:165], v228 offset:26624
    ds_read_b64_tr_b16 a[166:167], v228 offset:27648
    s_waitcnt vmcnt(25)
    s_barrier
    s_waitcnt lgkmcnt(8)
    v_mfma_f32_32x32x16_bf16 v[72:87], a[144:147], v[136:139], 0
    ds_read_b64_tr_b16 a[168:169], v225 offset:38912
    ds_read_b64_tr_b16 a[170:171], v225 offset:39936
    s_add_u32 m0, s30, 49152
    s_add_u32 s5, s36, 256
    v_add_u32 v239, s4, v239
    v_add_u32 v240, s4, v240
    buffer_load_dwordx4 v239, s[20:23], s5 offen lds
    buffer_load_dwordx4 v240, s[20:23], s5 offen offset:1024 lds
    v_mfma_f32_32x32x16_bf16 v[88:103], a[148:151], v[136:139], 0
    ds_read_b64_tr_b16 a[172:173], v228 offset:38912
    ds_read_b64_tr_b16 a[174:175], v228 offset:39936
    s_waitcnt lgkmcnt(8)
    v_mfma_f32_32x32x16_bf16 v[104:119], a[152:155], v[136:139], 0
    ds_read_b64_tr_b16 a[144:145], v225 offset:28672
    ds_read_b64_tr_b16 a[146:147], v225 offset:29696
    v_mfma_f32_32x32x16_bf16 v[120:135], a[156:159], v[136:139], 0
    ds_read_b64_tr_b16 a[148:149], v228 offset:28672
    ds_read_b64_tr_b16 a[150:151], v228 offset:29696
    s_waitcnt lgkmcnt(8)
    v_mfma_f32_32x32x16_bf16 v[72:87], a[160:163], v[140:143], v[72:87]
    ds_read_b64_tr_b16 a[152:153], v225 offset:40960
    ds_read_b64_tr_b16 a[154:155], v225 offset:41984
    s_add_u32 m0, s30, 51200
    s_add_u32 s5, s36, 18688
    buffer_load_dwordx4 v239, s[20:23], s5 offen lds
    buffer_load_dwordx4 v240, s[20:23], s5 offen offset:1024 lds
    v_mfma_f32_32x32x16_bf16 v[88:103], a[164:167], v[140:143], v[88:103]
    ds_read_b64_tr_b16 a[156:157], v228 offset:40960
    ds_read_b64_tr_b16 a[158:159], v228 offset:41984
    v_mul_f32 v24, v8, v24
    v_mul_f32 v25, v9, v25
    v_mul_f32 v26, v10, v26
    v_mul_f32 v27, v11, v27
    s_add_u32 s31, s53, 9216
    buffer_load_dwordx4 a[212:215], v242, s[16:19], s31 offen sc1
    s_waitcnt lgkmcnt(8)
    v_mfma_f32_32x32x16_bf16 v[104:119], a[168:171], v[140:143], v[104:119]
    ds_read_b64_tr_b16 a[160:161], v225 offset:30720
    ds_read_b64_tr_b16 a[162:163], v225 offset:31744
    v_mul_f32 v8, v244, v8
    v_mul_f32 v9, v244, v9
    v_mul_f32 v10, v244, v10
    v_mul_f32 v11, v244, v11
    v_mfma_f32_32x32x16_bf16 v[120:135], a[172:175], v[140:143], v[120:135]
    ds_read_b64_tr_b16 a[164:165], v228 offset:30720
    ds_read_b64_tr_b16 a[166:167], v228 offset:31744
    v_exp_f32 v8, v8
    v_exp_f32 v9, v9
    v_exp_f32 v10, v10
    s_waitcnt lgkmcnt(8)
    v_mfma_f32_32x32x16_bf16 v[72:87], a[144:147], v[144:147], v[72:87]
    ds_read_b64_tr_b16 a[168:169], v225 offset:43008
    ds_read_b64_tr_b16 a[170:171], v225 offset:44032
    v_exp_f32 v11, v11
    v_fma_f32 v8, v8, v245, v245
    v_fma_f32 v9, v9, v245, v245
    v_fma_f32 v10, v10, v245, v245
    s_add_u32 m0, s30, 53248
    s_add_u32 s5, s36, 37120
    buffer_load_dwordx4 v239, s[20:23], s5 offen lds
    buffer_load_dwordx4 v240, s[20:23], s5 offen offset:1024 lds
    v_mfma_f32_32x32x16_bf16 v[88:103], a[148:151], v[144:147], v[88:103]
    ds_read_b64_tr_b16 a[172:173], v228 offset:43008
    ds_read_b64_tr_b16 a[174:175], v228 offset:44032
    v_fma_f32 v11, v11, v245, v245
    v_rcp_f32 v8, v8
    v_rcp_f32 v9, v9
    v_rcp_f32 v10, v10
    s_waitcnt lgkmcnt(8)
    v_mfma_f32_32x32x16_bf16 v[104:119], a[152:155], v[144:147], v[104:119]
    ds_read_b64_tr_b16 a[144:145], v225 offset:32768
    ds_read_b64_tr_b16 a[146:147], v225 offset:33792
    v_rcp_f32 v11, v11
    v_mul_f32 v24, v24, v8
    v_mul_f32 v25, v25, v9
    v_mfma_f32_32x32x16_bf16 v[120:135], a[156:159], v[144:147], v[120:135]
    ds_read_b64_tr_b16 a[148:149], v228 offset:32768
    ds_read_b64_tr_b16 a[150:151], v228 offset:33792
    v_mul_f32 v26, v26, v10
    v_mul_f32 v27, v27, v11
    v_cvt_pk_bf16_f32 v200, v24, v25
    v_cvt_pk_bf16_f32 v201, v26, v27
    s_waitcnt lgkmcnt(8)
    v_mfma_f32_32x32x16_bf16 v[72:87], a[160:163], v[148:151], v[72:87]
    ds_read_b64_tr_b16 a[152:153], v225 offset:45056
    ds_read_b64_tr_b16 a[154:155], v225 offset:46080
    v_mul_f32 v28, v12, v28
    v_mul_f32 v29, v13, v29
    v_mul_f32 v30, v14, v30
    v_mul_f32 v31, v15, v31
    v_mfma_f32_32x32x16_bf16 v[88:103], a[164:167], v[148:151], v[88:103]
    ds_read_b64_tr_b16 a[156:157], v228 offset:45056
    ds_read_b64_tr_b16 a[158:159], v228 offset:46080
    v_mul_f32 v12, v244, v12
    v_mul_f32 v13, v244, v13
    v_mul_f32 v14, v244, v14
    s_waitcnt lgkmcnt(8)
    v_mfma_f32_32x32x16_bf16 v[104:119], a[168:171], v[148:151], v[104:119]
    ds_read_b64_tr_b16 a[160:161], v225 offset:34816
    ds_read_b64_tr_b16 a[162:163], v225 offset:35840
    v_mul_f32 v15, v244, v15
    v_exp_f32 v12, v12
    v_exp_f32 v13, v13
    v_exp_f32 v14, v14
    v_mfma_f32_32x32x16_bf16 v[120:135], a[172:175], v[148:151], v[120:135]
    ds_read_b64_tr_b16 a[164:165], v228 offset:34816
    ds_read_b64_tr_b16 a[166:167], v228 offset:35840
    v_exp_f32 v15, v15
    v_fma_f32 v12, v12, v245, v245
    v_fma_f32 v13, v13, v245, v245
    v_fma_f32 v14, v14, v245, v245
    s_waitcnt lgkmcnt(8)
    v_mfma_f32_32x32x16_bf16 v[72:87], a[144:147], v[152:155], v[72:87]
    ds_read_b64_tr_b16 a[168:169], v225 offset:47104
    ds_read_b64_tr_b16 a[170:171], v225 offset:48128
    v_fma_f32 v15, v15, v245, v245
    v_rcp_f32 v12, v12
    v_rcp_f32 v13, v13
    v_mfma_f32_32x32x16_bf16 v[88:103], a[148:151], v[152:155], v[88:103]
    ds_read_b64_tr_b16 a[172:173], v228 offset:47104
    ds_read_b64_tr_b16 a[174:175], v228 offset:48128
    v_rcp_f32 v14, v14
    v_rcp_f32 v15, v15
    v_mul_f32 v28, v28, v12
    v_mul_f32 v29, v29, v13
    s_waitcnt lgkmcnt(8)
    v_mfma_f32_32x32x16_bf16 v[104:119], a[152:155], v[152:155], v[104:119]
    ds_read_b64_tr_b16 a[144:145], v226 offset:0
    ds_read_b64_tr_b16 a[146:147], v226 offset:1024
    v_mul_f32 v30, v30, v14
    v_mul_f32 v31, v31, v15
    v_cvt_pk_bf16_f32 v202, v28, v29
    v_cvt_pk_bf16_f32 v203, v30, v31
    v_mfma_f32_32x32x16_bf16 v[120:135], a[156:159], v[152:155], v[120:135]
    ds_read_b64_tr_b16 a[148:149], v229 offset:0
    ds_read_b64_tr_b16 a[150:151], v229 offset:1024
    s_add_u32 s31, s52, 16384
    buffer_store_dwordx4 v[200:203], v242, s[16:19], s31 offen sc1
    v_mul_f32 v32, v16, v32
    v_mul_f32 v33, v17, v33
    s_add_u32 s31, s53, 10240
    buffer_load_dwordx4 a[216:219], v242, s[16:19], s31 offen sc1
    s_waitcnt lgkmcnt(8)
    v_mfma_f32_32x32x16_bf16 v[72:87], a[160:163], v[156:159], v[72:87]
    ds_read_b64_tr_b16 a[152:153], v226 offset:12288
    ds_read_b64_tr_b16 a[154:155], v226 offset:13312
    v_mul_f32 v34, v18, v34
    v_mul_f32 v35, v19, v35
    v_mul_f32 v16, v244, v16
    v_mul_f32 v17, v244, v17
    v_mfma_f32_32x32x16_bf16 v[88:103], a[164:167], v[156:159], v[88:103]
    ds_read_b64_tr_b16 a[156:157], v229 offset:12288
    ds_read_b64_tr_b16 a[158:159], v229 offset:13312
    v_mul_f32 v18, v244, v18
    v_mul_f32 v19, v244, v19
    v_exp_f32 v16, v16
    v_exp_f32 v17, v17
    s_waitcnt lgkmcnt(8)
    v_mfma_f32_32x32x16_bf16 v[104:119], a[168:171], v[156:159], v[104:119]
    ds_read_b64_tr_b16 a[160:161], v226 offset:2048
    ds_read_b64_tr_b16 a[162:163], v226 offset:3072
    v_exp_f32 v18, v18
    v_exp_f32 v19, v19
    v_fma_f32 v16, v16, v245, v245
    v_mfma_f32_32x32x16_bf16 v[120:135], a[172:175], v[156:159], v[120:135]
    ds_read_b64_tr_b16 a[164:165], v229 offset:2048
    ds_read_b64_tr_b16 a[166:167], v229 offset:3072
    v_fma_f32 v17, v17, v245, v245
    v_fma_f32 v18, v18, v245, v245
    v_fma_f32 v19, v19, v245, v245
    v_rcp_f32 v16, v16
    s_waitcnt vmcnt(28)
    s_barrier
    s_waitcnt lgkmcnt(8)
    v_mfma_f32_32x32x16_bf16 v[72:87], a[144:147], v[160:163], v[72:87]
    ds_read_b64_tr_b16 a[168:169], v226 offset:14336
    ds_read_b64_tr_b16 a[170:171], v226 offset:15360
    v_rcp_f32 v17, v17
    v_rcp_f32 v18, v18
    v_rcp_f32 v19, v19
    v_mul_f32 v32, v32, v16
    s_add_u32 m0, s30, 73728
    s_add_u32 s5, s36, 221440
    s_add_u32 s34, s38, 221440
    s_cmp_ge_u32 s24, 2
    s_cselect_b32 s5, s34, s5
    buffer_load_dwordx4 v239, s[20:23], s5 offen lds
    buffer_load_dwordx4 v240, s[20:23], s5 offen offset:1024 lds
    v_mfma_f32_32x32x16_bf16 v[88:103], a[148:151], v[160:163], v[88:103]
    ds_read_b64_tr_b16 a[172:173], v229 offset:14336
    ds_read_b64_tr_b16 a[174:175], v229 offset:15360
    v_mul_f32 v33, v33, v17
    v_mul_f32 v34, v34, v18
    v_mul_f32 v35, v35, v19
    s_waitcnt lgkmcnt(8)
    v_mfma_f32_32x32x16_bf16 v[104:119], a[152:155], v[160:163], v[104:119]
    ds_read_b64_tr_b16 a[144:145], v226 offset:4096
    ds_read_b64_tr_b16 a[146:147], v226 offset:5120
    v_cvt_pk_bf16_f32 v204, v32, v33
    v_cvt_pk_bf16_f32 v205, v34, v35
    v_mul_f32 v36, v20, v36
    v_mul_f32 v37, v21, v37
    v_mfma_f32_32x32x16_bf16 v[120:135], a[156:159], v[160:163], v[120:135]
    ds_read_b64_tr_b16 a[148:149], v229 offset:4096
    ds_read_b64_tr_b16 a[150:151], v229 offset:5120
    v_mul_f32 v38, v22, v38
    v_mul_f32 v39, v23, v39
    v_mul_f32 v20, v244, v20
    v_mul_f32 v21, v244, v21
    s_waitcnt lgkmcnt(8)
    v_mfma_f32_32x32x16_bf16 v[72:87], a[160:163], v[164:167], v[72:87]
    ds_read_b64_tr_b16 a[152:153], v226 offset:16384
    ds_read_b64_tr_b16 a[154:155], v226 offset:17408
    v_mul_f32 v22, v244, v22
    v_mul_f32 v23, v244, v23
    v_exp_f32 v20, v20
    s_add_u32 m0, s30, 75776
    s_add_u32 s5, s36, 239872
    s_add_u32 s34, s37, 239872
    s_cmp_ge_u32 s24, 1
    s_cselect_b32 s5, s34, s5
    s_add_u32 s34, s38, 239872
    s_cmp_ge_u32 s24, 2
    s_cselect_b32 s5, s34, s5
    buffer_load_dwordx4 v239, s[20:23], s5 offen lds
    buffer_load_dwordx4 v240, s[20:23], s5 offen offset:1024 lds
    v_mfma_f32_32x32x16_bf16 v[88:103], a[164:167], v[164:167], v[88:103]
    ds_read_b64_tr_b16 a[156:157], v229 offset:16384
    ds_read_b64_tr_b16 a[158:159], v229 offset:17408
    v_exp_f32 v21, v21
    v_exp_f32 v22, v22
    v_exp_f32 v23, v23
    v_fma_f32 v20, v20, v245, v245
    s_waitcnt lgkmcnt(8)
    v_mfma_f32_32x32x16_bf16 v[104:119], a[168:171], v[164:167], v[104:119]
    ds_read_b64_tr_b16 a[160:161], v226 offset:6144
    ds_read_b64_tr_b16 a[162:163], v226 offset:7168
    v_fma_f32 v21, v21, v245, v245
    v_fma_f32 v22, v22, v245, v245
    v_fma_f32 v23, v23, v245, v245
    v_rcp_f32 v20, v20
    v_mfma_f32_32x32x16_bf16 v[120:135], a[172:175], v[164:167], v[120:135]
    ds_read_b64_tr_b16 a[164:165], v229 offset:6144
    ds_read_b64_tr_b16 a[166:167], v229 offset:7168
    v_rcp_f32 v21, v21
    v_rcp_f32 v22, v22
    v_rcp_f32 v23, v23
    s_waitcnt lgkmcnt(8)
    v_mfma_f32_32x32x16_bf16 v[72:87], a[144:147], v[168:171], v[72:87]
    ds_read_b64_tr_b16 a[168:169], v226 offset:18432
    ds_read_b64_tr_b16 a[170:171], v226 offset:19456
    v_mul_f32 v36, v36, v20
    v_mul_f32 v37, v37, v21
    v_mul_f32 v38, v38, v22
    v_mul_f32 v39, v39, v23
    s_add_u32 m0, s30, 77824
    s_add_u32 s5, s36, 258304
    s_add_u32 s34, s37, 258304
    s_cmp_ge_u32 s24, 1
    s_cselect_b32 s5, s34, s5
    s_add_u32 s34, s38, 258304
    s_cmp_ge_u32 s24, 2
    s_cselect_b32 s5, s34, s5
    buffer_load_dwordx4 v239, s[20:23], s5 offen lds
    buffer_load_dwordx4 v240, s[20:23], s5 offen offset:1024 lds
    v_mfma_f32_32x32x16_bf16 v[88:103], a[148:151], v[168:171], v[88:103]
    ds_read_b64_tr_b16 a[172:173], v229 offset:18432
    ds_read_b64_tr_b16 a[174:175], v229 offset:19456
    v_cvt_pk_bf16_f32 v206, v36, v37
    v_cvt_pk_bf16_f32 v207, v38, v39
    s_add_u32 s31, s52, 17408
    buffer_store_dwordx4 v[204:207], v242, s[16:19], s31 offen sc1
    s_add_u32 s31, s53, 11264
    buffer_load_dwordx4 a[220:223], v242, s[16:19], s31 offen sc1
    s_waitcnt lgkmcnt(8)
    v_mfma_f32_32x32x16_bf16 v[104:119], a[152:155], v[168:171], v[104:119]
    ds_read_b64_tr_b16 a[144:145], v226 offset:8192
    ds_read_b64_tr_b16 a[146:147], v226 offset:9216
    v_mfma_f32_32x32x16_bf16 v[120:135], a[156:159], v[168:171], v[120:135]
    ds_read_b64_tr_b16 a[148:149], v229 offset:8192
    ds_read_b64_tr_b16 a[150:151], v229 offset:9216
    s_waitcnt lgkmcnt(8)
    v_mfma_f32_32x32x16_bf16 v[72:87], a[160:163], v[172:175], v[72:87]
    ds_read_b64_tr_b16 a[152:153], v226 offset:20480
    ds_read_b64_tr_b16 a[154:155], v226 offset:21504
    v_mfma_f32_32x32x16_bf16 v[88:103], a[164:167], v[172:175], v[88:103]
    ds_read_b64_tr_b16 a[156:157], v229 offset:20480
    ds_read_b64_tr_b16 a[158:159], v229 offset:21504
    s_waitcnt lgkmcnt(8)
    v_mfma_f32_32x32x16_bf16 v[104:119], a[168:171], v[172:175], v[104:119]
    ds_read_b64_tr_b16 a[160:161], v226 offset:10240
    ds_read_b64_tr_b16 a[162:163], v226 offset:11264
    v_mfma_f32_32x32x16_bf16 v[120:135], a[172:175], v[172:175], v[120:135]
    ds_read_b64_tr_b16 a[164:165], v229 offset:10240
    ds_read_b64_tr_b16 a[166:167], v229 offset:11264
    s_waitcnt lgkmcnt(8)
    v_mfma_f32_32x32x16_bf16 v[72:87], a[144:147], v[176:179], v[72:87]
    ds_read_b64_tr_b16 a[168:169], v226 offset:22528
    ds_read_b64_tr_b16 a[170:171], v226 offset:23552
    v_mfma_f32_32x32x16_bf16 v[88:103], a[148:151], v[176:179], v[88:103]
    ds_read_b64_tr_b16 a[172:173], v229 offset:22528
    ds_read_b64_tr_b16 a[174:175], v229 offset:23552
    s_waitcnt lgkmcnt(8)
    v_mfma_f32_32x32x16_bf16 v[104:119], a[152:155], v[176:179], v[104:119]
    ds_read_b64_tr_b16 a[144:145], v226 offset:24576
    ds_read_b64_tr_b16 a[146:147], v226 offset:25600
    v_mfma_f32_32x32x16_bf16 v[120:135], a[156:159], v[176:179], v[120:135]
    ds_read_b64_tr_b16 a[148:149], v229 offset:24576
    ds_read_b64_tr_b16 a[150:151], v229 offset:25600
    s_waitcnt lgkmcnt(8)
    v_mfma_f32_32x32x16_bf16 v[72:87], a[160:163], v[180:183], v[72:87]
    ds_read_b64_tr_b16 a[152:153], v226 offset:36864
    ds_read_b64_tr_b16 a[154:155], v226 offset:37888
    v_mfma_f32_32x32x16_bf16 v[88:103], a[164:167], v[180:183], v[88:103]
    ds_read_b64_tr_b16 a[156:157], v229 offset:36864
    ds_read_b64_tr_b16 a[158:159], v229 offset:37888
    s_waitcnt lgkmcnt(8)
    v_mfma_f32_32x32x16_bf16 v[104:119], a[168:171], v[180:183], v[104:119]
    ds_read_b64_tr_b16 a[160:161], v226 offset:26624
    ds_read_b64_tr_b16 a[162:163], v226 offset:27648
    v_mfma_f32_32x32x16_bf16 v[120:135], a[172:175], v[180:183], v[120:135]
    ds_read_b64_tr_b16 a[164:165], v229 offset:26624
    ds_read_b64_tr_b16 a[166:167], v229 offset:27648
    s_waitcnt vmcnt(28)
    s_barrier
    s_waitcnt lgkmcnt(8)
    v_mfma_f32_32x32x16_bf16 v[72:87], a[144:147], v[184:187], v[72:87]
    ds_read_b64_tr_b16 a[168:169], v226 offset:38912
    ds_read_b64_tr_b16 a[170:171], v226 offset:39936
    s_add_u32 m0, s30, 98304
    s_add_u32 s5, s38, 552960
    v_subrev_u32 v239, s4, v239
    v_subrev_u32 v240, s4, v240
    buffer_load_dwordx4 v239, s[20:23], s5 offen lds
    buffer_load_dwordx4 v240, s[20:23], s5 offen offset:1024 lds
    v_mfma_f32_32x32x16_bf16 v[88:103], a[148:151], v[184:187], v[88:103]
    ds_read_b64_tr_b16 a[172:173], v229 offset:38912
    ds_read_b64_tr_b16 a[174:175], v229 offset:39936
    s_waitcnt lgkmcnt(8)
    v_mfma_f32_32x32x16_bf16 v[104:119], a[152:155], v[184:187], v[104:119]
    ds_read_b64_tr_b16 a[144:145], v226 offset:28672
    ds_read_b64_tr_b16 a[146:147], v226 offset:29696
    v_mfma_f32_32x32x16_bf16 v[120:135], a[156:159], v[184:187], v[120:135]
    ds_read_b64_tr_b16 a[148:149], v229 offset:28672
    ds_read_b64_tr_b16 a[150:151], v229 offset:29696
    s_waitcnt lgkmcnt(8)
    v_mfma_f32_32x32x16_bf16 v[72:87], a[160:163], v[188:191], v[72:87]
    ds_read_b64_tr_b16 a[152:153], v226 offset:40960
    ds_read_b64_tr_b16 a[154:155], v226 offset:41984
    s_add_u32 m0, s30, 100352
    s_add_u32 s5, s38, 571392
    s_add_u32 s34, s39, 571392
    s_cmp_ge_u32 s41, 1
    s_cselect_b32 s5, s34, s5
    buffer_load_dwordx4 v239, s[20:23], s5 offen lds
    buffer_load_dwordx4 v240, s[20:23], s5 offen offset:1024 lds
    v_mfma_f32_32x32x16_bf16 v[88:103], a[164:167], v[188:191], v[88:103]
    ds_read_b64_tr_b16 a[156:157], v229 offset:40960
    ds_read_b64_tr_b16 a[158:159], v229 offset:41984
    s_waitcnt lgkmcnt(8)
    v_mfma_f32_32x32x16_bf16 v[104:119], a[168:171], v[188:191], v[104:119]
    ds_read_b64_tr_b16 a[160:161], v226 offset:30720
    ds_read_b64_tr_b16 a[162:163], v226 offset:31744
    v_mfma_f32_32x32x16_bf16 v[120:135], a[172:175], v[188:191], v[120:135]
    ds_read_b64_tr_b16 a[164:165], v229 offset:30720
    ds_read_b64_tr_b16 a[166:167], v229 offset:31744
    s_waitcnt lgkmcnt(8)
    v_mfma_f32_32x32x16_bf16 v[72:87], a[144:147], v[192:195], v[72:87]
    ds_read_b64_tr_b16 a[168:169], v226 offset:43008
    ds_read_b64_tr_b16 a[170:171], v226 offset:44032
    s_add_u32 m0, s30, 102400
    s_add_u32 s5, s38, 589824
    s_add_u32 s34, s39, 589824
    s_cmp_ge_u32 s41, 1
    s_cselect_b32 s5, s34, s5
    buffer_load_dwordx4 v239, s[20:23], s5 offen lds
    buffer_load_dwordx4 v240, s[20:23], s5 offen offset:1024 lds
    v_mfma_f32_32x32x16_bf16 v[88:103], a[148:151], v[192:195], v[88:103]
    ds_read_b64_tr_b16 a[172:173], v229 offset:43008
    ds_read_b64_tr_b16 a[174:175], v229 offset:44032
    s_waitcnt lgkmcnt(8)
    v_mfma_f32_32x32x16_bf16 v[104:119], a[152:155], v[192:195], v[104:119]
    ds_read_b64_tr_b16 a[144:145], v226 offset:32768
    ds_read_b64_tr_b16 a[146:147], v226 offset:33792
    v_mfma_f32_32x32x16_bf16 v[120:135], a[156:159], v[192:195], v[120:135]
    ds_read_b64_tr_b16 a[148:149], v229 offset:32768
    ds_read_b64_tr_b16 a[150:151], v229 offset:33792
    s_waitcnt lgkmcnt(8)
    v_mfma_f32_32x32x16_bf16 v[72:87], a[160:163], v[196:199], v[72:87]
    ds_read_b64_tr_b16 a[152:153], v226 offset:45056
    ds_read_b64_tr_b16 a[154:155], v226 offset:46080
    v_mfma_f32_32x32x16_bf16 v[88:103], a[164:167], v[196:199], v[88:103]
    ds_read_b64_tr_b16 a[156:157], v229 offset:45056
    ds_read_b64_tr_b16 a[158:159], v229 offset:46080
    s_waitcnt lgkmcnt(8)
    v_mfma_f32_32x32x16_bf16 v[104:119], a[168:171], v[196:199], v[104:119]
    ds_read_b64_tr_b16 a[160:161], v226 offset:34816
    ds_read_b64_tr_b16 a[162:163], v226 offset:35840
    v_mfma_f32_32x32x16_bf16 v[120:135], a[172:175], v[196:199], v[120:135]
    ds_read_b64_tr_b16 a[164:165], v229 offset:34816
    ds_read_b64_tr_b16 a[166:167], v229 offset:35840
    s_waitcnt lgkmcnt(8)
    v_mfma_f32_32x32x16_bf16 v[72:87], a[144:147], v[200:203], v[72:87]
    ds_read_b64_tr_b16 a[168:169], v226 offset:47104
    ds_read_b64_tr_b16 a[170:171], v226 offset:48128
    v_mfma_f32_32x32x16_bf16 v[88:103], a[148:151], v[200:203], v[88:103]
    ds_read_b64_tr_b16 a[172:173], v229 offset:47104
    ds_read_b64_tr_b16 a[174:175], v229 offset:48128
    s_waitcnt lgkmcnt(8)
    v_mfma_f32_32x32x16_bf16 v[104:119], a[152:155], v[200:203], v[104:119]
    ds_read_b64_tr_b16 a[144:145], v224 offset:0
    ds_read_b64_tr_b16 a[146:147], v224 offset:1024
    s_waitcnt vmcnt(7)
    v_mov_b32 v250, 4
    buffer_store_dword v250, v246, s[16:19], s54 offen sc1
    v_mfma_f32_32x32x16_bf16 v[120:135], a[156:159], v[200:203], v[120:135]
    ds_read_b64_tr_b16 a[148:149], v227 offset:0
    ds_read_b64_tr_b16 a[150:151], v227 offset:1024
    s_waitcnt lgkmcnt(8)
    v_mfma_f32_32x32x16_bf16 v[72:87], a[160:163], v[204:207], v[72:87]
    ds_read_b64_tr_b16 a[152:153], v224 offset:12288
    ds_read_b64_tr_b16 a[154:155], v224 offset:13312
    v_mfma_f32_32x32x16_bf16 v[88:103], a[164:167], v[204:207], v[88:103]
    ds_read_b64_tr_b16 a[156:157], v227 offset:12288
    ds_read_b64_tr_b16 a[158:159], v227 offset:13312
    s_waitcnt lgkmcnt(8)
    v_mfma_f32_32x32x16_bf16 v[104:119], a[168:171], v[204:207], v[104:119]
    ds_read_b64_tr_b16 a[160:161], v224 offset:2048
    ds_read_b64_tr_b16 a[162:163], v224 offset:3072
    v_mfma_f32_32x32x16_bf16 v[120:135], a[172:175], v[204:207], v[120:135]
    ds_read_b64_tr_b16 a[164:165], v227 offset:2048
    ds_read_b64_tr_b16 a[166:167], v227 offset:3072
    s_waitcnt vmcnt(26)
    s_barrier
    s_waitcnt vmcnt(63)
    s_waitcnt lgkmcnt(8)
    v_mfma_f32_32x32x16_bf16 v[72:87], a[144:147], a[176:179], v[72:87]
    ds_read_b64_tr_b16 a[168:169], v224 offset:14336
    ds_read_b64_tr_b16 a[170:171], v224 offset:15360
    s_add_u32 m0, s30, 122880
    s_add_u32 s5, s38, 442624
    v_add_u32 v239, s4, v239
    v_add_u32 v240, s4, v240
    buffer_load_dwordx4 v239, s[20:23], s5 offen lds
    buffer_load_dwordx4 v240, s[20:23], s5 offen offset:1024 lds
    v_mfma_f32_32x32x16_bf16 v[88:103], a[148:151], a[176:179], v[88:103]
    ds_read_b64_tr_b16 a[172:173], v227 offset:14336
    ds_read_b64_tr_b16 a[174:175], v227 offset:15360
    s_waitcnt lgkmcnt(8)
    v_mfma_f32_32x32x16_bf16 v[104:119], a[152:155], a[176:179], v[104:119]
    ds_read_b64_tr_b16 a[144:145], v224 offset:4096
    ds_read_b64_tr_b16 a[146:147], v224 offset:5120
    v_mfma_f32_32x32x16_bf16 v[120:135], a[156:159], a[176:179], v[120:135]
    ds_read_b64_tr_b16 a[148:149], v227 offset:4096
    ds_read_b64_tr_b16 a[150:151], v227 offset:5120
    s_waitcnt vmcnt(63)
    s_waitcnt lgkmcnt(8)
    v_mfma_f32_32x32x16_bf16 v[72:87], a[160:163], a[180:183], v[72:87]
    ds_read_b64_tr_b16 a[152:153], v224 offset:16384
    ds_read_b64_tr_b16 a[154:155], v224 offset:17408
    s_add_u32 m0, s30, 124928
    s_add_u32 s5, s38, 461056
    s_add_u32 s34, s39, 461056
    s_cmp_ge_u32 s24, 3
    s_cselect_b32 s5, s34, s5
    buffer_load_dwordx4 v239, s[20:23], s5 offen lds
    buffer_load_dwordx4 v240, s[20:23], s5 offen offset:1024 lds
    v_mfma_f32_32x32x16_bf16 v[88:103], a[164:167], a[180:183], v[88:103]
    ds_read_b64_tr_b16 a[156:157], v227 offset:16384
    ds_read_b64_tr_b16 a[158:159], v227 offset:17408
    s_waitcnt lgkmcnt(8)
    v_mfma_f32_32x32x16_bf16 v[104:119], a[168:171], a[180:183], v[104:119]
    ds_read_b64_tr_b16 a[160:161], v224 offset:6144
    ds_read_b64_tr_b16 a[162:163], v224 offset:7168
    v_mfma_f32_32x32x16_bf16 v[120:135], a[172:175], a[180:183], v[120:135]
    ds_read_b64_tr_b16 a[164:165], v227 offset:6144
    ds_read_b64_tr_b16 a[166:167], v227 offset:7168
    s_waitcnt vmcnt(63)
    s_waitcnt lgkmcnt(8)
    v_mfma_f32_32x32x16_bf16 v[72:87], a[144:147], a[184:187], v[72:87]
    ds_read_b64_tr_b16 a[168:169], v224 offset:18432
    ds_read_b64_tr_b16 a[170:171], v224 offset:19456
    s_add_u32 m0, s30, 126976
    s_add_u32 s5, s38, 479488
    s_add_u32 s34, s39, 479488
    s_cmp_ge_u32 s24, 3
    s_cselect_b32 s5, s34, s5
    buffer_load_dwordx4 v239, s[20:23], s5 offen lds
    buffer_load_dwordx4 v240, s[20:23], s5 offen offset:1024 lds
    v_mfma_f32_32x32x16_bf16 v[88:103], a[148:151], a[184:187], v[88:103]
    ds_read_b64_tr_b16 a[172:173], v227 offset:18432
    ds_read_b64_tr_b16 a[174:175], v227 offset:19456
    s_waitcnt lgkmcnt(8)
    v_mfma_f32_32x32x16_bf16 v[104:119], a[152:155], a[184:187], v[104:119]
    ds_read_b64_tr_b16 a[144:145], v224 offset:8192
    ds_read_b64_tr_b16 a[146:147], v224 offset:9216
    v_mfma_f32_32x32x16_bf16 v[120:135], a[156:159], a[184:187], v[120:135]
    ds_read_b64_tr_b16 a[148:149], v227 offset:8192
    ds_read_b64_tr_b16 a[150:151], v227 offset:9216
    s_waitcnt vmcnt(63)
    s_waitcnt lgkmcnt(8)
    v_mfma_f32_32x32x16_bf16 v[72:87], a[160:163], a[188:191], v[72:87]
    ds_read_b64_tr_b16 a[152:153], v224 offset:20480
    ds_read_b64_tr_b16 a[154:155], v224 offset:21504
    v_mfma_f32_32x32x16_bf16 v[88:103], a[164:167], a[188:191], v[88:103]
    ds_read_b64_tr_b16 a[156:157], v227 offset:20480
    ds_read_b64_tr_b16 a[158:159], v227 offset:21504
    s_waitcnt lgkmcnt(8)
    v_mfma_f32_32x32x16_bf16 v[104:119], a[168:171], a[188:191], v[104:119]
    ds_read_b64_tr_b16 a[160:161], v224 offset:10240
    ds_read_b64_tr_b16 a[162:163], v224 offset:11264
    v_mfma_f32_32x32x16_bf16 v[120:135], a[172:175], a[188:191], v[120:135]
    ds_read_b64_tr_b16 a[164:165], v227 offset:10240
    ds_read_b64_tr_b16 a[166:167], v227 offset:11264
    s_waitcnt vmcnt(63)
    s_waitcnt lgkmcnt(8)
    v_mfma_f32_32x32x16_bf16 v[72:87], a[144:147], a[192:195], v[72:87]
    ds_read_b64_tr_b16 a[168:169], v224 offset:22528
    ds_read_b64_tr_b16 a[170:171], v224 offset:23552
    v_mfma_f32_32x32x16_bf16 v[88:103], a[148:151], a[192:195], v[88:103]
    ds_read_b64_tr_b16 a[172:173], v227 offset:22528
    ds_read_b64_tr_b16 a[174:175], v227 offset:23552
    s_waitcnt lgkmcnt(8)
    v_mfma_f32_32x32x16_bf16 v[104:119], a[152:155], a[192:195], v[104:119]
    ds_read_b64_tr_b16 a[144:145], v224 offset:24576
    ds_read_b64_tr_b16 a[146:147], v224 offset:25600
    v_mfma_f32_32x32x16_bf16 v[120:135], a[156:159], a[192:195], v[120:135]
    ds_read_b64_tr_b16 a[148:149], v227 offset:24576
    ds_read_b64_tr_b16 a[150:151], v227 offset:25600
    s_waitcnt vmcnt(63)
    s_waitcnt lgkmcnt(8)
    v_mfma_f32_32x32x16_bf16 v[72:87], a[160:163], a[196:199], v[72:87]
    ds_read_b64_tr_b16 a[152:153], v224 offset:36864
    ds_read_b64_tr_b16 a[154:155], v224 offset:37888
    buffer_load_dword v249, off, s[16:19], s55 offset:0 sc1
    v_mfma_f32_32x32x16_bf16 v[88:103], a[164:167], a[196:199], v[88:103]
    ds_read_b64_tr_b16 a[156:157], v227 offset:36864
    ds_read_b64_tr_b16 a[158:159], v227 offset:37888
    s_waitcnt lgkmcnt(8)
    v_mfma_f32_32x32x16_bf16 v[104:119], a[168:171], a[196:199], v[104:119]
    ds_read_b64_tr_b16 a[160:161], v224 offset:26624
    ds_read_b64_tr_b16 a[162:163], v224 offset:27648
    v_mfma_f32_32x32x16_bf16 v[120:135], a[172:175], a[196:199], v[120:135]
    ds_read_b64_tr_b16 a[164:165], v227 offset:26624
    ds_read_b64_tr_b16 a[166:167], v227 offset:27648
    s_waitcnt vmcnt(24)
    s_barrier
    s_waitcnt vmcnt(63)
    s_waitcnt lgkmcnt(8)
    v_mfma_f32_32x32x16_bf16 v[72:87], a[144:147], a[200:203], v[72:87]
    ds_read_b64_tr_b16 a[168:169], v224 offset:38912
    ds_read_b64_tr_b16 a[170:171], v224 offset:39936
    s_add_u32 m0, s30, 0
    s_add_u32 s5, s36, 384
    buffer_load_dwordx4 v239, s[20:23], s5 offen lds
    buffer_load_dwordx4 v240, s[20:23], s5 offen offset:1024 lds
    v_mfma_f32_32x32x16_bf16 v[88:103], a[148:151], a[200:203], v[88:103]
    ds_read_b64_tr_b16 a[172:173], v227 offset:38912
    ds_read_b64_tr_b16 a[174:175], v227 offset:39936
    s_waitcnt lgkmcnt(8)
    v_mfma_f32_32x32x16_bf16 v[104:119], a[152:155], a[200:203], v[104:119]
    ds_read_b64_tr_b16 a[144:145], v224 offset:28672
    ds_read_b64_tr_b16 a[146:147], v224 offset:29696
    v_mfma_f32_32x32x16_bf16 v[120:135], a[156:159], a[200:203], v[120:135]
    ds_read_b64_tr_b16 a[148:149], v227 offset:28672
    ds_read_b64_tr_b16 a[150:151], v227 offset:29696
    s_waitcnt vmcnt(63)
    s_waitcnt lgkmcnt(8)
    v_mfma_f32_32x32x16_bf16 v[72:87], a[160:163], a[204:207], v[72:87]
    ds_read_b64_tr_b16 a[152:153], v224 offset:40960
    ds_read_b64_tr_b16 a[154:155], v224 offset:41984
    s_add_u32 m0, s30, 2048
    s_add_u32 s5, s36, 18816
    buffer_load_dwordx4 v239, s[20:23], s5 offen lds
    buffer_load_dwordx4 v240, s[20:23], s5 offen offset:1024 lds
    v_mfma_f32_32x32x16_bf16 v[88:103], a[164:167], a[204:207], v[88:103]
    ds_read_b64_tr_b16 a[156:157], v227 offset:40960
    ds_read_b64_tr_b16 a[158:159], v227 offset:41984
    s_waitcnt lgkmcnt(8)
    v_mfma_f32_32x32x16_bf16 v[104:119], a[168:171], a[204:207], v[104:119]
    ds_read_b64_tr_b16 a[160:161], v224 offset:30720
    ds_read_b64_tr_b16 a[162:163], v224 offset:31744
    v_mfma_f32_32x32x16_bf16 v[120:135], a[172:175], a[204:207], v[120:135]
    ds_read_b64_tr_b16 a[164:165], v227 offset:30720
    ds_read_b64_tr_b16 a[166:167], v227 offset:31744
    s_waitcnt vmcnt(36)
    s_waitcnt lgkmcnt(8)
    v_mfma_f32_32x32x16_bf16 v[72:87], a[144:147], a[208:211], v[72:87]
    ds_read_b64_tr_b16 a[168:169], v224 offset:43008
    ds_read_b64_tr_b16 a[170:171], v224 offset:44032
    s_add_u32 m0, s30, 4096
    s_add_u32 s5, s36, 37248
    buffer_load_dwordx4 v239, s[20:23], s5 offen lds
    buffer_load_dwordx4 v240, s[20:23], s5 offen offset:1024 lds
    v_mfma_f32_32x32x16_bf16 v[88:103], a[148:151], a[208:211], v[88:103]
    ds_read_b64_tr_b16 a[172:173], v227 offset:43008
    ds_read_b64_tr_b16 a[174:175], v227 offset:44032
    s_waitcnt lgkmcnt(8)
    v_mfma_f32_32x32x16_bf16 v[104:119], a[152:155], a[208:211], v[104:119]
    ds_read_b64_tr_b16 a[144:145], v224 offset:32768
    ds_read_b64_tr_b16 a[146:147], v224 offset:33792
    v_mfma_f32_32x32x16_bf16 v[120:135], a[156:159], a[208:211], v[120:135]
    ds_read_b64_tr_b16 a[148:149], v227 offset:32768
    ds_read_b64_tr_b16 a[150:151], v227 offset:33792
    s_waitcnt vmcnt(32)
    s_waitcnt lgkmcnt(8)
    v_mfma_f32_32x32x16_bf16 v[72:87], a[160:163], a[212:215], v[72:87]
    ds_read_b64_tr_b16 a[152:153], v224 offset:45056
    ds_read_b64_tr_b16 a[154:155], v224 offset:46080
    s_waitcnt vmcnt(6)
L_ffn_kernel_pca3:
    v_readfirstlane_b32 s50, v249
    s_sub_u32 s51, s51, 1
    s_cselect_b32 s50, 4, s50
    s_cmp_ge_u32 s50, 4
    s_cbranch_scc1 L_ffn_kernel_pda3
    buffer_load_dword v249, off, s[16:19], s55 offset:0 sc1
    s_waitcnt vmcnt(0)
    s_branch L_ffn_kernel_pca3
L_ffn_kernel_pda3:
    v_mfma_f32_32x32x16_bf16 v[88:103], a[164:167], a[212:215], v[88:103]
    ds_read_b64_tr_b16 a[156:157], v227 offset:45056
    ds_read_b64_tr_b16 a[158:159], v227 offset:46080
    s_add_u32 s31, s53, 12288
    buffer_load_dwordx4 a[224:227], v242, s[16:19], s31 offen sc1
    s_waitcnt lgkmcnt(8)
    v_mfma_f32_32x32x16_bf16 v[104:119], a[168:171], a[212:215], v[104:119]
    ds_read_b64_tr_b16 a[160:161], v224 offset:34816
    ds_read_b64_tr_b16 a[162:163], v224 offset:35840
    v_mfma_f32_32x32x16_bf16 v[120:135], a[172:175], a[212:215], v[120:135]
    ds_read_b64_tr_b16 a[164:165], v227 offset:34816
    ds_read_b64_tr_b16 a[166:167], v227 offset:35840
    s_waitcnt vmcnt(29)
    s_waitcnt lgkmcnt(8)
    v_mfma_f32_32x32x16_bf16 v[72:87], a[144:147], a[216:219], v[72:87]
    ds_read_b64_tr_b16 a[168:169], v224 offset:47104
    ds_read_b64_tr_b16 a[170:171], v224 offset:48128
    v_mfma_f32_32x32x16_bf16 v[88:103], a[148:151], a[216:219], v[88:103]
    ds_read_b64_tr_b16 a[172:173], v227 offset:47104
    ds_read_b64_tr_b16 a[174:175], v227 offset:48128
    s_waitcnt lgkmcnt(8)
    v_mfma_f32_32x32x16_bf16 v[104:119], a[152:155], a[216:219], v[104:119]
    ds_read_b64_tr_b16 a[144:145], v225 offset:0
    ds_read_b64_tr_b16 a[146:147], v225 offset:1024
    s_add_u32 s31, s53, 13312
    buffer_load_dwordx4 a[228:231], v242, s[16:19], s31 offen sc1
    v_mfma_f32_32x32x16_bf16 v[120:135], a[156:159], a[216:219], v[120:135]
    ds_read_b64_tr_b16 a[148:149], v228 offset:0
    ds_read_b64_tr_b16 a[150:151], v228 offset:1024
    s_waitcnt vmcnt(22)
    s_waitcnt lgkmcnt(8)
    v_mfma_f32_32x32x16_bf16 v[72:87], a[160:163], a[220:223], v[72:87]
    ds_read_b64_tr_b16 a[152:153], v225 offset:2048
    ds_read_b64_tr_b16 a[154:155], v225 offset:3072
    v_mfma_f32_32x32x16_bf16 v[88:103], a[164:167], a[220:223], v[88:103]
    ds_read_b64_tr_b16 a[156:157], v228 offset:2048
    ds_read_b64_tr_b16 a[158:159], v228 offset:3072
    s_waitcnt lgkmcnt(8)
    v_mfma_f32_32x32x16_bf16 v[104:119], a[168:171], a[220:223], v[104:119]
    ds_read_b64_tr_b16 a[160:161], v225 offset:4096
    ds_read_b64_tr_b16 a[162:163], v225 offset:5120
    v_mfma_f32_32x32x16_bf16 v[120:135], a[172:175], a[220:223], v[120:135]
    ds_read_b64_tr_b16 a[164:165], v228 offset:4096
    ds_read_b64_tr_b16 a[166:167], v228 offset:5120
    s_add_u32 s31, s53, 14336
    buffer_load_dwordx4 a[232:235], v242, s[16:19], s31 offen sc1
    s_waitcnt vmcnt(25)
    s_barrier
    s_waitcnt lgkmcnt(8)
    v_mfma_f32_32x32x16_bf16 v[8:23], a[144:147], v[136:139], 0
    ds_read_b64_tr_b16 a[168:169], v225 offset:6144
    ds_read_b64_tr_b16 a[170:171], v225 offset:7168
    s_add_u32 m0, s30, 24576
    s_add_u32 s5, s36, 221568
    s_add_u32 s34, s38, 221568
    s_cmp_ge_u32 s24, 2
    s_cselect_b32 s5, s34, s5
    buffer_load_dwordx4 v239, s[20:23], s5 offen lds
    buffer_load_dwordx4 v240, s[20:23], s5 offen offset:1024 lds
    v_mfma_f32_32x32x16_bf16 v[24:39], a[148:151], v[136:139], 0
    ds_read_b64_tr_b16 a[172:173], v228 offset:6144
    ds_read_b64_tr_b16 a[174:175], v228 offset:7168
    s_waitcnt lgkmcnt(8)
    v_mfma_f32_32x32x16_bf16 v[8:23], a[152:155], v[140:143], v[8:23]
    ds_read_b64_tr_b16 a[144:145], v225 offset:8192
    ds_read_b64_tr_b16 a[146:147], v225 offset:9216
    v_mfma_f32_32x32x16_bf16 v[24:39], a[156:159], v[140:143], v[24:39]
    ds_read_b64_tr_b16 a[148:149], v228 offset:8192
    ds_read_b64_tr_b16 a[150:151], v228 offset:9216
    s_waitcnt lgkmcnt(8)
    v_mfma_f32_32x32x16_bf16 v[8:23], a[160:163], v[144:147], v[8:23]
    ds_read_b64_tr_b16 a[152:153], v225 offset:10240
    ds_read_b64_tr_b16 a[154:155], v225 offset:11264
    s_add_u32 s31, s53, 15360
    buffer_load_dwordx4 a[236:239], v242, s[16:19], s31 offen sc1
    s_add_u32 m0, s30, 26624
    s_add_u32 s5, s36, 240000
    s_add_u32 s34, s37, 240000
    s_cmp_ge_u32 s24, 1
    s_cselect_b32 s5, s34, s5
    s_add_u32 s34, s38, 240000
    s_cmp_ge_u32 s24, 2
    s_cselect_b32 s5, s34, s5
    buffer_load_dwordx4 v239, s[20:23], s5 offen lds
    buffer_load_dwordx4 v240, s[20:23], s5 offen offset:1024 lds
    v_mfma_f32_32x32x16_bf16 v[24:39], a[164:167], v[144:147], v[24:39]
    ds_read_b64_tr_b16 a[156:157], v228 offset:10240
    ds_read_b64_tr_b16 a[158:159], v228 offset:11264
    s_waitcnt lgkmcnt(8)
    v_mfma_f32_32x32x16_bf16 v[8:23], a[168:171], v[148:151], v[8:23]
    ds_read_b64_tr_b16 a[160:161], v225 offset:12288
    ds_read_b64_tr_b16 a[162:163], v225 offset:13312
    v_mfma_f32_32x32x16_bf16 v[24:39], a[172:175], v[148:151], v[24:39]
    ds_read_b64_tr_b16 a[164:165], v228 offset:12288
    ds_read_b64_tr_b16 a[166:167], v228 offset:13312
    s_waitcnt lgkmcnt(8)
    v_mfma_f32_32x32x16_bf16 v[8:23], a[144:147], v[152:155], v[8:23]
    ds_read_b64_tr_b16 a[168:169], v225 offset:14336
    ds_read_b64_tr_b16 a[170:171], v225 offset:15360
    s_add_u32 m0, s30, 28672
    s_add_u32 s5, s36, 258432
    s_add_u32 s34, s37, 258432
    s_cmp_ge_u32 s24, 1
    s_cselect_b32 s5, s34, s5
    s_add_u32 s34, s38, 258432
    s_cmp_ge_u32 s24, 2
    s_cselect_b32 s5, s34, s5
    buffer_load_dwordx4 v239, s[20:23], s5 offen lds
    buffer_load_dwordx4 v240, s[20:23], s5 offen offset:1024 lds
    v_mfma_f32_32x32x16_bf16 v[24:39], a[148:151], v[152:155], v[24:39]
    ds_read_b64_tr_b16 a[172:173], v228 offset:14336
    ds_read_b64_tr_b16 a[174:175], v228 offset:15360
    s_add_u32 s31, s53, 16384
    buffer_load_dwordx4 a[240:243], v242, s[16:19], s31 offen sc1
    s_waitcnt lgkmcnt(8)
    v_mfma_f32_32x32x16_bf16 v[8:23], a[152:155], v[156:159], v[8:23]
    ds_read_b64_tr_b16 a[144:145], v225 offset:16384
    ds_read_b64_tr_b16 a[146:147], v225 offset:17408
    v_mfma_f32_32x32x16_bf16 v[24:39], a[156:159], v[156:159], v[24:39]
    ds_read_b64_tr_b16 a[148:149], v228 offset:16384
    ds_read_b64_tr_b16 a[150:151], v228 offset:17408
    s_waitcnt lgkmcnt(8)
    v_mfma_f32_32x32x16_bf16 v[8:23], a[160:163], v[160:163], v[8:23]
    ds_read_b64_tr_b16 a[152:153], v225 offset:18432
    ds_read_b64_tr_b16 a[154:155], v225 offset:19456
    v_mfma_f32_32x32x16_bf16 v[24:39], a[164:167], v[160:163], v[24:39]
    ds_read_b64_tr_b16 a[156:157], v228 offset:18432
    ds_read_b64_tr_b16 a[158:159], v228 offset:19456
    s_waitcnt lgkmcnt(8)
    v_mfma_f32_32x32x16_bf16 v[8:23], a[168:171], v[164:167], v[8:23]
    ds_read_b64_tr_b16 a[160:161], v225 offset:20480
    ds_read_b64_tr_b16 a[162:163], v225 offset:21504
    s_add_u32 s31, s53, 17408
    buffer_load_dwordx4 a[244:247], v242, s[16:19], s31 offen sc1
    v_mfma_f32_32x32x16_bf16 v[24:39], a[172:175], v[164:167], v[24:39]
    ds_read_b64_tr_b16 a[164:165], v228 offset:20480
    ds_read_b64_tr_b16 a[166:167], v228 offset:21504
    s_waitcnt lgkmcnt(8)
    v_mfma_f32_32x32x16_bf16 v[8:23], a[144:147], v[168:171], v[8:23]
    ds_read_b64_tr_b16 a[168:169], v225 offset:22528
    ds_read_b64_tr_b16 a[170:171], v225 offset:23552
    v_mfma_f32_32x32x16_bf16 v[24:39], a[148:151], v[168:171], v[24:39]
    ds_read_b64_tr_b16 a[172:173], v228 offset:22528
    ds_read_b64_tr_b16 a[174:175], v228 offset:23552
    s_waitcnt lgkmcnt(8)
    v_mfma_f32_32x32x16_bf16 v[8:23], a[152:155], v[172:175], v[8:23]
    ds_read_b64_tr_b16 a[144:145], v225 offset:24576
    ds_read_b64_tr_b16 a[146:147], v225 offset:25600
    v_mfma_f32_32x32x16_bf16 v[24:39], a[156:159], v[172:175], v[24:39]
    ds_read_b64_tr_b16 a[148:149], v228 offset:24576
    ds_read_b64_tr_b16 a[150:151], v228 offset:25600
    s_waitcnt lgkmcnt(8)
    v_mfma_f32_32x32x16_bf16 v[8:23], a[160:163], v[176:179], v[8:23]
    ds_read_b64_tr_b16 a[152:153], v225 offset:26624
    ds_read_b64_tr_b16 a[154:155], v225 offset:27648
    v_mfma_f32_32x32x16_bf16 v[24:39], a[164:167], v[176:179], v[24:39]
    ds_read_b64_tr_b16 a[156:157], v228 offset:26624
    ds_read_b64_tr_b16 a[158:159], v228 offset:27648
    s_waitcnt lgkmcnt(8)
    v_mfma_f32_32x32x16_bf16 v[8:23], a[168:171], v[180:183], v[8:23]
    ds_read_b64_tr_b16 a[160:161], v225 offset:28672
    ds_read_b64_tr_b16 a[162:163], v225 offset:29696
    v_mfma_f32_32x32x16_bf16 v[24:39], a[172:175], v[180:183], v[24:39]
    ds_read_b64_tr_b16 a[164:165], v228 offset:28672
    ds_read_b64_tr_b16 a[166:167], v228 offset:29696
    s_waitcnt vmcnt(26)
    s_barrier
    s_waitcnt lgkmcnt(8)
    v_mfma_f32_32x32x16_bf16 v[8:23], a[144:147], v[184:187], v[8:23]
    ds_read_b64_tr_b16 a[168:169], v225 offset:30720
    ds_read_b64_tr_b16 a[170:171], v225 offset:31744
    s_add_u32 m0, s30, 49152
    s_add_u32 s5, s38, 442752
    buffer_load_dwordx4 v239, s[20:23], s5 offen lds
    buffer_load_dwordx4 v240, s[20:23], s5 offen offset:1024 lds
    v_mfma_f32_32x32x16_bf16 v[24:39], a[148:151], v[184:187], v[24:39]
    ds_read_b64_tr_b16 a[172:173], v228 offset:30720
    ds_read_b64_tr_b16 a[174:175], v228 offset:31744
    s_waitcnt lgkmcnt(8)
    v_mfma_f32_32x32x16_bf16 v[8:23], a[152:155], v[188:191], v[8:23]
    ds_read_b64_tr_b16 a[144:145], v225 offset:32768
    ds_read_b64_tr_b16 a[146:147], v225 offset:33792
    v_mfma_f32_32x32x16_bf16 v[24:39], a[156:159], v[188:191], v[24:39]
    ds_read_b64_tr_b16 a[148:149], v228 offset:32768
    ds_read_b64_tr_b16 a[150:151], v228 offset:33792
    s_waitcnt lgkmcnt(8)
    v_mfma_f32_32x32x16_bf16 v[8:23], a[160:163], v[192:195], v[8:23]
    ds_read_b64_tr_b16 a[152:153], v225 offset:34816
    ds_read_b64_tr_b16 a[154:155], v225 offset:35840
    s_add_u32 m0, s30, 51200
    s_add_u32 s5, s38, 461184
    s_add_u32 s34, s39, 461184
    s_cmp_ge_u32 s24, 3
    s_cselect_b32 s5, s34, s5
    buffer_load_dwordx4 v239, s[20:23], s5 offen lds
    buffer_load_dwordx4 v240, s[20:23], s5 offen offset:1024 lds
    v_mfma_f32_32x32x16_bf16 v[24:39], a[164:167], v[192:195], v[24:39]
    ds_read_b64_tr_b16 a[156:157], v228 offset:34816
    ds_read_b64_tr_b16 a[158:159], v228 offset:35840
    s_waitcnt lgkmcnt(8)
    v_mfma_f32_32x32x16_bf16 v[8:23], a[168:171], v[196:199], v[8:23]
    ds_read_b64_tr_b16 a[160:161], v225 offset:36864
    ds_read_b64_tr_b16 a[162:163], v225 offset:37888
    v_mfma_f32_32x32x16_bf16 v[24:39], a[172:175], v[196:199], v[24:39]
    ds_read_b64_tr_b16 a[164:165], v228 offset:36864
    ds_read_b64_tr_b16 a[166:167], v228 offset:37888
    s_waitcnt lgkmcnt(8)
    v_mfma_f32_32x32x16_bf16 v[8:23], a[144:147], v[200:203], v[8:23]
    ds_read_b64_tr_b16 a[168:169], v225 offset:38912
    ds_read_b64_tr_b16 a[170:171], v225 offset:39936
    s_add_u32 m0, s30, 53248
    s_add_u32 s5, s38, 479616
    s_add_u32 s34, s39, 479616
    s_cmp_ge_u32 s24, 3
    s_cselect_b32 s5, s34, s5
    buffer_load_dwordx4 v239, s[20:23], s5 offen lds
    buffer_load_dwordx4 v240, s[20:23], s5 offen offset:1024 lds
    v_mfma_f32_32x32x16_bf16 v[24:39], a[148:151], v[200:203], v[24:39]
    ds_read_b64_tr_b16 a[172:173], v228 offset:38912
    ds_read_b64_tr_b16 a[174:175], v228 offset:39936
    s_waitcnt lgkmcnt(8)
    v_mfma_f32_32x32x16_bf16 v[8:23], a[152:155], v[204:207], v[8:23]
    ds_read_b64_tr_b16 a[144:145], v225 offset:40960
    ds_read_b64_tr_b16 a[146:147], v225 offset:41984
    v_mfma_f32_32x32x16_bf16 v[24:39], a[156:159], v[204:207], v[24:39]
    ds_read_b64_tr_b16 a[148:149], v228 offset:40960
    ds_read_b64_tr_b16 a[150:151], v228 offset:41984
    s_waitcnt lgkmcnt(8)
    v_mfma_f32_32x32x16_bf16 v[8:23], a[160:163], a[176:179], v[8:23]
    ds_read_b64_tr_b16 a[152:153], v225 offset:43008
    ds_read_b64_tr_b16 a[154:155], v225 offset:44032
    v_mfma_f32_32x32x16_bf16 v[24:39], a[164:167], a[176:179], v[24:39]
    ds_read_b64_tr_b16 a[156:157], v228 offset:43008
    ds_read_b64_tr_b16 a[158:159], v228 offset:44032
    s_waitcnt lgkmcnt(8)
    v_mfma_f32_32x32x16_bf16 v[8:23], a[168:171], a[180:183], v[8:23]
    ds_read_b64_tr_b16 a[160:161], v225 offset:45056
    ds_read_b64_tr_b16 a[162:163], v225 offset:46080
    v_mfma_f32_32x32x16_bf16 v[24:39], a[172:175], a[180:183], v[24:39]
    ds_read_b64_tr_b16 a[164:165], v228 offset:45056
    ds_read_b64_tr_b16 a[166:167], v228 offset:46080
    s_waitcnt lgkmcnt(8)
    v_mfma_f32_32x32x16_bf16 v[8:23], a[144:147], a[184:187], v[8:23]
    ds_read_b64_tr_b16 a[168:169], v225 offset:47104
    ds_read_b64_tr_b16 a[170:171], v225 offset:48128
    v_mfma_f32_32x32x16_bf16 v[24:39], a[148:151], a[184:187], v[24:39]
    ds_read_b64_tr_b16 a[172:173], v228 offset:47104
    ds_read_b64_tr_b16 a[174:175], v228 offset:48128
    s_waitcnt lgkmcnt(8)
    v_mfma_f32_32x32x16_bf16 v[8:23], a[152:155], a[188:191], v[8:23]
    ds_read_b64_tr_b16 a[144:145], v226 offset:0
    ds_read_b64_tr_b16 a[146:147], v226 offset:1024
    v_mfma_f32_32x32x16_bf16 v[24:39], a[156:159], a[188:191], v[24:39]
    ds_read_b64_tr_b16 a[148:149], v229 offset:0
    ds_read_b64_tr_b16 a[150:151], v229 offset:1024
    s_waitcnt lgkmcnt(8)
    v_mfma_f32_32x32x16_bf16 v[8:23], a[160:163], a[192:195], v[8:23]
    ds_read_b64_tr_b16 a[152:153], v226 offset:12288
    ds_read_b64_tr_b16 a[154:155], v226 offset:13312
    v_mfma_f32_32x32x16_bf16 v[24:39], a[164:167], a[192:195], v[24:39]
    ds_read_b64_tr_b16 a[156:157], v229 offset:12288
    ds_read_b64_tr_b16 a[158:159], v229 offset:13312
    s_waitcnt lgkmcnt(8)
    v_mfma_f32_32x32x16_bf16 v[8:23], a[168:171], a[196:199], v[8:23]
    ds_read_b64_tr_b16 a[160:161], v226 offset:2048
    ds_read_b64_tr_b16 a[162:163], v226 offset:3072
    v_mfma_f32_32x32x16_bf16 v[24:39], a[172:175], a[196:199], v[24:39]
    ds_read_b64_tr_b16 a[164:165], v229 offset:2048
    ds_read_b64_tr_b16 a[166:167], v229 offset:3072
    s_waitcnt vmcnt(25)
    s_barrier
    s_waitcnt vmcnt(17)
    s_waitcnt lgkmcnt(8)
    v_mfma_f32_32x32x16_bf16 v[72:87], a[144:147], a[224:227], v[72:87]
    ds_read_b64_tr_b16 a[168:169], v226 offset:14336
    ds_read_b64_tr_b16 a[170:171], v226 offset:15360
    s_add_u32 m0, s30, 73728
    s_add_u32 s5, s36, 4294967232
    s_add_u32 s34, s38, 4294967232
    s_cmp_ge_u32 s24, 3
    s_cselect_b32 s5, s34, s5
    buffer_load_dwordx4 v241, s[20:23], s5 offen lds
    v_mfma_f32_32x32x16_bf16 v[88:103], a[148:151], a[224:227], v[88:103]
    ds_read_b64_tr_b16 a[172:173], v229 offset:14336
    ds_read_b64_tr_b16 a[174:175], v229 offset:15360
    s_waitcnt lgkmcnt(8)
    v_mfma_f32_32x32x16_bf16 v[104:119], a[152:155], a[224:227], v[104:119]
    ds_read_b64_tr_b16 a[144:145], v226 offset:4096
    ds_read_b64_tr_b16 a[146:147], v226 offset:5120
    v_mfma_f32_32x32x16_bf16 v[120:135], a[156:159], a[224:227], v[120:135]
    ds_read_b64_tr_b16 a[148:149], v229 offset:4096
    ds_read_b64_tr_b16 a[150:151], v229 offset:5120
    s_add_u32 m0, s30, 74752
    s_add_u32 s5, s36, 18368
    s_add_u32 s34, s38, 18368
    s_cmp_ge_u32 s24, 3
    s_cselect_b32 s5, s34, s5
    buffer_load_dwordx4 v241, s[20:23], s5 offen lds
    s_waitcnt vmcnt(18)
    s_waitcnt lgkmcnt(8)
    v_mfma_f32_32x32x16_bf16 v[72:87], a[160:163], a[228:231], v[72:87]
    ds_read_b64_tr_b16 a[152:153], v226 offset:16384
    ds_read_b64_tr_b16 a[154:155], v226 offset:17408
    v_mfma_f32_32x32x16_bf16 v[88:103], a[164:167], a[228:231], v[88:103]
    ds_read_b64_tr_b16 a[156:157], v229 offset:16384
    ds_read_b64_tr_b16 a[158:159], v229 offset:17408
    s_waitcnt lgkmcnt(8)
    v_mfma_f32_32x32x16_bf16 v[104:119], a[168:171], a[228:231], v[104:119]
    ds_read_b64_tr_b16 a[160:161], v226 offset:6144
    ds_read_b64_tr_b16 a[162:163], v226 offset:7168
    s_add_u32 m0, s30, 75776
    s_add_u32 s5, s36, 36800
    s_add_u32 s34, s38, 36800
    s_cmp_ge_u32 s24, 3
    s_cselect_b32 s5, s34, s5
    buffer_load_dwordx4 v241, s[20:23], s5 offen lds
    v_mfma_f32_32x32x16_bf16 v[120:135], a[172:175], a[228:231], v[120:135]
    ds_read_b64_tr_b16 a[164:165], v229 offset:6144
    ds_read_b64_tr_b16 a[166:167], v229 offset:7168
    s_waitcnt vmcnt(18)
    s_waitcnt lgkmcnt(8)
    v_mfma_f32_32x32x16_bf16 v[72:87], a[144:147], a[232:235], v[72:87]
    ds_read_b64_tr_b16 a[168:169], v226 offset:18432
    ds_read_b64_tr_b16 a[170:171], v226 offset:19456
    v_mfma_f32_32x32x16_bf16 v[88:103], a[148:151], a[232:235], v[88:103]
    ds_read_b64_tr_b16 a[172:173], v229 offset:18432
    ds_read_b64_tr_b16 a[174:175], v229 offset:19456
    s_add_u32 m0, s30, 76800
    s_add_u32 s5, s36, 55232
    s_add_u32 s34, s38, 55232
    s_cmp_ge_u32 s24, 3
    s_cselect_b32 s5, s34, s5
    buffer_load_dwordx4 v241, s[20:23], s5 offen lds
    s_waitcnt lgkmcnt(8)
    v_mfma_f32_32x32x16_bf16 v[104:119], a[152:155], a[232:235], v[104:119]
    ds_read_b64_tr_b16 a[144:145], v226 offset:8192
    ds_read_b64_tr_b16 a[146:147], v226 offset:9216
    v_mfma_f32_32x32x16_bf16 v[120:135], a[156:159], a[232:235], v[120:135]
    ds_read_b64_tr_b16 a[148:149], v229 offset:8192
    ds_read_b64_tr_b16 a[150:151], v229 offset:9216
    s_waitcnt vmcnt(16)
    s_waitcnt lgkmcnt(8)
    v_mfma_f32_32x32x16_bf16 v[72:87], a[160:163], a[236:239], v[72:87]
    ds_read_b64_tr_b16 a[152:153], v226 offset:20480
    ds_read_b64_tr_b16 a[154:155], v226 offset:21504
    s_add_u32 m0, s30, 77824
    s_add_u32 s5, s36, 73664
    s_add_u32 s34, s37, 73664
    s_cmp_ge_u32 s24, 2
    s_cselect_b32 s5, s34, s5
    s_add_u32 s34, s38, 73664
    s_cmp_ge_u32 s24, 3
    s_cselect_b32 s5, s34, s5
    buffer_load_dwordx4 v241, s[20:23], s5 offen lds
    v_mfma_f32_32x32x16_bf16 v[88:103], a[164:167], a[236:239], v[88:103]
    ds_read_b64_tr_b16 a[156:157], v229 offset:20480
    ds_read_b64_tr_b16 a[158:159], v229 offset:21504
    s_waitcnt lgkmcnt(8)
    v_mfma_f32_32x32x16_bf16 v[104:119], a[168:171], a[236:239], v[104:119]
    ds_read_b64_tr_b16 a[160:161], v226 offset:10240
    ds_read_b64_tr_b16 a[162:163], v226 offset:11264
    v_mfma_f32_32x32x16_bf16 v[120:135], a[172:175], a[236:239], v[120:135]
    ds_read_b64_tr_b16 a[164:165], v229 offset:10240
    ds_read_b64_tr_b16 a[166:167], v229 offset:11264
    s_add_u32 m0, s30, 78848
    s_add_u32 s5, s36, 92096
    s_add_u32 s34, s37, 92096
    s_cmp_ge_u32 s24, 2
    s_cselect_b32 s5, s34, s5
    s_add_u32 s34, s38, 92096
    s_cmp_ge_u32 s24, 3
    s_cselect_b32 s5, s34, s5
    buffer_load_dwordx4 v241, s[20:23], s5 offen lds
    s_waitcnt vmcnt(13)
    s_waitcnt lgkmcnt(8)
    v_mfma_f32_32x32x16_bf16 v[72:87], a[144:147], a[240:243], v[72:87]
    ds_read_b64_tr_b16 a[168:169], v226 offset:22528
    ds_read_b64_tr_b16 a[170:171], v226 offset:23552
    v_mfma_f32_32x32x16_bf16 v[88:103], a[148:151], a[240:243], v[88:103]
    ds_read_b64_tr_b16 a[172:173], v229 offset:22528
    ds_read_b64_tr_b16 a[174:175], v229 offset:23552
    s_waitcnt lgkmcnt(8)
    v_mfma_f32_32x32x16_bf16 v[104:119], a[152:155], a[240:243], v[104:119]
    ds_read_b64_tr_b16 a[144:145], v226 offset:24576
    ds_read_b64_tr_b16 a[146:147], v226 offset:25600
    v_mfma_f32_32x32x16_bf16 v[120:135], a[156:159], a[240:243], v[120:135]
    ds_read_b64_tr_b16 a[148:149], v229 offset:24576
    ds_read_b64_tr_b16 a[150:151], v229 offset:25600
    s_waitcnt vmcnt(12)
    s_waitcnt lgkmcnt(8)
    v_mfma_f32_32x32x16_bf16 v[72:87], a[160:163], a[244:247], v[72:87]
    ds_read_b64_tr_b16 a[152:153], v226 offset:26624
    ds_read_b64_tr_b16 a[154:155], v226 offset:27648
    v_mfma_f32_32x32x16_bf16 v[88:103], a[164:167], a[244:247], v[88:103]
    ds_read_b64_tr_b16 a[156:157], v229 offset:26624
    ds_read_b64_tr_b16 a[158:159], v229 offset:27648
    s_waitcnt lgkmcnt(8)
    v_mfma_f32_32x32x16_bf16 v[104:119], a[168:171], a[244:247], v[104:119]
    ds_read_b64_tr_b16 a[160:161], v226 offset:28672
    ds_read_b64_tr_b16 a[162:163], v226 offset:29696
    v_mfma_f32_32x32x16_bf16 v[120:135], a[172:175], a[244:247], v[120:135]
    ds_read_b64_tr_b16 a[164:165], v229 offset:28672
    ds_read_b64_tr_b16 a[166:167], v229 offset:29696
    s_waitcnt vmcnt(24)
    s_barrier
    s_waitcnt lgkmcnt(8)
    v_mfma_f32_32x32x16_bf16 v[8:23], a[144:147], a[200:203], v[8:23]
    ds_read_b64_tr_b16 a[168:169], v226 offset:30720
    ds_read_b64_tr_b16 a[170:171], v226 offset:31744
    s_add_u32 m0, s40, 98304
    s_add_u32 s5, s38, 442304
    s_mul_i32 s34, s24, 55296
    v_subrev_u32 v241, s34, v241
    buffer_load_dwordx4 v241, s[20:23], s5 offen lds
    v_mfma_f32_32x32x16_bf16 v[24:39], a[148:151], a[200:203], v[24:39]
    ds_read_b64_tr_b16 a[172:173], v229 offset:30720
    ds_read_b64_tr_b16 a[174:175], v229 offset:31744
    s_waitcnt lgkmcnt(8)
    v_mfma_f32_32x32x16_bf16 v[8:23], a[152:155], a[204:207], v[8:23]
    ds_read_b64_tr_b16 a[144:145], v226 offset:32768
    ds_read_b64_tr_b16 a[146:147], v226 offset:33792
    v_mfma_f32_32x32x16_bf16 v[24:39], a[156:159], a[204:207], v[24:39]
    ds_read_b64_tr_b16 a[148:149], v229 offset:32768
    ds_read_b64_tr_b16 a[150:151], v229 offset:33792
    s_waitcnt lgkmcnt(8)
    v_mfma_f32_32x32x16_bf16 v[8:23], a[160:163], a[208:211], v[8:23]
    ds_read_b64_tr_b16 a[152:153], v226 offset:34816
    ds_read_b64_tr_b16 a[154:155], v226 offset:35840
    s_add_u32 m0, s40, 99328
    s_add_u32 s5, s38, 460736
    s_add_u32 s34, s39, 460736
    s_cmp_ge_u32 s24, 3
    s_cselect_b32 s5, s34, s5
    buffer_load_dwordx4 v241, s[20:23], s5 offen lds
    v_mfma_f32_32x32x16_bf16 v[24:39], a[164:167], a[208:211], v[24:39]
    ds_read_b64_tr_b16 a[156:157], v229 offset:34816
    ds_read_b64_tr_b16 a[158:159], v229 offset:35840
    v_cvt_pk_bf16_f32 v208, v72, v73
    v_cvt_pk_bf16_f32 v209, v74, v75
    s_waitcnt lgkmcnt(8)
    v_mfma_f32_32x32x16_bf16 v[8:23], a[168:171], a[212:215], v[8:23]
    ds_read_b64_tr_b16 a[160:161], v226 offset:36864
    ds_read_b64_tr_b16 a[162:163], v226 offset:37888
    v_cvt_pk_bf16_f32 v210, v76, v77
    v_cvt_pk_bf16_f32 v211, v78, v79
    v_mfma_f32_32x32x16_bf16 v[24:39], a[172:175], a[212:215], v[24:39]
    ds_read_b64_tr_b16 a[164:165], v229 offset:36864
    ds_read_b64_tr_b16 a[166:167], v229 offset:37888
    s_add_u32 s31, s35, 0
    buffer_store_dwordx4 v[208:211], v242, s[16:19], s31 offen sc1
    v_cvt_pk_bf16_f32 v212, v80, v81
    s_waitcnt lgkmcnt(8)
    v_mfma_f32_32x32x16_bf16 v[8:23], a[144:147], a[216:219], v[8:23]
    ds_read_b64_tr_b16 a[168:169], v226 offset:38912
    ds_read_b64_tr_b16 a[170:171], v226 offset:39936
    v_cvt_pk_bf16_f32 v213, v82, v83
    s_add_u32 m0, s40, 100352
    s_add_u32 s5, s38, 479168
    s_add_u32 s34, s39, 479168
    s_cmp_ge_u32 s24, 3
    s_cselect_b32 s5, s34, s5
    buffer_load_dwordx4 v241, s[20:23], s5 offen lds
    v_mfma_f32_32x32x16_bf16 v[24:39], a[148:151], a[216:219], v[24:39]
    ds_read_b64_tr_b16 a[172:173], v229 offset:38912
    ds_read_b64_tr_b16 a[174:175], v229 offset:39936
    v_cvt_pk_bf16_f32 v214, v84, v85
    v_cvt_pk_bf16_f32 v215, v86, v87
    s_waitcnt lgkmcnt(8)
    v_mfma_f32_32x32x16_bf16 v[8:23], a[152:155], a[220:223], v[8:23]
    ds_read_b64_tr_b16 a[144:145], v226 offset:40960
    ds_read_b64_tr_b16 a[146:147], v226 offset:41984
    s_add_u32 s31, s35, 1024
    buffer_store_dwordx4 v[212:215], v242, s[16:19], s31 offen sc1
    v_cvt_pk_bf16_f32 v216, v88, v89
    v_mfma_f32_32x32x16_bf16 v[24:39], a[156:159], a[220:223], v[24:39]
    ds_read_b64_tr_b16 a[148:149], v229 offset:40960
    ds_read_b64_tr_b16 a[150:151], v229 offset:41984
    v_cvt_pk_bf16_f32 v217, v90, v91
    v_cvt_pk_bf16_f32 v218, v92, v93
    s_waitcnt lgkmcnt(8)
    v_mfma_f32_32x32x16_bf16 v[8:23], a[160:163], a[224:227], v[8:23]
    ds_read_b64_tr_b16 a[152:153], v226 offset:43008
    ds_read_b64_tr_b16 a[154:155], v226 offset:44032
    v_cvt_pk_bf16_f32 v219, v94, v95
    v_mfma_f32_32x32x16_bf16 v[24:39], a[164:167], a[224:227], v[24:39]
    ds_read_b64_tr_b16 a[156:157], v229 offset:43008
    ds_read_b64_tr_b16 a[158:159], v229 offset:44032
    s_add_u32 s31, s35, 2048
    buffer_store_dwordx4 v[216:219], v242, s[16:19], s31 offen sc1
    v_cvt_pk_bf16_f32 v220, v96, v97
    s_waitcnt lgkmcnt(8)
    v_mfma_f32_32x32x16_bf16 v[8:23], a[168:171], a[228:231], v[8:23]
    ds_read_b64_tr_b16 a[160:161], v226 offset:45056
    ds_read_b64_tr_b16 a[162:163], v226 offset:46080
    v_cvt_pk_bf16_f32 v221, v98, v99
    v_cvt_pk_bf16_f32 v222, v100, v101
    v_mfma_f32_32x32x16_bf16 v[24:39], a[172:175], a[228:231], v[24:39]
    ds_read_b64_tr_b16 a[164:165], v229 offset:45056
    ds_read_b64_tr_b16 a[166:167], v229 offset:46080
    v_cvt_pk_bf16_f32 v223, v102, v103
    s_add_u32 s31, s35, 3072
    buffer_store_dwordx4 v[220:223], v242, s[16:19], s31 offen sc1
    s_waitcnt lgkmcnt(8)
    v_mfma_f32_32x32x16_bf16 v[8:23], a[144:147], a[232:235], v[8:23]
    ds_read_b64_tr_b16 a[168:169], v226 offset:47104
    ds_read_b64_tr_b16 a[170:171], v226 offset:48128
    v_cvt_pk_bf16_f32 v208, v104, v105
    v_mfma_f32_32x32x16_bf16 v[24:39], a[148:151], a[232:235], v[24:39]
    ds_read_b64_tr_b16 a[172:173], v229 offset:47104
    ds_read_b64_tr_b16 a[174:175], v229 offset:48128
    v_cvt_pk_bf16_f32 v209, v106, v107
    v_cvt_pk_bf16_f32 v210, v108, v109
    s_waitcnt lgkmcnt(8)
    v_mfma_f32_32x32x16_bf16 v[8:23], a[152:155], a[236:239], v[8:23]
    ds_read_b64_tr_b16 a[144:145], v224 offset:0
    ds_read_b64_tr_b16 a[146:147], v224 offset:1024
    v_cvt_pk_bf16_f32 v211, v110, v111
    s_add_u32 s31, s35, 4096
    buffer_store_dwordx4 v[208:211], v242, s[16:19], s31 offen sc1
    v_mfma_f32_32x32x16_bf16 v[24:39], a[156:159], a[236:239], v[24:39]
    ds_read_b64_tr_b16 a[148:149], v227 offset:0
    ds_read_b64_tr_b16 a[150:151], v227 offset:1024
    v_cvt_pk_bf16_f32 v212, v112, v113
    v_cvt_pk_bf16_f32 v213, v114, v115
    s_waitcnt lgkmcnt(8)
    v_mfma_f32_32x32x16_bf16 v[8:23], a[160:163], a[240:243], v[8:23]
    ds_read_b64_tr_b16 a[152:153], v224 offset:2048
    ds_read_b64_tr_b16 a[154:155], v224 offset:3072
    v_cvt_pk_bf16_f32 v214, v116, v117
    v_mfma_f32_32x32x16_bf16 v[24:39], a[164:167], a[240:243], v[24:39]
    ds_read_b64_tr_b16 a[156:157], v227 offset:2048
    ds_read_b64_tr_b16 a[158:159], v227 offset:3072
    v_cvt_pk_bf16_f32 v215, v118, v119
    s_add_u32 s31, s35, 5120
    buffer_store_dwordx4 v[212:215], v242, s[16:19], s31 offen sc1
    s_waitcnt lgkmcnt(8)
    v_mfma_f32_32x32x16_bf16 v[8:23], a[168:171], a[244:247], v[8:23]
    ds_read_b64_tr_b16 a[160:161], v224 offset:4096
    ds_read_b64_tr_b16 a[162:163], v224 offset:5120
    v_cvt_pk_bf16_f32 v216, v120, v121
    v_cvt_pk_bf16_f32 v217, v122, v123
    v_mfma_f32_32x32x16_bf16 v[24:39], a[172:175], a[244:247], v[24:39]
    ds_read_b64_tr_b16 a[164:165], v227 offset:4096
    ds_read_b64_tr_b16 a[166:167], v227 offset:5120
    v_cvt_pk_bf16_f32 v218, v124, v125
    v_cvt_pk_bf16_f32 v219, v126, v127
    s_waitcnt vmcnt(23)
    s_barrier
    s_waitcnt lgkmcnt(8)
    v_mfma_f32_32x32x16_bf16 v[40:55], a[144:147], v[136:139], 0
    ds_read_b64_tr_b16 a[168:169], v224 offset:6144
    ds_read_b64_tr_b16 a[170:171], v224 offset:7168
    s_add_u32 s31, s35, 6144
    buffer_store_dwordx4 v[216:219], v242, s[16:19], s31 offen sc1
    v_mfma_f32_32x32x16_bf16 v[56:71], a[148:151], v[136:139], 0
    ds_read_b64_tr_b16 a[172:173], v227 offset:6144
    ds_read_b64_tr_b16 a[174:175], v227 offset:7168
    v_cvt_pk_bf16_f32 v220, v128, v129
    v_cvt_pk_bf16_f32 v221, v130, v131
    s_waitcnt lgkmcnt(8)
    v_mfma_f32_32x32x16_bf16 v[40:55], a[152:155], v[140:143], v[40:55]
    ds_read_b64_tr_b16 a[144:145], v224 offset:8192
    ds_read_b64_tr_b16 a[146:147], v224 offset:9216
    v_cvt_pk_bf16_f32 v222, v132, v133
    v_cvt_pk_bf16_f32 v223, v134, v135
    v_mfma_f32_32x32x16_bf16 v[56:71], a[156:159], v[140:143], v[56:71]
    ds_read_b64_tr_b16 a[148:149], v227 offset:8192
    ds_read_b64_tr_b16 a[150:151], v227 offset:9216
    s_add_u32 s31, s35, 7168
    buffer_store_dwordx4 v[220:223], v242, s[16:19], s31 offen sc1
    s_waitcnt lgkmcnt(8)
    v_mfma_f32_32x32x16_bf16 v[40:55], a[160:163], v[144:147], v[40:55]
    ds_read_b64_tr_b16 a[152:153], v224 offset:10240
    ds_read_b64_tr_b16 a[154:155], v224 offset:11264
    v_mfma_f32_32x32x16_bf16 v[56:71], a[164:167], v[144:147], v[56:71]
    ds_read_b64_tr_b16 a[156:157], v227 offset:10240
    ds_read_b64_tr_b16 a[158:159], v227 offset:11264
    s_waitcnt lgkmcnt(8)
    v_mfma_f32_32x32x16_bf16 v[40:55], a[168:171], v[148:151], v[40:55]
    ds_read_b64_tr_b16 a[160:161], v224 offset:12288
    ds_read_b64_tr_b16 a[162:163], v224 offset:13312
    v_cvt_pk_bf16_f32 v208, v8, v9
    v_cvt_pk_bf16_f32 v209, v10, v11
    v_mfma_f32_32x32x16_bf16 v[56:71], a[172:175], v[148:151], v[56:71]
    ds_read_b64_tr_b16 a[164:165], v227 offset:12288
    ds_read_b64_tr_b16 a[166:167], v227 offset:13312
    v_cvt_pk_bf16_f32 v210, v12, v13
    s_waitcnt lgkmcnt(8)
    v_mfma_f32_32x32x16_bf16 v[40:55], a[144:147], v[152:155], v[40:55]
    ds_read_b64_tr_b16 a[168:169], v224 offset:14336
    ds_read_b64_tr_b16 a[170:171], v224 offset:15360
    v_cvt_pk_bf16_f32 v211, v14, v15
    s_add_u32 s31, s35, 8192
    buffer_store_dwordx4 v[208:211], v242, s[16:19], s31 offen sc1
    v_mfma_f32_32x32x16_bf16 v[56:71], a[148:151], v[152:155], v[56:71]
    ds_read_b64_tr_b16 a[172:173], v227 offset:14336
    ds_read_b64_tr_b16 a[174:175], v227 offset:15360
    v_cvt_pk_bf16_f32 v212, v16, v17
    s_waitcnt lgkmcnt(8)
    v_mfma_f32_32x32x16_bf16 v[40:55], a[152:155], v[156:159], v[40:55]
    ds_read_b64_tr_b16 a[144:145], v224 offset:16384
    ds_read_b64_tr_b16 a[146:147], v224 offset:17408
    v_cvt_pk_bf16_f32 v213, v18, v19
    v_cvt_pk_bf16_f32 v214, v20, v21
    v_mfma_f32_32x32x16_bf16 v[56:71], a[156:159], v[156:159], v[56:71]
    ds_read_b64_tr_b16 a[148:149], v227 offset:16384
    ds_read_b64_tr_b16 a[150:151], v227 offset:17408
    v_cvt_pk_bf16_f32 v215, v22, v23
    s_waitcnt lgkmcnt(8)
    v_mfma_f32_32x32x16_bf16 v[40:55], a[160:163], v[160:163], v[40:55]
    ds_read_b64_tr_b16 a[152:153], v224 offset:18432
    ds_read_b64_tr_b16 a[154:155], v224 offset:19456
    s_add_u32 s31, s35, 9216
    buffer_store_dwordx4 v[212:215], v242, s[16:19], s31 offen sc1
    v_mfma_f32_32x32x16_bf16 v[56:71], a[164:167], v[160:163], v[56:71]
    ds_read_b64_tr_b16 a[156:157], v227 offset:18432
    ds_read_b64_tr_b16 a[158:159], v227 offset:19456
    v_cvt_pk_bf16_f32 v216, v24, v25
    v_cvt_pk_bf16_f32 v217, v26, v27
    s_waitcnt lgkmcnt(8)
    v_mfma_f32_32x32x16_bf16 v[40:55], a[168:171], v[164:167], v[40:55]
    ds_read_b64_tr_b16 a[160:161], v224 offset:20480
    ds_read_b64_tr_b16 a[162:163], v224 offset:21504
    v_cvt_pk_bf16_f32 v218, v28, v29
    v_mfma_f32_32x32x16_bf16 v[56:71], a[172:175], v[164:167], v[56:71]
    ds_read_b64_tr_b16 a[164:165], v227 offset:20480
    ds_read_b64_tr_b16 a[166:167], v227 offset:21504
    v_cvt_pk_bf16_f32 v219, v30, v31
    s_add_u32 s31, s35, 10240
    buffer_store_dwordx4 v[216:219], v242, s[16:19], s31 offen sc1
    s_waitcnt lgkmcnt(8)
    v_mfma_f32_32x32x16_bf16 v[40:55], a[144:147], v[168:171], v[40:55]
    ds_read_b64_tr_b16 a[168:169], v224 offset:22528
    ds_read_b64_tr_b16 a[170:171], v224 offset:23552
    v_cvt_pk_bf16_f32 v220, v32, v33
    v_mfma_f32_32x32x16_bf16 v[56:71], a[148:151], v[168:171], v[56:71]
    ds_read_b64_tr_b16 a[172:173], v227 offset:22528
    ds_read_b64_tr_b16 a[174:175], v227 offset:23552
    v_cvt_pk_bf16_f32 v221, v34, v35
    v_cvt_pk_bf16_f32 v222, v36, v37
    s_waitcnt lgkmcnt(8)
    v_mfma_f32_32x32x16_bf16 v[40:55], a[152:155], v[172:175], v[40:55]
    ds_read_b64_tr_b16 a[144:145], v224 offset:24576
    ds_read_b64_tr_b16 a[146:147], v224 offset:25600
    v_cvt_pk_bf16_f32 v223, v38, v39
    v_mfma_f32_32x32x16_bf16 v[56:71], a[156:159], v[172:175], v[56:71]
    ds_read_b64_tr_b16 a[148:149], v227 offset:24576
    ds_read_b64_tr_b16 a[150:151], v227 offset:25600
    s_add_u32 s31, s35, 11264
    buffer_store_dwordx4 v[220:223], v242, s[16:19], s31 offen sc1
    s_waitcnt lgkmcnt(8)
    v_mfma_f32_32x32x16_bf16 v[40:55], a[160:163], v[176:179], v[40:55]
    ds_read_b64_tr_b16 a[152:153], v224 offset:26624
    ds_read_b64_tr_b16 a[154:155], v224 offset:27648
    v_mfma_f32_32x32x16_bf16 v[56:71], a[164:167], v[176:179], v[56:71]
    ds_read_b64_tr_b16 a[156:157], v227 offset:26624
    ds_read_b64_tr_b16 a[158:159], v227 offset:27648
    s_waitcnt lgkmcnt(8)
    v_mfma_f32_32x32x16_bf16 v[40:55], a[168:171], v[180:183], v[40:55]
    ds_read_b64_tr_b16 a[160:161], v224 offset:28672
    ds_read_b64_tr_b16 a[162:163], v224 offset:29696
    v_mfma_f32_32x32x16_bf16 v[56:71], a[172:175], v[180:183], v[56:71]
    ds_read_b64_tr_b16 a[164:165], v227 offset:28672
    ds_read_b64_tr_b16 a[166:167], v227 offset:29696
    s_waitcnt vmcnt(21)
    s_barrier
    s_waitcnt lgkmcnt(8)
    v_mfma_f32_32x32x16_bf16 v[40:55], a[144:147], v[184:187], v[40:55]
    ds_read_b64_tr_b16 a[168:169], v224 offset:30720
    ds_read_b64_tr_b16 a[170:171], v224 offset:31744
    s_and_b32 s34, s26, 3
    s_lshl_b32 s57, s25, 2
    s_add_u32 s34, s34, s57
    s_lshr_b32 s58, s26, 3
    s_mul_i32 s58, s58, 10
    s_bfe_u32 s57, s26, 0x10002
    s_lshl_b32 s57, s57, 1
    s_add_u32 s58, s58, s57
    s_mul_i32 s56, s34, 36864
    s_lshl_b32 s57, s58, 11
    s_add_u32 s56, s56, s57
    s_lshl_b32 s57, s24, 10
    s_add_u32 s56, s56, s57
    s_lshl_b32 s58, s58, 6
    s_lshl_b32 s57, s24, 5
    s_add_u32 s58, s58, s57
    s_mul_i32 s57, s34, 36864
    s_add_u32 s58, s58, s57
    s_lshl_b32 s57, s34, 7
    s_add_u32 s57, s57, 4857856
    v_mfma_f32_32x32x16_bf16 v[56:71], a[148:151], v[184:187], v[56:71]
    ds_read_b64_tr_b16 a[172:173], v227 offset:30720
    ds_read_b64_tr_b16 a[174:175], v227 offset:31744
    s_waitcnt lgkmcnt(8)
    v_mfma_f32_32x32x16_bf16 v[40:55], a[152:155], v[188:191], v[40:55]
    ds_read_b64_tr_b16 a[144:145], v224 offset:32768
    ds_read_b64_tr_b16 a[146:147], v224 offset:33792
    buffer_load_dword v108, v248, s[16:19], s57 offen sc1
    v_mfma_f32_32x32x16_bf16 v[56:71], a[156:159], v[188:191], v[56:71]
    ds_read_b64_tr_b16 a[148:149], v227 offset:32768
    ds_read_b64_tr_b16 a[150:151], v227 offset:33792
    s_waitcnt lgkmcnt(8)
    v_mfma_f32_32x32x16_bf16 v[40:55], a[160:163], v[192:195], v[40:55]
    ds_read_b64_tr_b16 a[152:153], v224 offset:34816
    ds_read_b64_tr_b16 a[154:155], v224 offset:35840
    s_add_u32 s33, s56, 5767168
    buffer_load_dwordx4 v[104:107], v242, s[16:19], s33 offen sc1
    v_mfma_f32_32x32x16_bf16 v[56:71], a[164:167], v[192:195], v[56:71]
    ds_read_b64_tr_b16 a[156:157], v227 offset:34816
    ds_read_b64_tr_b16 a[158:159], v227 offset:35840
    s_waitcnt lgkmcnt(8)
    v_mfma_f32_32x32x16_bf16 v[40:55], a[168:171], v[196:199], v[40:55]
    ds_read_b64_tr_b16 a[160:161], v224 offset:36864
    ds_read_b64_tr_b16 a[162:163], v224 offset:37888
    v_mfma_f32_32x32x16_bf16 v[56:71], a[172:175], v[196:199], v[56:71]
    ds_read_b64_tr_b16 a[164:165], v227 offset:36864
    ds_read_b64_tr_b16 a[166:167], v227 offset:37888
    s_waitcnt lgkmcnt(8)
    v_mfma_f32_32x32x16_bf16 v[40:55], a[144:147], v[200:203], v[40:55]
    ds_read_b64_tr_b16 a[168:169], v224 offset:38912
    ds_read_b64_tr_b16 a[170:171], v224 offset:39936
    s_and_b32 s34, s26, 3
    s_lshl_b32 s60, s25, 2
    s_add_u32 s34, s34, s60
    s_bfe_u32 s61, s26, 0x10002
    s_mul_i32 s61, s61, 10
    s_add_u32 s61, s61, 4
    s_mul_i32 s59, s34, 36864
    s_lshl_b32 s60, s61, 11
    s_add_u32 s59, s59, s60
    s_lshl_b32 s60, s24, 10
    s_add_u32 s59, s59, s60
    s_lshl_b32 s61, s61, 6
    s_lshl_b32 s60, s24, 5
    s_add_u32 s61, s61, s60
    s_mul_i32 s60, s34, 36864
    s_add_u32 s61, s61, s60
    s_lshl_b32 s60, s34, 7
    s_add_u32 s60, s60, 4857856
    s_cmp_ge_u32 s26, 8
    s_cselect_b32 s59, s59, 1073741824
    s_cselect_b32 s61, s61, 1073741824
    v_mfma_f32_32x32x16_bf16 v[56:71], a[148:151], v[200:203], v[56:71]
    ds_read_b64_tr_b16 a[172:173], v227 offset:38912
    ds_read_b64_tr_b16 a[174:175], v227 offset:39936
    s_waitcnt lgkmcnt(8)
    v_mfma_f32_32x32x16_bf16 v[40:55], a[152:155], v[204:207], v[40:55]
    ds_read_b64_tr_b16 a[144:145], v224 offset:40960
    ds_read_b64_tr_b16 a[146:147], v224 offset:41984
    v_mfma_f32_32x32x16_bf16 v[56:71], a[156:159], v[204:207], v[56:71]
    ds_read_b64_tr_b16 a[148:149], v227 offset:40960
    ds_read_b64_tr_b16 a[150:151], v227 offset:41984
    s_waitcnt lgkmcnt(8)
    v_mfma_f32_32x32x16_bf16 v[40:55], a[160:163], a[176:179], v[40:55]
    ds_read_b64_tr_b16 a[152:153], v224 offset:43008
    ds_read_b64_tr_b16 a[154:155], v224 offset:44032
    s_and_b32 s34, s26, 3
    s_lshl_b32 s37, s25, 2
    s_add_u32 s34, s34, s37
    s_bfe_u32 s38, s26, 0x10002
    s_mul_i32 s38, s38, 10
    s_add_u32 s38, s38, 6
    s_cmp_lt_u32 s26, 8
    s_cselect_b32 s38, s38, 8
    s_mul_i32 s36, s34, 36864
    s_lshl_b32 s37, s38, 11
    s_add_u32 s36, s36, s37
    s_lshl_b32 s37, s24, 10
    s_add_u32 s36, s36, s37
    s_lshl_b32 s38, s38, 6
    s_lshl_b32 s37, s24, 5
    s_add_u32 s38, s38, s37
    s_mul_i32 s37, s34, 36864
    s_add_u32 s38, s38, s37
    s_lshl_b32 s37, s34, 7
    s_add_u32 s37, s37, 4857856
    v_mfma_f32_32x32x16_bf16 v[56:71], a[164:167], a[176:179], v[56:71]
    ds_read_b64_tr_b16 a[156:157], v227 offset:43008
    ds_read_b64_tr_b16 a[158:159], v227 offset:44032
    s_waitcnt lgkmcnt(8)
    v_mfma_f32_32x32x16_bf16 v[40:55], a[168:171], a[180:183], v[40:55]
    ds_read_b64_tr_b16 a[160:161], v224 offset:45056
    ds_read_b64_tr_b16 a[162:163], v224 offset:46080
    v_mfma_f32_32x32x16_bf16 v[56:71], a[172:175], a[180:183], v[56:71]
    ds_read_b64_tr_b16 a[164:165], v227 offset:45056
    ds_read_b64_tr_b16 a[166:167], v227 offset:46080
    s_waitcnt lgkmcnt(8)
    v_mfma_f32_32x32x16_bf16 v[40:55], a[144:147], a[184:187], v[40:55]
    ds_read_b64_tr_b16 a[168:169], v224 offset:47104
    ds_read_b64_tr_b16 a[170:171], v224 offset:48128
    v_mfma_f32_32x32x16_bf16 v[56:71], a[148:151], a[184:187], v[56:71]
    ds_read_b64_tr_b16 a[172:173], v227 offset:47104
    ds_read_b64_tr_b16 a[174:175], v227 offset:48128
    s_waitcnt lgkmcnt(8)
    v_mfma_f32_32x32x16_bf16 v[40:55], a[152:155], a[188:191], v[40:55]
    ds_read_b64_tr_b16 a[144:145], v225 offset:0
    ds_read_b64_tr_b16 a[146:147], v225 offset:1024
    v_mfma_f32_32x32x16_bf16 v[56:71], a[156:159], a[188:191], v[56:71]
    ds_read_b64_tr_b16 a[148:149], v228 offset:0
    ds_read_b64_tr_b16 a[150:151], v228 offset:1024
    s_waitcnt lgkmcnt(8)
    v_mfma_f32_32x32x16_bf16 v[40:55], a[160:163], a[192:195], v[40:55]
    ds_read_b64_tr_b16 a[152:153], v225 offset:2048
    ds_read_b64_tr_b16 a[154:155], v225 offset:3072
    v_mfma_f32_32x32x16_bf16 v[56:71], a[164:167], a[192:195], v[56:71]
    ds_read_b64_tr_b16 a[156:157], v228 offset:2048
    ds_read_b64_tr_b16 a[158:159], v228 offset:3072
    s_waitcnt lgkmcnt(8)
    v_mfma_f32_32x32x16_bf16 v[40:55], a[168:171], a[196:199], v[40:55]
    ds_read_b64_tr_b16 a[160:161], v225 offset:4096
    ds_read_b64_tr_b16 a[162:163], v225 offset:5120
    v_mfma_f32_32x32x16_bf16 v[56:71], a[172:175], a[196:199], v[56:71]
    ds_read_b64_tr_b16 a[164:165], v228 offset:4096
    ds_read_b64_tr_b16 a[166:167], v228 offset:5120
    s_waitcnt vmcnt(2)
    s_barrier
    buffer_atomic_add v7, v246, s[16:19], s49 offen offset:0 sc1
    s_waitcnt lgkmcnt(8)
    v_mfma_f32_32x32x16_bf16 v[40:55], a[144:147], a[200:203], v[40:55]
    ds_read_b64_tr_b16 a[168:169], v225 offset:6144
    ds_read_b64_tr_b16 a[170:171], v225 offset:7168
    v_mfma_f32_32x32x16_bf16 v[56:71], a[148:151], a[200:203], v[56:71]
    ds_read_b64_tr_b16 a[172:173], v228 offset:6144
    ds_read_b64_tr_b16 a[174:175], v228 offset:7168
    s_waitcnt lgkmcnt(8)
    v_mfma_f32_32x32x16_bf16 v[40:55], a[152:155], a[204:207], v[40:55]
    ds_read_b64_tr_b16 a[144:145], v225 offset:8192
    ds_read_b64_tr_b16 a[146:147], v225 offset:9216
    v_mfma_f32_32x32x16_bf16 v[56:71], a[156:159], a[204:207], v[56:71]
    ds_read_b64_tr_b16 a[148:149], v228 offset:8192
    ds_read_b64_tr_b16 a[150:151], v228 offset:9216
    s_waitcnt lgkmcnt(8)
    v_mfma_f32_32x32x16_bf16 v[40:55], a[160:163], a[208:211], v[40:55]
    ds_read_b64_tr_b16 a[152:153], v225 offset:10240
    ds_read_b64_tr_b16 a[154:155], v225 offset:11264
    v_mfma_f32_32x32x16_bf16 v[56:71], a[164:167], a[208:211], v[56:71]
    ds_read_b64_tr_b16 a[156:157], v228 offset:10240
    ds_read_b64_tr_b16 a[158:159], v228 offset:11264
    s_waitcnt lgkmcnt(8)
    v_mfma_f32_32x32x16_bf16 v[40:55], a[168:171], a[212:215], v[40:55]
    ds_read_b64_tr_b16 a[160:161], v225 offset:12288
    ds_read_b64_tr_b16 a[162:163], v225 offset:13312
    v_mfma_f32_32x32x16_bf16 v[56:71], a[172:175], a[212:215], v[56:71]
    ds_read_b64_tr_b16 a[164:165], v228 offset:12288
    ds_read_b64_tr_b16 a[166:167], v228 offset:13312
    s_waitcnt lgkmcnt(8)
    v_mfma_f32_32x32x16_bf16 v[40:55], a[144:147], a[216:219], v[40:55]
    ds_read_b64_tr_b16 a[168:169], v225 offset:14336
    ds_read_b64_tr_b16 a[170:171], v225 offset:15360
    v_mfma_f32_32x32x16_bf16 v[56:71], a[148:151], a[216:219], v[56:71]
    ds_read_b64_tr_b16 a[172:173], v228 offset:14336
    ds_read_b64_tr_b16 a[174:175], v228 offset:15360
    s_waitcnt lgkmcnt(8)
    v_mfma_f32_32x32x16_bf16 v[40:55], a[152:155], a[220:223], v[40:55]
    ds_read_b64_tr_b16 a[144:145], v225 offset:16384
    ds_read_b64_tr_b16 a[146:147], v225 offset:17408
    v_mfma_f32_32x32x16_bf16 v[56:71], a[156:159], a[220:223], v[56:71]
    ds_read_b64_tr_b16 a[148:149], v228 offset:16384
    ds_read_b64_tr_b16 a[150:151], v228 offset:17408
    s_waitcnt lgkmcnt(8)
    v_mfma_f32_32x32x16_bf16 v[40:55], a[160:163], a[224:227], v[40:55]
    ds_read_b64_tr_b16 a[152:153], v225 offset:18432
    ds_read_b64_tr_b16 a[154:155], v225 offset:19456
    v_mfma_f32_32x32x16_bf16 v[56:71], a[164:167], a[224:227], v[56:71]
    ds_read_b64_tr_b16 a[156:157], v228 offset:18432
    ds_read_b64_tr_b16 a[158:159], v228 offset:19456
    s_waitcnt lgkmcnt(8)
    v_mfma_f32_32x32x16_bf16 v[40:55], a[168:171], a[228:231], v[40:55]
    ds_read_b64_tr_b16 a[160:161], v225 offset:20480
    ds_read_b64_tr_b16 a[162:163], v225 offset:21504
    v_mfma_f32_32x32x16_bf16 v[56:71], a[172:175], a[228:231], v[56:71]
    ds_read_b64_tr_b16 a[164:165], v228 offset:20480
    ds_read_b64_tr_b16 a[166:167], v228 offset:21504
    s_waitcnt lgkmcnt(8)
    v_mfma_f32_32x32x16_bf16 v[40:55], a[144:147], a[232:235], v[40:55]
    ds_read_b64_tr_b16 a[168:169], v225 offset:22528
    ds_read_b64_tr_b16 a[170:171], v225 offset:23552
    v_mfma_f32_32x32x16_bf16 v[56:71], a[148:151], a[232:235], v[56:71]
    ds_read_b64_tr_b16 a[172:173], v228 offset:22528
    ds_read_b64_tr_b16 a[174:175], v228 offset:23552
    s_waitcnt lgkmcnt(8)
    v_mfma_f32_32x32x16_bf16 v[40:55], a[152:155], a[236:239], v[40:55]
    ds_read_b64_tr_b16 a[144:145], v231 offset:24576
    ds_read_b64_tr_b16 a[146:147], v231 offset:25088
    v_mfma_f32_32x32x16_bf16 v[56:71], a[156:159], a[236:239], v[56:71]
    ds_read_b64_tr_b16 a[148:149], v231 offset:25600
    ds_read_b64_tr_b16 a[150:151], v231 offset:26112
    s_waitcnt lgkmcnt(8)
    v_mfma_f32_32x32x16_bf16 v[40:55], a[160:163], a[240:243], v[40:55]
    ds_read_b64_tr_b16 a[152:153], v231 offset:26624
    ds_read_b64_tr_b16 a[154:155], v231 offset:27136
    v_mfma_f32_32x32x16_bf16 v[56:71], a[164:167], a[240:243], v[56:71]
    ds_read_b64_tr_b16 a[156:157], v231 offset:27648
    ds_read_b64_tr_b16 a[158:159], v231 offset:28160
    s_waitcnt lgkmcnt(8)
    v_mfma_f32_32x32x16_bf16 v[40:55], a[168:171], a[244:247], v[40:55]
    ds_read_b64_tr_b16 a[160:161], v231 offset:28672
    ds_read_b64_tr_b16 a[162:163], v231 offset:29184
    buffer_load_dword v249, off, s[16:19], s48 offset:0 sc1
    v_mfma_f32_32x32x16_bf16 v[56:71], a[172:175], a[244:247], v[56:71]
    ds_read_b64_tr_b16 a[164:165], v231 offset:29696
    ds_read_b64_tr_b16 a[166:167], v231 offset:30208
    s_waitcnt vmcnt(15)
    s_barrier
    s_waitcnt lgkmcnt(8)
    v_mfma_f32_32x32x16_bf16 v[8:23], a[144:147], v[136:139], 0
    ds_read_b64_tr_b16 a[168:169], v231 offset:30720
    ds_read_b64_tr_b16 a[170:171], v231 offset:31232
    v_mfma_f32_32x32x16_bf16 v[8:23], a[148:151], v[140:143], v[8:23]
    ds_read_b64_tr_b16 a[172:173], v231 offset:31744
    ds_read_b64_tr_b16 a[174:175], v231 offset:32256
    s_waitcnt lgkmcnt(8)
    v_mfma_f32_32x32x16_bf16 v[8:23], a[152:155], v[144:147], v[8:23]
    ds_read_b64_tr_b16 a[144:145], v231 offset:32768
    ds_read_b64_tr_b16 a[146:147], v231 offset:33280
    v_mfma_f32_32x32x16_bf16 v[8:23], a[156:159], v[148:151], v[8:23]
    ds_read_b64_tr_b16 a[148:149], v231 offset:33792
    ds_read_b64_tr_b16 a[150:151], v231 offset:34304
    s_waitcnt lgkmcnt(8)
    v_mfma_f32_32x32x16_bf16 v[8:23], a[160:163], v[152:155], v[8:23]
    ds_read_b64_tr_b16 a[152:153], v231 offset:34816
    ds_read_b64_tr_b16 a[154:155], v231 offset:35328
    v_mfma_f32_32x32x16_bf16 v[8:23], a[164:167], v[156:159], v[8:23]
    ds_read_b64_tr_b16 a[156:157], v231 offset:35840
    ds_read_b64_tr_b16 a[158:159], v231 offset:36352
    v_cvt_pk_bf16_f32 v208, v40, v41
    v_cvt_pk_bf16_f32 v209, v42, v43
    s_waitcnt lgkmcnt(8)
    v_mfma_f32_32x32x16_bf16 v[8:23], a[168:171], v[160:163], v[8:23]
    ds_read_b64_tr_b16 a[160:161], v231 offset:36864
    ds_read_b64_tr_b16 a[162:163], v231 offset:37376
    v_cvt_pk_bf16_f32 v210, v44, v45
    v_cvt_pk_bf16_f32 v211, v46, v47
    v_mfma_f32_32x32x16_bf16 v[8:23], a[172:175], v[164:167], v[8:23]
    ds_read_b64_tr_b16 a[164:165], v231 offset:37888
    ds_read_b64_tr_b16 a[166:167], v231 offset:38400
    s_add_u32 s31, s35, 12288
    buffer_store_dwordx4 v[208:211], v242, s[16:19], s31 offen sc1
    s_waitcnt lgkmcnt(8)
    v_mfma_f32_32x32x16_bf16 v[8:23], a[144:147], v[168:171], v[8:23]
    ds_read_b64_tr_b16 a[168:169], v231 offset:38912
    ds_read_b64_tr_b16 a[170:171], v231 offset:39424
    v_cvt_pk_bf16_f32 v212, v48, v49
    v_cvt_pk_bf16_f32 v213, v50, v51
    v_mfma_f32_32x32x16_bf16 v[8:23], a[148:151], v[172:175], v[8:23]
    ds_read_b64_tr_b16 a[172:173], v231 offset:39936
    ds_read_b64_tr_b16 a[174:175], v231 offset:40448
    v_cvt_pk_bf16_f32 v214, v52, v53
    s_waitcnt lgkmcnt(8)
    v_mfma_f32_32x32x16_bf16 v[8:23], a[152:155], v[176:179], v[8:23]
    ds_read_b64_tr_b16 a[144:145], v231 offset:40960
    ds_read_b64_tr_b16 a[146:147], v231 offset:41472
    v_cvt_pk_bf16_f32 v215, v54, v55
    s_add_u32 s31, s35, 13312
    buffer_store_dwordx4 v[212:215], v242, s[16:19], s31 offen sc1
    v_mfma_f32_32x32x16_bf16 v[8:23], a[156:159], v[180:183], v[8:23]
    ds_read_b64_tr_b16 a[148:149], v231 offset:41984
    ds_read_b64_tr_b16 a[150:151], v231 offset:42496
    v_cvt_pk_bf16_f32 v216, v56, v57
    s_waitcnt lgkmcnt(8)
    v_mfma_f32_32x32x16_bf16 v[8:23], a[160:163], v[184:187], v[8:23]
    ds_read_b64_tr_b16 a[152:153], v231 offset:43008
    ds_read_b64_tr_b16 a[154:155], v231 offset:43520
    v_cvt_pk_bf16_f32 v217, v58, v59
    v_cvt_pk_bf16_f32 v218, v60, v61
    s_waitcnt vmcnt(2)
L_ffn_kernel_pcg0:
    v_readfirstlane_b32 s50, v249
    s_sub_u32 s51, s51, 1
    s_cselect_b32 s50, 16, s50
    s_cmp_ge_u32 s50, 16
    s_cbranch_scc1 L_ffn_kernel_pdg0
    buffer_load_dword v249, off, s[16:19], s48 offset:0 sc1
    s_waitcnt vmcnt(0)
    s_branch L_ffn_kernel_pcg0
L_ffn_kernel_pdg0:
    v_mfma_f32_32x32x16_bf16 v[8:23], a[164:167], v[188:191], v[8:23]
    ds_read_b64_tr_b16 a[156:157], v231 offset:44032
    ds_read_b64_tr_b16 a[158:159], v231 offset:44544
    v_cvt_pk_bf16_f32 v219, v62, v63
    s_add_u32 s33, s56, 8126464
    buffer_load_dwordx4 v[72:75], v242, s[16:19], s33 offen sc1
    s_waitcnt lgkmcnt(8)
    v_mfma_f32_32x32x16_bf16 v[8:23], a[168:171], v[192:195], v[8:23]
    ds_read_b64_tr_b16 a[160:161], v231 offset:45056
    ds_read_b64_tr_b16 a[162:163], v231 offset:45568
    s_add_u32 s31, s35, 14336
    buffer_store_dwordx4 v[216:219], v242, s[16:19], s31 offen sc1
    v_cvt_pk_bf16_f32 v220, v64, v65
    s_add_u32 s33, s56, 10485760
    buffer_load_dwordx4 v[76:79], v242, s[16:19], s33 offen sc1
    v_mfma_f32_32x32x16_bf16 v[8:23], a[172:175], v[196:199], v[8:23]
    ds_read_b64_tr_b16 a[164:165], v231 offset:46080
    ds_read_b64_tr_b16 a[166:167], v231 offset:46592
    v_cvt_pk_bf16_f32 v221, v66, v67
    s_add_u32 s33, s56, 12845056
    buffer_load_dwordx4 v[80:83], v242, s[16:19], s33 offen sc1
    s_waitcnt lgkmcnt(8)
    v_mfma_f32_32x32x16_bf16 v[8:23], a[144:147], v[200:203], v[8:23]
    ds_read_b64_tr_b16 a[168:169], v231 offset:47104
    ds_read_b64_tr_b16 a[170:171], v231 offset:47616
    v_cvt_pk_bf16_f32 v222, v68, v69
    v_cvt_pk_bf16_f32 v223, v70, v71
    s_add_u32 s33, s56, 15204352
    buffer_load_dwordx4 v[84:87], v242, s[16:19], s33 offen sc1
    v_mfma_f32_32x32x16_bf16 v[8:23], a[148:151], v[204:207], v[8:23]
    ds_read_b64_tr_b16 a[172:173], v231 offset:48128
    ds_read_b64_tr_b16 a[174:175], v231 offset:48640
    s_add_u32 s31, s35, 15360
    buffer_store_dwordx4 v[220:223], v242, s[16:19], s31 offen sc1
    s_add_u32 s33, s56, 17563648
    buffer_load_dwordx4 v[88:91], v242, s[16:19], s33 offen sc1
    s_waitcnt lgkmcnt(8)
    v_mfma_f32_32x32x16_bf16 v[8:23], a[152:155], a[176:179], v[8:23]
    ds_read_b64_tr_b16 a[144:145], v232 offset:0
    ds_read_b64_tr_b16 a[146:147], v232 offset:512
    s_add_u32 s33, s56, 19922944
    buffer_load_dwordx4 v[92:95], v242, s[16:19], s33 offen sc1
    v_mfma_f32_32x32x16_bf16 v[8:23], a[156:159], a[180:183], v[8:23]
    ds_read_b64_tr_b16 a[148:149], v232 offset:1024
    ds_read_b64_tr_b16 a[150:151], v232 offset:1536
    s_add_u32 s33, s56, 22282240
    buffer_load_dwordx4 v[96:99], v242, s[16:19], s33 offen sc1
    s_waitcnt lgkmcnt(8)
    v_mfma_f32_32x32x16_bf16 v[8:23], a[160:163], a[184:187], v[8:23]
    ds_read_b64_tr_b16 a[152:153], v232 offset:2048
    ds_read_b64_tr_b16 a[154:155], v232 offset:2560
    s_add_u32 s33, s56, 24641536
    buffer_load_dwordx4 v[100:103], v242, s[16:19], s33 offen sc1
    v_mfma_f32_32x32x16_bf16 v[8:23], a[164:167], a[188:191], v[8:23]
    ds_read_b64_tr_b16 a[156:157], v232 offset:3072
    ds_read_b64_tr_b16 a[158:159], v232 offset:3584
    s_waitcnt lgkmcnt(8)
    v_mfma_f32_32x32x16_bf16 v[8:23], a[168:171], a[192:195], v[8:23]
    ds_read_b64_tr_b16 a[160:161], v232 offset:4096
    ds_read_b64_tr_b16 a[162:163], v232 offset:4608
    buffer_load_dword v60, v248, s[16:19], s60 offen sc1
    v_mfma_f32_32x32x16_bf16 v[8:23], a[172:175], a[196:199], v[8:23]
    ds_read_b64_tr_b16 a[164:165], v232 offset:5120
    ds_read_b64_tr_b16 a[166:167], v232 offset:5632
    s_add_u32 s33, s59, 5767168
    buffer_load_dwordx4 v[56:59], v242, s[16:19], s33 offen sc1
    s_waitcnt lgkmcnt(8)
    v_mfma_f32_32x32x16_bf16 v[8:23], a[144:147], a[200:203], v[8:23]
    ds_read_b64_tr_b16 a[168:169], v232 offset:6144
    ds_read_b64_tr_b16 a[170:171], v232 offset:6656
    s_add_u32 s33, s59, 8126464
    buffer_load_dwordx4 v[24:27], v242, s[16:19], s33 offen sc1
    v_mfma_f32_32x32x16_bf16 v[8:23], a[148:151], a[204:207], v[8:23]
    ds_read_b64_tr_b16 a[172:173], v232 offset:7168
    ds_read_b64_tr_b16 a[174:175], v232 offset:7680
    s_add_u32 s33, s59, 10485760
    buffer_load_dwordx4 v[28:31], v242, s[16:19], s33 offen sc1
    s_waitcnt lgkmcnt(8)
    v_mfma_f32_32x32x16_bf16 v[8:23], a[152:155], a[208:211], v[8:23]
    ds_read_b64_tr_b16 a[144:145], v232 offset:8192
    ds_read_b64_tr_b16 a[146:147], v232 offset:8704
    s_add_u32 s33, s59, 12845056
    buffer_load_dwordx4 v[32:35], v242, s[16:19], s33 offen sc1
    v_mfma_f32_32x32x16_bf16 v[8:23], a[156:159], a[212:215], v[8:23]
    ds_read_b64_tr_b16 a[148:149], v232 offset:9216
    ds_read_b64_tr_b16 a[150:151], v232 offset:9728
    s_waitcnt lgkmcnt(8)
    v_mfma_f32_32x32x16_bf16 v[8:23], a[160:163], a[216:219], v[8:23]
    ds_read_b64_tr_b16 a[152:153], v232 offset:10240
    ds_read_b64_tr_b16 a[154:155], v232 offset:10752
    s_add_u32 s33, s59, 15204352
    buffer_load_dwordx4 v[36:39], v242, s[16:19], s33 offen sc1
    v_mfma_f32_32x32x16_bf16 v[8:23], a[164:167], a[220:223], v[8:23]
    ds_read_b64_tr_b16 a[156:157], v232 offset:11264
    ds_read_b64_tr_b16 a[158:159], v232 offset:11776
    s_add_u32 s33, s59, 17563648
    buffer_load_dwordx4 v[40:43], v242, s[16:19], s33 offen sc1
    s_waitcnt lgkmcnt(8)
    v_mfma_f32_32x32x16_bf16 v[8:23], a[168:171], a[224:227], v[8:23]
    s_add_u32 s33, s59, 19922944
    buffer_load_dwordx4 v[44:47], v242, s[16:19], s33 offen sc1
    v_mfma_f32_32x32x16_bf16 v[8:23], a[172:175], a[228:231], v[8:23]
    s_add_u32 s33, s59, 22282240
    buffer_load_dwordx4 v[48:51], v242, s[16:19], s33 offen sc1
    s_waitcnt lgkmcnt(4)
    v_mfma_f32_32x32x16_bf16 v[8:23], a[144:147], a[232:235], v[8:23]
    s_add_u32 s33, s59, 24641536
    buffer_load_dwordx4 v[52:55], v242, s[16:19], s33 offen sc1
    v_mfma_f32_32x32x16_bf16 v[8:23], a[148:151], a[236:239], v[8:23]
    s_waitcnt lgkmcnt(0)
    v_mfma_f32_32x32x16_bf16 v[8:23], a[152:155], a[240:243], v[8:23]
    v_mfma_f32_32x32x16_bf16 v[8:23], a[156:159], a[244:247], v[8:23]
    s_nop 7
    s_nop 7
    v_cvt_pk_bf16_f32 v208, v8, v9
    v_cvt_pk_bf16_f32 v209, v10, v11
    v_cvt_pk_bf16_f32 v210, v12, v13
    v_cvt_pk_bf16_f32 v211, v14, v15
    s_lshl_b32 s31, s3, 5
    s_add_u32 s31, s31, s35
    s_add_u32 s31, s31, 0
    buffer_store_dwordx4 v[208:211], v242, s[16:19], s31 offen sc1
    v_cvt_pk_bf16_f32 v212, v16, v17
    v_cvt_pk_bf16_f32 v213, v18, v19
    v_cvt_pk_bf16_f32 v214, v20, v21
    v_cvt_pk_bf16_f32 v215, v22, v23
    s_lshl_b32 s31, s3, 5
    s_add_u32 s31, s31, s35
    s_add_u32 s31, s31, 1024
    buffer_store_dwordx4 v[212:215], v242, s[16:19], s31 offen sc1
    buffer_load_dword v172, v248, s[16:19], s37 offen sc1
    s_add_u32 s33, s36, 5767168
    buffer_load_dwordx4 v[168:171], v242, s[16:19], s33 offen sc1
    s_waitcnt vmcnt(28)
    v_lshlrev_b32 v2, 16, v104
    v_and_b32 v3, 0xffff0000, v104
    v_add_f32 v112, v108, v2
    v_add_f32 v113, v108, v3
    v_lshlrev_b32 v4, 16, v105
    v_and_b32 v5, 0xffff0000, v105
    v_add_f32 v114, v108, v4
    v_add_f32 v115, v108, v5
    v_lshlrev_b32 v2, 16, v106
    v_and_b32 v3, 0xffff0000, v106
    v_add_f32 v116, v108, v2
    v_add_f32 v117, v108, v3
    v_lshlrev_b32 v4, 16, v107
    v_and_b32 v5, 0xffff0000, v107
    v_add_f32 v118, v108, v4
    v_add_f32 v119, v108, v5
    s_waitcnt vmcnt(23)
    v_lshlrev_b32 v2, 16, v72
    v_and_b32 v3, 0xffff0000, v72
    v_add_f32 v112, v112, v2
    v_add_f32 v113, v113, v3
    v_lshlrev_b32 v4, 16, v73
    v_and_b32 v5, 0xffff0000, v73
    v_add_f32 v114, v114, v4
    v_add_f32 v115, v115, v5
    v_lshlrev_b32 v2, 16, v74
    v_and_b32 v3, 0xffff0000, v74
    v_add_f32 v116, v116, v2
    v_add_f32 v117, v117, v3
    v_lshlrev_b32 v4, 16, v75
    v_and_b32 v5, 0xffff0000, v75
    v_add_f32 v118, v118, v4
    v_add_f32 v119, v119, v5
    s_waitcnt vmcnt(21)
    v_lshlrev_b32 v2, 16, v76
    v_and_b32 v3, 0xffff0000, v76
    v_add_f32 v112, v112, v2
    v_add_f32 v113, v113, v3
    v_lshlrev_b32 v4, 16, v77
    v_and_b32 v5, 0xffff0000, v77
    v_add_f32 v114, v114, v4
    v_add_f32 v115, v115, v5
    v_lshlrev_b32 v2, 16, v78
    v_and_b32 v3, 0xffff0000, v78
    v_add_f32 v116, v116, v2
    v_add_f32 v117, v117, v3
    v_lshlrev_b32 v4, 16, v79
    v_and_b32 v5, 0xffff0000, v79
    v_add_f32 v118, v118, v4
    v_add_f32 v119, v119, v5
    s_waitcnt vmcnt(20)
    v_lshlrev_b32 v2, 16, v80
    v_and_b32 v3, 0xffff0000, v80
    v_add_f32 v112, v112, v2
    v_add_f32 v113, v113, v3
    v_lshlrev_b32 v4, 16, v81
    v_and_b32 v5, 0xffff0000, v81
    v_add_f32 v114, v114, v4
    v_add_f32 v115, v115, v5
    v_lshlrev_b32 v2, 16, v82
    v_and_b32 v3, 0xffff0000, v82
    v_add_f32 v116, v116, v2
    v_add_f32 v117, v117, v3
    v_lshlrev_b32 v4, 16, v83
    v_and_b32 v5, 0xffff0000, v83
    v_add_f32 v118, v118, v4
    v_add_f32 v119, v119, v5
    s_waitcnt vmcnt(19)
    v_lshlrev_b32 v2, 16, v84
    v_and_b32 v3, 0xffff0000, v84
    v_add_f32 v112, v112, v2
    v_add_f32 v113, v113, v3
    v_lshlrev_b32 v4, 16, v85
    v_and_b32 v5, 0xffff0000, v85
    v_add_f32 v114, v114, v4
    v_add_f32 v115, v115, v5
    v_lshlrev_b32 v2, 16, v86
    v_and_b32 v3, 0xffff0000, v86
    v_add_f32 v116, v116, v2
    v_add_f32 v117, v117, v3
    v_lshlrev_b32 v4, 16, v87
    v_and_b32 v5, 0xffff0000, v87
    v_add_f32 v118, v118, v4
    v_add_f32 v119, v119, v5
    s_waitcnt vmcnt(17)
    v_lshlrev_b32 v2, 16, v88
    v_and_b32 v3, 0xffff0000, v88
    v_add_f32 v112, v112, v2
    v_add_f32 v113, v113, v3
    v_lshlrev_b32 v4, 16, v89
    v_and_b32 v5, 0xffff0000, v89
    v_add_f32 v114, v114, v4
    v_add_f32 v115, v115, v5
    v_lshlrev_b32 v2, 16, v90
    v_and_b32 v3, 0xffff0000, v90
    v_add_f32 v116, v116, v2
    v_add_f32 v117, v117, v3
    v_lshlrev_b32 v4, 16, v91
    v_and_b32 v5, 0xffff0000, v91
    v_add_f32 v118, v118, v4
    v_add_f32 v119, v119, v5
    s_waitcnt vmcnt(16)
    v_lshlrev_b32 v2, 16, v92
    v_and_b32 v3, 0xffff0000, v92
    v_add_f32 v112, v112, v2
    v_add_f32 v113, v113, v3
    v_lshlrev_b32 v4, 16, v93
    v_and_b32 v5, 0xffff0000, v93
    v_add_f32 v114, v114, v4
    v_add_f32 v115, v115, v5
    v_lshlrev_b32 v2, 16, v94
    v_and_b32 v3, 0xffff0000, v94
    v_add_f32 v116, v116, v2
    v_add_f32 v117, v117, v3
    v_lshlrev_b32 v4, 16, v95
    v_and_b32 v5, 0xffff0000, v95
    v_add_f32 v118, v118, v4
    v_add_f32 v119, v119, v5
    s_waitcnt vmcnt(15)
    v_lshlrev_b32 v2, 16, v96
    v_and_b32 v3, 0xffff0000, v96
    v_add_f32 v112, v112, v2
    v_add_f32 v113, v113, v3
    v_lshlrev_b32 v4, 16, v97
    v_and_b32 v5, 0xffff0000, v97
    v_add_f32 v114, v114, v4
    v_add_f32 v115, v115, v5
    v_lshlrev_b32 v2, 16, v98
    v_and_b32 v3, 0xffff0000, v98
    v_add_f32 v116, v116, v2
    v_add_f32 v117, v117, v3
    v_lshlrev_b32 v4, 16, v99
    v_and_b32 v5, 0xffff0000, v99
    v_add_f32 v118, v118, v4
    v_add_f32 v119, v119, v5
    s_waitcnt vmcnt(14)
    v_lshlrev_b32 v2, 16, v100
    v_and_b32 v3, 0xffff0000, v100
    v_add_f32 v112, v112, v2
    v_add_f32 v113, v113, v3
    v_lshlrev_b32 v4, 16, v101
    v_and_b32 v5, 0xffff0000, v101
    v_add_f32 v114, v114, v4
    v_add_f32 v115, v115, v5
    v_lshlrev_b32 v2, 16, v102
    v_and_b32 v3, 0xffff0000, v102
    v_add_f32 v116, v116, v2
    v_add_f32 v117, v117, v3
    v_lshlrev_b32 v4, 16, v103
    v_and_b32 v5, 0xffff0000, v103
    v_add_f32 v118, v118, v4
    v_add_f32 v119, v119, v5
    v_cvt_pk_bf16_f32 v104, v112, v113
    v_cvt_pk_bf16_f32 v105, v114, v115
    v_cvt_pk_bf16_f32 v106, v116, v117
    v_cvt_pk_bf16_f32 v107, v118, v119
    s_nop 1
    v_permlane32_swap_b32 v104, v106
    v_permlane32_swap_b32 v105, v107
    s_nop 1
    buffer_store_dwordx4 v[104:107], v247, s[44:47], s58 offen
    s_waitcnt vmcnt(3)
    s_barrier
    buffer_atomic_add v7, v246, s[16:19], s49 offen offset:128 sc1
    s_cmp_lt_u32 s26, 8
    s_cbranch_scc1 L_ffn_kernel_t2
    s_waitcnt vmcnt(14)
    v_lshlrev_b32 v2, 16, v56
    v_and_b32 v3, 0xffff0000, v56
    v_add_f32 v64, v60, v2
    v_add_f32 v65, v60, v3
    v_lshlrev_b32 v4, 16, v57
    v_and_b32 v5, 0xffff0000, v57
    v_add_f32 v66, v60, v4
    v_add_f32 v67, v60, v5
    v_lshlrev_b32 v2, 16, v58
    v_and_b32 v3, 0xffff0000, v58
    v_add_f32 v68, v60, v2
    v_add_f32 v69, v60, v3
    v_lshlrev_b32 v4, 16, v59
    v_and_b32 v5, 0xffff0000, v59
    v_add_f32 v70, v60, v4
    v_add_f32 v71, v60, v5
    s_waitcnt vmcnt(13)
    v_lshlrev_b32 v2, 16, v24
    v_and_b32 v3, 0xffff0000, v24
    v_add_f32 v64, v64, v2
    v_add_f32 v65, v65, v3
    v_lshlrev_b32 v4, 16, v25
    v_and_b32 v5, 0xffff0000, v25
    v_add_f32 v66, v66, v4
    v_add_f32 v67, v67, v5
    v_lshlrev_b32 v2, 16, v26
    v_and_b32 v3, 0xffff0000, v26
    v_add_f32 v68, v68, v2
    v_add_f32 v69, v69, v3
    v_lshlrev_b32 v4, 16, v27
    v_and_b32 v5, 0xffff0000, v27
    v_add_f32 v70, v70, v4
    v_add_f32 v71, v71, v5
    s_waitcnt vmcnt(12)
    v_lshlrev_b32 v2, 16, v28
    v_and_b32 v3, 0xffff0000, v28
    v_add_f32 v64, v64, v2
    v_add_f32 v65, v65, v3
    v_lshlrev_b32 v4, 16, v29
    v_and_b32 v5, 0xffff0000, v29
    v_add_f32 v66, v66, v4
    v_add_f32 v67, v67, v5
    v_lshlrev_b32 v2, 16, v30
    v_and_b32 v3, 0xffff0000, v30
    v_add_f32 v68, v68, v2
    v_add_f32 v69, v69, v3
    v_lshlrev_b32 v4, 16, v31
    v_and_b32 v5, 0xffff0000, v31
    v_add_f32 v70, v70, v4
    v_add_f32 v71, v71, v5
    s_waitcnt vmcnt(11)
    v_lshlrev_b32 v2, 16, v32
    v_and_b32 v3, 0xffff0000, v32
    v_add_f32 v64, v64, v2
    v_add_f32 v65, v65, v3
    v_lshlrev_b32 v4, 16, v33
    v_and_b32 v5, 0xffff0000, v33
    v_add_f32 v66, v66, v4
    v_add_f32 v67, v67, v5
    v_lshlrev_b32 v2, 16, v34
    v_and_b32 v3, 0xffff0000, v34
    v_add_f32 v68, v68, v2
    v_add_f32 v69, v69, v3
    v_lshlrev_b32 v4, 16, v35
    v_and_b32 v5, 0xffff0000, v35
    v_add_f32 v70, v70, v4
    v_add_f32 v71, v71, v5
    s_waitcnt vmcnt(10)
    v_lshlrev_b32 v2, 16, v36
    v_and_b32 v3, 0xffff0000, v36
    v_add_f32 v64, v64, v2
    v_add_f32 v65, v65, v3
    v_lshlrev_b32 v4, 16, v37
    v_and_b32 v5, 0xffff0000, v37
    v_add_f32 v66, v66, v4
    v_add_f32 v67, v67, v5
    v_lshlrev_b32 v2, 16, v38
    v_and_b32 v3, 0xffff0000, v38
    v_add_f32 v68, v68, v2
    v_add_f32 v69, v69, v3
    v_lshlrev_b32 v4, 16, v39
    v_and_b32 v5, 0xffff0000, v39
    v_add_f32 v70, v70, v4
    v_add_f32 v71, v71, v5
    s_waitcnt vmcnt(9)
    v_lshlrev_b32 v2, 16, v40
    v_and_b32 v3, 0xffff0000, v40
    v_add_f32 v64, v64, v2
    v_add_f32 v65, v65, v3
    v_lshlrev_b32 v4, 16, v41
    v_and_b32 v5, 0xffff0000, v41
    v_add_f32 v66, v66, v4
    v_add_f32 v67, v67, v5
    v_lshlrev_b32 v2, 16, v42
    v_and_b32 v3, 0xffff0000, v42
    v_add_f32 v68, v68, v2
    v_add_f32 v69, v69, v3
    v_lshlrev_b32 v4, 16, v43
    v_and_b32 v5, 0xffff0000, v43
    v_add_f32 v70, v70, v4
    v_add_f32 v71, v71, v5
    s_waitcnt vmcnt(8)
    v_lshlrev_b32 v2, 16, v44
    v_and_b32 v3, 0xffff0000, v44
    v_add_f32 v64, v64, v2
    v_add_f32 v65, v65, v3
    v_lshlrev_b32 v4, 16, v45
    v_and_b32 v5, 0xffff0000, v45
    v_add_f32 v66, v66, v4
    v_add_f32 v67, v67, v5
    v_lshlrev_b32 v2, 16, v46
    v_and_b32 v3, 0xffff0000, v46
    v_add_f32 v68, v68, v2
    v_add_f32 v69, v69, v3
    v_lshlrev_b32 v4, 16, v47
    v_and_b32 v5, 0xffff0000, v47
    v_add_f32 v70, v70, v4
    v_add_f32 v71, v71, v5
    s_waitcnt vmcnt(7)
    v_lshlrev_b32 v2, 16, v48
    v_and_b32 v3, 0xffff0000, v48
    v_add_f32 v64, v64, v2
    v_add_f32 v65, v65, v3
    v_lshlrev_b32 v4, 16, v49
    v_and_b32 v5, 0xffff0000, v49
    v_add_f32 v66, v66, v4
    v_add_f32 v67, v67, v5
    v_lshlrev_b32 v2, 16, v50
    v_and_b32 v3, 0xffff0000, v50
    v_add_f32 v68, v68, v2
    v_add_f32 v69, v69, v3
    v_lshlrev_b32 v4, 16, v51
    v_and_b32 v5, 0xffff0000, v51
    v_add_f32 v70, v70, v4
    v_add_f32 v71, v71, v5
    s_waitcnt vmcnt(6)
    v_lshlrev_b32 v2, 16, v52
    v_and_b32 v3, 0xffff0000, v52
    v_add_f32 v64, v64, v2
    v_add_f32 v65, v65, v3
    v_lshlrev_b32 v4, 16, v53
    v_and_b32 v5, 0xffff0000, v53
    v_add_f32 v66, v66, v4
    v_add_f32 v67, v67, v5
    v_lshlrev_b32 v2, 16, v54
    v_and_b32 v3, 0xffff0000, v54
    v_add_f32 v68, v68, v2
    v_add_f32 v69, v69, v3
    v_lshlrev_b32 v4, 16, v55
    v_and_b32 v5, 0xffff0000, v55
    v_add_f32 v70, v70, v4
    v_add_f32 v71, v71, v5
    v_cvt_pk_bf16_f32 v56, v64, v65
    v_cvt_pk_bf16_f32 v57, v66, v67
    v_cvt_pk_bf16_f32 v58, v68, v69
    v_cvt_pk_bf16_f32 v59, v70, v71
    s_nop 1
    v_permlane32_swap_b32 v56, v58
    v_permlane32_swap_b32 v57, v59
    s_nop 1
    buffer_store_dwordx4 v[56:59], v247, s[44:47], s61 offen
    s_cmp_ge_u32 s26, 12
    s_cbranch_scc1 L_ffn_kernel_fin
L_ffn_kernel_t2:
    buffer_load_dword v249, off, s[16:19], s48 offset:128 sc1
    s_waitcnt vmcnt(0)
L_ffn_kernel_pcg1:
    v_readfirstlane_b32 s50, v249
    s_sub_u32 s51, s51, 1
    s_cselect_b32 s50, 16, s50
    s_cmp_ge_u32 s50, 16
    s_cbranch_scc1 L_ffn_kernel_pdg1
    buffer_load_dword v249, off, s[16:19], s48 offset:128 sc1
    s_waitcnt vmcnt(0)
    s_branch L_ffn_kernel_pcg1
L_ffn_kernel_pdg1:
    s_add_u32 s33, s36, 8126464
    buffer_load_dwordx4 v[136:139], v242, s[16:19], s33 offen sc1
    s_add_u32 s33, s36, 10485760
    buffer_load_dwordx4 v[140:143], v242, s[16:19], s33 offen sc1
    s_add_u32 s33, s36, 12845056
    buffer_load_dwordx4 v[144:147], v242, s[16:19], s33 offen sc1
    s_add_u32 s33, s36, 15204352
    buffer_load_dwordx4 v[148:151], v242, s[16:19], s33 offen sc1
    s_add_u32 s33, s36, 17563648
    buffer_load_dwordx4 v[152:155], v242, s[16:19], s33 offen sc1
    s_add_u32 s33, s36, 19922944
    buffer_load_dwordx4 v[156:159], v242, s[16:19], s33 offen sc1
    s_add_u32 s33, s36, 22282240
    buffer_load_dwordx4 v[160:163], v242, s[16:19], s33 offen sc1
    s_add_u32 s33, s36, 24641536
    buffer_load_dwordx4 v[164:167], v242, s[16:19], s33 offen sc1
    s_waitcnt vmcnt(12)
    v_lshlrev_b32 v2, 16, v168
    v_and_b32 v3, 0xffff0000, v168
    v_add_f32 v176, v172, v2
    v_add_f32 v177, v172, v3
    v_lshlrev_b32 v4, 16, v169
    v_and_b32 v5, 0xffff0000, v169
    v_add_f32 v178, v172, v4
    v_add_f32 v179, v172, v5
    v_lshlrev_b32 v2, 16, v170
    v_and_b32 v3, 0xffff0000, v170
    v_add_f32 v180, v172, v2
    v_add_f32 v181, v172, v3
    v_lshlrev_b32 v4, 16, v171
    v_and_b32 v5, 0xffff0000, v171
    v_add_f32 v182, v172, v4
    v_add_f32 v183, v172, v5
    s_waitcnt vmcnt(7)
    v_lshlrev_b32 v2, 16, v136
    v_and_b32 v3, 0xffff0000, v136
    v_add_f32 v176, v176, v2
    v_add_f32 v177, v177, v3
    v_lshlrev_b32 v4, 16, v137
    v_and_b32 v5, 0xffff0000, v137
    v_add_f32 v178, v178, v4
    v_add_f32 v179, v179, v5
    v_lshlrev_b32 v2, 16, v138
    v_and_b32 v3, 0xffff0000, v138
    v_add_f32 v180, v180, v2
    v_add_f32 v181, v181, v3
    v_lshlrev_b32 v4, 16, v139
    v_and_b32 v5, 0xffff0000, v139
    v_add_f32 v182, v182, v4
    v_add_f32 v183, v183, v5
    s_waitcnt vmcnt(6)
    v_lshlrev_b32 v2, 16, v140
    v_and_b32 v3, 0xffff0000, v140
    v_add_f32 v176, v176, v2
    v_add_f32 v177, v177, v3
    v_lshlrev_b32 v4, 16, v141
    v_and_b32 v5, 0xffff0000, v141
    v_add_f32 v178, v178, v4
    v_add_f32 v179, v179, v5
    v_lshlrev_b32 v2, 16, v142
    v_and_b32 v3, 0xffff0000, v142
    v_add_f32 v180, v180, v2
    v_add_f32 v181, v181, v3
    v_lshlrev_b32 v4, 16, v143
    v_and_b32 v5, 0xffff0000, v143
    v_add_f32 v182, v182, v4
    v_add_f32 v183, v183, v5
    s_waitcnt vmcnt(5)
    v_lshlrev_b32 v2, 16, v144
    v_and_b32 v3, 0xffff0000, v144
    v_add_f32 v176, v176, v2
    v_add_f32 v177, v177, v3
    v_lshlrev_b32 v4, 16, v145
    v_and_b32 v5, 0xffff0000, v145
    v_add_f32 v178, v178, v4
    v_add_f32 v179, v179, v5
    v_lshlrev_b32 v2, 16, v146
    v_and_b32 v3, 0xffff0000, v146
    v_add_f32 v180, v180, v2
    v_add_f32 v181, v181, v3
    v_lshlrev_b32 v4, 16, v147
    v_and_b32 v5, 0xffff0000, v147
    v_add_f32 v182, v182, v4
    v_add_f32 v183, v183, v5
    s_waitcnt vmcnt(4)
    v_lshlrev_b32 v2, 16, v148
    v_and_b32 v3, 0xffff0000, v148
    v_add_f32 v176, v176, v2
    v_add_f32 v177, v177, v3
    v_lshlrev_b32 v4, 16, v149
    v_and_b32 v5, 0xffff0000, v149
    v_add_f32 v178, v178, v4
    v_add_f32 v179, v179, v5
    v_lshlrev_b32 v2, 16, v150
    v_and_b32 v3, 0xffff0000, v150
    v_add_f32 v180, v180, v2
    v_add_f32 v181, v181, v3
    v_lshlrev_b32 v4, 16, v151
    v_and_b32 v5, 0xffff0000, v151
    v_add_f32 v182, v182, v4
    v_add_f32 v183, v183, v5
    s_waitcnt vmcnt(3)
    v_lshlrev_b32 v2, 16, v152
    v_and_b32 v3, 0xffff0000, v152
    v_add_f32 v176, v176, v2
    v_add_f32 v177, v177, v3
    v_lshlrev_b32 v4, 16, v153
    v_and_b32 v5, 0xffff0000, v153
    v_add_f32 v178, v178, v4
    v_add_f32 v179, v179, v5
    v_lshlrev_b32 v2, 16, v154
    v_and_b32 v3, 0xffff0000, v154
    v_add_f32 v180, v180, v2
    v_add_f32 v181, v181, v3
    v_lshlrev_b32 v4, 16, v155
    v_and_b32 v5, 0xffff0000, v155
    v_add_f32 v182, v182, v4
    v_add_f32 v183, v183, v5
    s_waitcnt vmcnt(2)
    v_lshlrev_b32 v2, 16, v156
    v_and_b32 v3, 0xffff0000, v156
    v_add_f32 v176, v176, v2
    v_add_f32 v177, v177, v3
    v_lshlrev_b32 v4, 16, v157
    v_and_b32 v5, 0xffff0000, v157
    v_add_f32 v178, v178, v4
    v_add_f32 v179, v179, v5
    v_lshlrev_b32 v2, 16, v158
    v_and_b32 v3, 0xffff0000, v158
    v_add_f32 v180, v180, v2
    v_add_f32 v181, v181, v3
    v_lshlrev_b32 v4, 16, v159
    v_and_b32 v5, 0xffff0000, v159
    v_add_f32 v182, v182, v4
    v_add_f32 v183, v183, v5
    s_waitcnt vmcnt(1)
    v_lshlrev_b32 v2, 16, v160
    v_and_b32 v3, 0xffff0000, v160
    v_add_f32 v176, v176, v2
    v_add_f32 v177, v177, v3
    v_lshlrev_b32 v4, 16, v161
    v_and_b32 v5, 0xffff0000, v161
    v_add_f32 v178, v178, v4
    v_add_f32 v179, v179, v5
    v_lshlrev_b32 v2, 16, v162
    v_and_b32 v3, 0xffff0000, v162
    v_add_f32 v180, v180, v2
    v_add_f32 v181, v181, v3
    v_lshlrev_b32 v4, 16, v163
    v_and_b32 v5, 0xffff0000, v163
    v_add_f32 v182, v182, v4
    v_add_f32 v183, v183, v5
    s_waitcnt vmcnt(0)
    v_lshlrev_b32 v2, 16, v164
    v_and_b32 v3, 0xffff0000, v164
    v_add_f32 v176, v176, v2
    v_add_f32 v177, v177, v3
    v_lshlrev_b32 v4, 16, v165
    v_and_b32 v5, 0xffff0000, v165
    v_add_f32 v178, v178, v4
    v_add_f32 v179, v179, v5
    v_lshlrev_b32 v2, 16, v166
    v_and_b32 v3, 0xffff0000, v166
    v_add_f32 v180, v180, v2
    v_add_f32 v181, v181, v3
    v_lshlrev_b32 v4, 16, v167
    v_and_b32 v5, 0xffff0000, v167
    v_add_f32 v182, v182, v4
    v_add_f32 v183, v183, v5
    v_cvt_pk_bf16_f32 v168, v176, v177
    v_cvt_pk_bf16_f32 v169, v178, v179
    v_cvt_pk_bf16_f32 v170, v180, v181
    v_cvt_pk_bf16_f32 v171, v182, v183
    s_nop 1
    v_permlane32_swap_b32 v168, v170
    v_permlane32_swap_b32 v169, v171
    s_nop 1
    buffer_store_dwordx4 v[168:171], v247, s[44:47], s38 offen
L_ffn_kernel_fin:
    s_waitcnt vmcnt(0) lgkmcnt(0)
L_ffn_kernel_end:
    s_endpgm
L_code_end:
.section .rodata,"a"
.p2align 6
.amdhsa_kernel sequential_preLN__linear_kernel_hedgehog__swiglu_ffn__prompt_kernel
  .amdhsa_next_free_vgpr 508
  .amdhsa_next_free_sgpr 64
  .amdhsa_accum_offset 252
  .amdhsa_group_segment_fixed_size 0
  .amdhsa_kernarg_size 88
  .amdhsa_user_sgpr_count 2
  .amdhsa_user_sgpr_kernarg_segment_ptr 1
  .amdhsa_system_sgpr_workgroup_id_x 1
.end_amdhsa_kernel
```
